```python
import torch

def _softmax(x, axis=-1):
    return torch.softmax(x, dim=axis)
def _gelu(x):
    return torch.nn.functional.gelu(x, approximate="tanh")
def _silu(x):
    return torch.nn.functional.silu(x)
def _sigmoid(x):
    return torch.sigmoid(x)
def _layernorm(x, axis=-1, eps=1e-5):
    m = x.mean(dim=axis, keepdim=True)
    v = x.var(dim=axis, keepdim=True, unbiased=False)
    return (x - m) / torch.sqrt(v + eps)
def _scatter_add(tgt, idx, src, axis=0):
    return tgt.clone().index_add_(axis, idx, src)
def _segment_sum(src, seg, n):
    out = torch.zeros((n,) + src.shape[1:], dtype=src.dtype)
    return out.index_add_(0, seg, src)
def _pad(x, pw):
    flat = tuple(v for pair in reversed(pw) for v in pair)
    return torch.nn.functional.pad(x, flat)

kernel_name = 'sequential_preLN__sliding_local_dilated__glu_gated_geglu__prompt'

def setup_inputs():

    _w = (lambda a: (lambda t: t.to(torch.bfloat16) if t.is_floating_point() else t)(torch.as_tensor(a)))
    def _A_setup():
        B, S, D = 1, 2048, 640
        return {
            "x": _w((lambda *s: torch.randn(*s, dtype=torch.bfloat16) * 0.05)(B, S, D)),
            "wqkv": _w((lambda *s: torch.randn(*s, dtype=torch.bfloat16) * 0.05)(D, 3 * D)),
            "wo": _w((lambda *s: torch.randn(*s, dtype=torch.bfloat16) * 0.05)(D, D)),
        }
    _A_in = _A_setup()

    def _B_setup():
        B, S, Dm, Df = 1, 2048, 640, 1536
        return {
            "x": _w((lambda *s: torch.randn(*s, dtype=torch.bfloat16) * 0.05)(B, S, Dm)),
            "w_gate": _w((lambda *s: torch.randn(*s, dtype=torch.bfloat16) * 0.8)(Dm, Df) * (Dm ** -0.5)),
            "w_up": _w((lambda *s: torch.randn(*s, dtype=torch.bfloat16) * 0.8)(Dm, Df) * (Dm ** -0.5)),
            "w_down": _w((lambda *s: torch.randn(*s, dtype=torch.bfloat16) * 0.8)(Df, Dm) * (Df ** -0.5)),
        }
    _B_in = _B_setup()

    return {
        "A_x": _A_in["x"],
        "A_wqkv": _A_in["wqkv"],
        "A_wo": _A_in["wo"],
        "B_x": _B_in["x"],
        "B_w_gate": _B_in["w_gate"],
        "B_w_up": _B_in["w_up"],
        "B_w_down": _B_in["w_down"],
    }

def reference(A_x, A_wqkv, A_wo, B_x, B_w_gate, B_w_up, B_w_down):
    def _A_ref(x, wqkv, wo):
        B, S, D = x.shape
        H = 32; Dh = D // H
        W, dil = 8, 2
        qkv = (lambda x, *d: x.permute(*d))((x @ wqkv).reshape(B, S, 3, H, Dh), 2, 0, 3, 1, 4)
        q, k, v = qkv[0], qkv[1], qkv[2]
        scale = Dh ** -0.5
        pos = torch.arange(S)
        off = torch.arange(W) * dil
        idx = pos[:, None] - off[None, :]
        mask = idx >= 0
        idx_c = torch.where(mask, idx, 0).reshape(-1)
        kg = k[:, :, idx_c, :].reshape(B, H, S, W, Dh)
        vg = v[:, :, idx_c, :].reshape(B, H, S, W, Dh)
        logits = torch.einsum("bhsd,bhswd->bhsw", q, kg) * scale
        logits = torch.where(mask[None, None, :, :], logits, -1e9)
        attn = _softmax(logits, axis=-1)
        o = torch.einsum("bhsw,bhswd->bhsd", attn, vg)
        return (lambda x, *d: x.permute(*d))(o, 0, 2, 1, 3).reshape(B, S, D) @ wo

    def _B_ref(x, w_gate, w_up, w_down):
        g = torch.einsum("bsd,df->bsf", x, w_gate)
        u = torch.einsum("bsd,df->bsf", x, w_up)
        h = _gelu(g) * u
        return torch.einsum("bsf,fd->bsd", h, w_down)

    x = A_x
    h = x + _A_ref(_layernorm(x, axis=-1), A_wqkv, A_wo)
    h2 = h + _B_ref(_layernorm(h, axis=-1), B_w_gate, B_w_up, B_w_down)
    return h2
```

```asm
; @launch grid=(256,1,1) block=(512,1,1) lds=163840
.amdgcn_target "amdgcn-amd-amdhsa--gfx950"
.text
.globl sequential_preLN__sliding_local_dilated__glu_gated_geglu__prompt_kernel
.p2align 8
.type sequential_preLN__sliding_local_dilated__glu_gated_geglu__prompt_kernel,@function
sequential_preLN__sliding_local_dilated__glu_gated_geglu__prompt_kernel:
  s_cmp_ge_u32 s2, 256
  s_cbranch_scc1 L_end
  s_load_dwordx16 s[4:19], s[0:1], 0
  s_load_dwordx4 s[20:23], s[0:1], 64
  v_lshrrev_b32 v1, 6, v0
  v_and_b32 v0, 63, v0
  v_readfirstlane_b32 s44, v1
  v_lshlrev_b32 v1, 4, v0
  s_cmp_lg_u32 s44, 0
  s_cbranch_scc1 L_nowarm
  s_getpc_b64 s[66:67]
L_pc:
  s_sub_u32 s66, s66, L_pc-sequential_preLN__sliding_local_dilated__glu_gated_geglu__prompt_kernel
  s_subb_u32 s67, s67, 0
  s_lshr_b32 s52, s2, 3
  s_lshl_b32 s52, s52, 4
  v_and_b32 v28, 15, v0
  v_add_u32 v28, s52, v28
  v_min_u32 v28, (L_end-sequential_preLN__sliding_local_dilated__glu_gated_geglu__prompt_kernel)/128, v28
  v_lshlrev_b32 v28, 7, v28
  global_load_dword v213, v28, s[66:67]
L_nowarm:
  s_and_b32 s52, s2, 7
  s_lshr_b32 s53, s2, 3
  s_lshr_b32 s55, s53, 4
  s_lshl_b32 s46, s52, 1
  s_add_u32 s46, s46, s55
  s_and_b32 s49, s53, 15
  s_lshr_b32 s56, s49, 3
  s_lshl_b32 s47, s46, 1
  s_add_u32 s47, s47, s56
  s_and_b32 s48, s53, 7
  s_lshl_b32 s50, s47, 6
  s_and_b32 s45, s44, 3
  v_mov_b32 v29, 163456
  v_mov_b32 v30, 1
  v_lshrrev_b32 v2, 4, v0
  v_and_b32 v5, 15, v0
  s_xor_b32 s59, s56, s48
  s_and_b32 s59, s59, 1
  s_mul_i32 s51, s59, 5
  s_mov_b32 s26, 2621440
  s_mov_b32 s27, 0x20000
  s_mov_b32 s30, 2457600
  s_mov_b32 s31, 0x20000
  s_mov_b32 s34, 21102592
  s_mov_b32 s35, 0x20000
  s_mov_b32 s38, 2621440
  s_mov_b32 s39, 0x20000
  s_mov_b32 s43, 0x20000
  s_mov_b32 s3, 0x3f803f80
  s_cmp_ge_u32 s44, 4
  s_cbranch_scc1 L_helper
  v_bfe_u32 v3, v0, 2, 2
  v_and_b32 v4, 3, v0
  s_lshl_b32 s52, s2, 2
  s_add_u32 s52, s52, s45
  s_mul_i32 s53, s52, 2432
  s_mul_i32 s52, s52, 2560
  v_lshlrev_b32 v11, 7, v0
  s_waitcnt lgkmcnt(0)
  s_add_u32 s22, s22, 0
  s_addc_u32 s23, s23, 0
  s_mov_b32 s24, s4
  s_mov_b32 s25, s5
  s_mov_b32 s28, s6
  s_mov_b32 s29, s7
  s_mov_b32 s32, s22
  s_mov_b32 s33, s23
  s_mov_b32 s36, s18
  s_mov_b32 s37, s19
  s_mov_b64 exec, 0x7ffff
  buffer_load_dword v208, v11, s[28:31], s53 offen
  s_mov_b64 exec, 0xfffff
  buffer_load_dword v209, v11, s[24:27], s52 offen
  s_mov_b64 exec, -1
  s_branch L_crest
L_helper:
  v_lshrrev_b32 v6, 3, v0
  s_lshl_b32 s53, s45, 2
  v_add_u32 v7, s53, v2
  v_xor_b32 v7, v0, v7
  v_and_b32 v7, 7, v7
  v_lshlrev_b32 v7, 4, v7
  s_lshl_b32 s53, s45, 3
  s_add_u32 s53, s53, s50
  s_add_u32 s54, s53, 16
  s_sub_u32 s53, s53, 16
  v_add_u32 v8, s53, v6
  v_max_i32 v8, 0, v8
  v_mul_u32_u24 v8, 1280, v8
  v_add_u32 v14, v8, v7
  v_add_u32 v8, s54, v6
  v_mul_u32_u24 v8, 1280, v8
  v_add_u32 v15, v8, v7
  s_lshl_b32 s70, s45, 10
  s_cmp_lt_u32 s45, 2
  s_cselect_b32 s71, 40960, 0
  s_cselect_b32 s72, 2, 1
  s_lshl_b32 s72, s72, 12
  s_add_u32 s73, s70, 10240
  s_cmp_eq_u32 s45, 0
  s_cselect_b32 s74, 0xffffff00, -1
  s_mov_b32 s60, s51
  s_mov_b32 s61, 0
  v_lshrrev_b32 v6, 5, v0
  s_lshl_b32 s53, s45, 1
  v_add_u32 v6, s53, v6
  v_bfe_u32 v7, v0, 1, 4
  v_and_b32 v8, 3, v6
  v_xor_b32 v7, v7, v8
  v_mul_u32_u24 v6, 3840, v6
  v_and_b32 v8, 1, v0
  v_lshl_add_u32 v6, v8, 4, v6
  s_mul_i32 s52, s48, 160
  v_add_u32 v6, s52, v6
  v_mov_b32 v22, 0x80000000
  v_mul_u32_u24 v8, 52, v7
  v_lshrrev_b32 v8, 8, v8
  v_mul_u32_u24 v8, 1120, v8
  v_lshl_add_u32 v8, v7, 5, v8
  v_add_u32 v8, v8, v6
  v_cmp_eq_u32 vcc, 15, v7
  s_nop 1
  v_cndmask_b32 v10, v8, v22, vcc
  v_xor_b32 v7, 4, v7
  v_mul_u32_u24 v8, 52, v7
  v_lshrrev_b32 v8, 8, v8
  v_mul_u32_u24 v8, 1120, v8
  v_lshl_add_u32 v8, v7, 5, v8
  v_add_u32 v8, v8, v6
  v_cmp_eq_u32 vcc, 15, v7
  s_nop 1
  v_cndmask_b32 v11, v8, v22, vcc
  s_waitcnt lgkmcnt(0)
  s_add_u32 s22, s22, 0
  s_addc_u32 s23, s23, 0
  s_mov_b32 s24, s4
  s_mov_b32 s25, s5
  s_mov_b32 s28, s6
  s_mov_b32 s29, s7
  s_mov_b32 s32, s22
  s_mov_b32 s33, s23
  s_mov_b32 s36, s18
  s_mov_b32 s37, s19
  s_lshl_b32 s62, s60, 7
  s_add_u32 s64, s61, s70
  s_mov_b32 m0, s64
  s_mov_b32 exec_lo, s74
  buffer_load_dwordx4 v14, s[24:27], s62 offen lds
  s_add_u32 m0, s64, 4096
  s_mov_b32 exec_lo, -1
  buffer_load_dwordx4 v15, s[24:27], s62 offen lds
  s_add_u32 m0, s64, s72
  s_add_u32 s62, s62, s71
  buffer_load_dwordx4 v15, s[24:27], s62 offen lds
  s_mul_i32 s63, s60, 245760
  s_add_u32 s64, s61, s73
  s_add_u32 m0, s64, 0
  s_nop 0
  buffer_load_dwordx4 v10, s[28:31], s63 offen lds
  s_add_u32 m0, s64, 4096
  s_add_u32 s63, s63, 30720
  buffer_load_dwordx4 v11, s[28:31], s63 offen lds
  s_add_u32 m0, s64, 8192
  s_add_u32 s63, s63, 30720
  buffer_load_dwordx4 v10, s[28:31], s63 offen lds
  s_add_u32 m0, s64, 12288
  s_add_u32 s63, s63, 30720
  buffer_load_dwordx4 v11, s[28:31], s63 offen lds
  s_add_u32 m0, s64, 16384
  s_add_u32 s63, s63, 30720
  buffer_load_dwordx4 v10, s[28:31], s63 offen lds
  s_add_u32 m0, s64, 20480
  s_add_u32 s63, s63, 30720
  buffer_load_dwordx4 v11, s[28:31], s63 offen lds
  s_add_u32 m0, s64, 24576
  s_add_u32 s63, s63, 30720
  buffer_load_dwordx4 v10, s[28:31], s63 offen lds
  s_add_u32 m0, s64, 28672
  s_add_u32 s63, s63, 30720
  buffer_load_dwordx4 v11, s[28:31], s63 offen lds
  s_add_u32 s60, s60, 1
  s_cmp_ge_u32 s60, 10
  s_cselect_b32 s60, 0, s60
  s_add_u32 s61, s61, 43008
  s_cmp_ge_u32 s61, 129024
  s_cselect_b32 s61, 0, s61
  v_mov_b32 v24, s3
  v_mov_b32 v25, s3
  v_mov_b32 v26, s3
  v_mov_b32 v27, s3
  v_add_u32 v28, 86016, v1
  v_lshl_add_u32 v23, v0, 3, v29
  v_mov_b32 v20, 0
  v_mov_b32 v21, 0
  s_mov_b64 exec, 0xff
  ds_write_b128 v1, v[24:27]
  ds_write_b128 v1, v[24:27] offset:43008
  ds_write_b128 v28, v[24:27]
  s_mov_b32 exec_lo, -1
  s_mov_b32 exec_hi, 0xffff
  ds_write_b64 v23, v[20:21]
  s_mov_b64 exec, -1
  v_lshrrev_b32 v8, 1, v5
  v_xor_b32 v9, v2, v8
  v_lshlrev_b32 v9, 4, v9
  v_lshl_add_u32 v17, v5, 7, v9
  v_xor_b32 v18, 64, v17
  s_lshl_b32 s65, s45, 11
  s_mov_b32 s75, 0
  v_mov_b32 v32, 0
  v_mov_b32 v33, 0
  v_mov_b32 v34, 0
  v_mov_b32 v35, 0
  v_lshrrev_b32 v6, 1, v0
  v_and_b32 v7, 1, v0
  v_lshlrev_b32 v7, 4, v7
  v_mul_u32_u24 v12, 3072, v6
  v_add_u32 v12, v12, v7
  v_mul_u32_u24 v13, 1280, v6
  v_add_u32 v13, v13, v7
  v_bfe_u32 v3, v0, 2, 2
  v_and_b32 v4, 3, v0
  s_mul_i32 s59, s45, 6144
  s_add_u32 s59, s59, 133120
  v_lshl_add_u32 v16, v2, 2, v3
  v_lshlrev_b32 v16, 5, v16
  v_lshl_add_u32 v16, v4, 3, v16
  v_add_u32 v16, s59, v16
  v_lshrrev_b32 v6, 1, v2
  v_and_b32 v7, 1, v2
  v_lshlrev_b32 v58, 2, v6
  v_add_u32 v58, v58, v7
  v_lshl_add_u32 v58, v58, 2, v3
  v_lshlrev_b32 v58, 5, v58
  v_lshl_add_u32 v58, v4, 3, v58
  v_add_u32 v58, s59, v58
  v_mul_u32_u24 v59, 6144, v6
  v_lshl_add_u32 v59, v7, 9, v59
  v_lshl_add_u32 v59, v5, 4, v59
  s_waitcnt lgkmcnt(0)
  s_and_b32 s52, s45, 1
  s_mul_i32 s52, s52, 49152
  s_mul_i32 s53, s49, 192
  s_add_u32 s52, s52, s53
  s_lshr_b32 s53, s45, 1
  s_mul_i32 s53, s53, 384
  s_add_u32 s53, s53, 162688
  s_mul_i32 s65, s45, 3072
  v_add_u32 v94, s65, v1
  v_add_u32 v95, 0x10000, v94
  v_add_u32 v96, 0x20000, v94
  s_lshl_b32 s65, s45, 11
  v_add_u32 v6, 0, v0
  v_mul_u32_u24 v7, 171, v6
  v_lshrrev_b32 v7, 11, v7
  v_mul_u32_u24 v8, 12, v7
  v_sub_u32 v6, v6, v8
  v_bfe_u32 v8, v7, 2, 1
  v_lshlrev_b32 v8, 1, v8
  v_xor_b32 v6, v6, v8
  v_mul_u32_u24 v7, 3072, v7
  v_lshl_add_u32 v7, v6, 4, v7
  v_add_u32 v88, s52, v7
  v_add_u32 v6, 64, v0
  v_mul_u32_u24 v7, 171, v6
  v_lshrrev_b32 v7, 11, v7
  v_mul_u32_u24 v8, 12, v7
  v_sub_u32 v6, v6, v8
  v_bfe_u32 v8, v7, 2, 1
  v_lshlrev_b32 v8, 1, v8
  v_xor_b32 v6, v6, v8
  v_mul_u32_u24 v7, 3072, v7
  v_lshl_add_u32 v7, v6, 4, v7
  v_add_u32 v89, s52, v7
  v_add_u32 v6, 128, v0
  v_mul_u32_u24 v7, 171, v6
  v_lshrrev_b32 v7, 11, v7
  v_mul_u32_u24 v8, 12, v7
  v_sub_u32 v6, v6, v8
  v_bfe_u32 v8, v7, 2, 1
  v_lshlrev_b32 v8, 1, v8
  v_xor_b32 v6, v6, v8
  v_mul_u32_u24 v7, 3072, v7
  v_lshl_add_u32 v7, v6, 4, v7
  v_add_u32 v90, s52, v7
  v_lshrrev_b32 v6, 3, v0
  s_lshl_b32 s52, s45, 5
  v_add_u32 v6, s52, v6
  v_mul_u32_u24 v97, 3072, v6
  v_and_b32 v6, 7, v0
  v_lshl_add_u32 v97, v6, 4, v97
  v_lshlrev_b32 v98, 5, v6
  s_cmp_ge_u32 s2, 240
  s_cselect_b32 s42, 0, 1966080
  s_mul_i32 s52, s2, 205
  s_lshr_b32 s52, s52, 10
  s_mul_i32 s53, s52, 5
  s_sub_u32 s53, s2, s53
  s_cmp_ge_u32 s52, 24
  s_cselect_b32 s40, s14, s12
  s_cselect_b32 s41, s15, s13
  s_cselect_b32 s54, 1, 0
  s_mul_i32 s55, s54, 24
  s_sub_u32 s55, s52, s55
  s_mul_i32 s76, s53, 393216
  s_lshl_b32 s57, s55, 7
  s_add_u32 s76, s76, s57
  s_lshl_b32 s58, s45, 5
  s_add_u32 s76, s76, s58
  s_mul_i32 s77, s52, 40960
  s_lshl_b32 s57, s53, 8
  s_add_u32 s77, s77, s57
  s_add_u32 s77, s77, s58
  s_lshl_b32 s56, s55, 2
  s_add_u32 s56, s56, s45
  s_mul_i32 s57, s56, 43
  s_lshr_b32 s57, s57, 8
  s_mul_i32 s58, s57, 6
  s_sub_u32 s58, s56, s58
  s_lshl_b32 s58, s58, 2
  s_add_u32 s58, s58, s54
  s_lshl_b32 s58, s58, 8
  s_mul_i32 s57, s57, 245760
  s_add_u32 s57, s57, s58
  s_mul_i32 s58, s53, 49152
  s_add_u32 s57, s57, s58
  s_add_u32 s78, s57, 1048576
  s_lshl_b32 s81, s56, 6
  s_mul_i32 s58, s54, 6144
  s_add_u32 s81, s81, s58
  s_mul_i32 s58, s53, 12288
  s_add_u32 s81, s81, s58
  s_add_u32 s81, s81, 8388608
  s_mul_i32 s85, s52, 5120
  s_add_u32 s85, s85, 5242880
  s_lshl_b32 s56, s53, 3
  s_add_u32 s56, s56, 0
  s_add_u32 s56, s56, s45
  s_mul_i32 s57, s56, 205
  s_lshr_b32 s57, s57, 10
  s_mul_i32 s58, s57, 5
  s_sub_u32 s58, s56, s58
  s_mul_i32 s57, s57, 245760
  s_lshl_b32 s58, s58, 10
  s_add_u32 s57, s57, s58
  s_add_u32 s79, s57, s85
  s_lshl_b32 s56, s53, 3
  s_add_u32 s56, s56, 4
  s_add_u32 s56, s56, s45
  s_mul_i32 s57, s56, 205
  s_lshr_b32 s57, s57, 10
  s_mul_i32 s58, s57, 5
  s_sub_u32 s58, s56, s58
  s_mul_i32 s57, s57, 245760
  s_lshl_b32 s58, s58, 10
  s_add_u32 s57, s57, s58
  s_add_u32 s80, s57, s85
  v_lshlrev_b32 v24, 2, v5
  s_lshl_b32 s52, s46, 10
  s_add_u32 s52, s52, 768
  v_add_u32 v24, s52, v24
  v_mov_b32 v54, 0
  v_lshlrev_b32 v25, 10, v5
  v_add_u32 v25, 512, v25
  v_lshlrev_b32 v53, 7, v0
  s_lshl_b32 s86, s47, 2
  s_add_u32 s86, s86, s45
  s_lshr_b32 s87, s86, 1
  s_mul_i32 s87, s87, 40960
  s_and_b32 s52, s45, 1
  s_mul_i32 s52, s52, 3072
  s_add_u32 s87, s87, s52
  s_lshl_b32 s62, s60, 7
  s_add_u32 s64, s61, s70
  s_mov_b32 m0, s64
  s_mov_b32 exec_lo, s74
  buffer_load_dwordx4 v14, s[24:27], s62 offen lds
  s_add_u32 m0, s64, 4096
  s_mov_b32 exec_lo, -1
  buffer_load_dwordx4 v15, s[24:27], s62 offen lds
  s_add_u32 m0, s64, s72
  s_add_u32 s62, s62, s71
  buffer_load_dwordx4 v15, s[24:27], s62 offen lds
  s_mul_i32 s63, s60, 245760
  s_add_u32 s64, s61, s73
  s_add_u32 m0, s64, 0
  s_nop 0
  buffer_load_dwordx4 v10, s[28:31], s63 offen lds
  s_add_u32 m0, s64, 4096
  s_add_u32 s63, s63, 30720
  buffer_load_dwordx4 v11, s[28:31], s63 offen lds
  s_add_u32 m0, s64, 8192
  s_add_u32 s63, s63, 30720
  buffer_load_dwordx4 v10, s[28:31], s63 offen lds
  s_add_u32 m0, s64, 12288
  s_add_u32 s63, s63, 30720
  buffer_load_dwordx4 v11, s[28:31], s63 offen lds
  s_add_u32 m0, s64, 16384
  s_add_u32 s63, s63, 30720
  buffer_load_dwordx4 v10, s[28:31], s63 offen lds
  s_add_u32 m0, s64, 20480
  s_add_u32 s63, s63, 30720
  buffer_load_dwordx4 v11, s[28:31], s63 offen lds
  s_add_u32 m0, s64, 24576
  s_add_u32 s63, s63, 30720
  buffer_load_dwordx4 v10, s[28:31], s63 offen lds
  s_add_u32 m0, s64, 28672
  s_add_u32 s63, s63, 30720
  buffer_load_dwordx4 v11, s[28:31], s63 offen lds
  s_add_u32 s60, s60, 1
  s_cmp_ge_u32 s60, 10
  s_cselect_b32 s60, 0, s60
  s_add_u32 s61, s61, 43008
  s_cmp_ge_u32 s61, 129024
  s_cselect_b32 s61, 0, s61
  s_mov_b32 s58, 0
L_h1:
  s_waitcnt vmcnt(11)
  s_barrier
  s_lshl_b32 s62, s60, 7
  s_add_u32 s64, s61, s70
  s_mov_b32 m0, s64
  s_mov_b32 exec_lo, s74
  buffer_load_dwordx4 v14, s[24:27], s62 offen lds
  s_add_u32 m0, s64, 4096
  s_mov_b32 exec_lo, -1
  buffer_load_dwordx4 v15, s[24:27], s62 offen lds
  s_add_u32 m0, s64, s72
  s_add_u32 s62, s62, s71
  buffer_load_dwordx4 v15, s[24:27], s62 offen lds
  s_mul_i32 s63, s60, 245760
  s_add_u32 s64, s61, s73
  s_add_u32 m0, s64, 0
  s_nop 0
  buffer_load_dwordx4 v10, s[28:31], s63 offen lds
  s_add_u32 m0, s64, 4096
  s_add_u32 s63, s63, 30720
  buffer_load_dwordx4 v11, s[28:31], s63 offen lds
  s_add_u32 m0, s64, 8192
  s_add_u32 s63, s63, 30720
  buffer_load_dwordx4 v10, s[28:31], s63 offen lds
  s_add_u32 m0, s64, 12288
  s_add_u32 s63, s63, 30720
  buffer_load_dwordx4 v11, s[28:31], s63 offen lds
  s_add_u32 m0, s64, 16384
  s_add_u32 s63, s63, 30720
  buffer_load_dwordx4 v10, s[28:31], s63 offen lds
  s_add_u32 m0, s64, 20480
  s_add_u32 s63, s63, 30720
  buffer_load_dwordx4 v11, s[28:31], s63 offen lds
  s_add_u32 m0, s64, 24576
  s_add_u32 s63, s63, 30720
  buffer_load_dwordx4 v10, s[28:31], s63 offen lds
  s_add_u32 m0, s64, 28672
  s_add_u32 s63, s63, 30720
  buffer_load_dwordx4 v11, s[28:31], s63 offen lds
  s_add_u32 s60, s60, 1
  s_cmp_ge_u32 s60, 10
  s_cselect_b32 s60, 0, s60
  s_add_u32 s61, s61, 43008
  s_cmp_ge_u32 s61, 129024
  s_cselect_b32 s61, 0, s61
  s_add_u32 s52, s75, s65
  v_add_u32 v19, s52, v17
  v_add_u32 v20, s52, v18
  v_add_u32 v21, s75, v17
  v_add_u32 v23, s75, v18
  ds_read_b128 v[36:39], v19
  ds_read_b128 v[40:43], v20
  ds_read_b128 v[44:47], v21 offset:8192
  ds_read_b128 v[48:51], v23 offset:8192
  s_waitcnt lgkmcnt(3)
  v_dot2_f32_bf16 v32, v36, s3, v32
  v_dot2_f32_bf16 v33, v36, v36, v33
  v_dot2_f32_bf16 v32, v37, s3, v32
  v_dot2_f32_bf16 v33, v37, v37, v33
  v_dot2_f32_bf16 v32, v38, s3, v32
  v_dot2_f32_bf16 v33, v38, v38, v33
  v_dot2_f32_bf16 v32, v39, s3, v32
  v_dot2_f32_bf16 v33, v39, v39, v33
  s_waitcnt lgkmcnt(2)
  v_dot2_f32_bf16 v32, v40, s3, v32
  v_dot2_f32_bf16 v33, v40, v40, v33
  v_dot2_f32_bf16 v32, v41, s3, v32
  v_dot2_f32_bf16 v33, v41, v41, v33
  v_dot2_f32_bf16 v32, v42, s3, v32
  v_dot2_f32_bf16 v33, v42, v42, v33
  v_dot2_f32_bf16 v32, v43, s3, v32
  v_dot2_f32_bf16 v33, v43, v43, v33
  s_waitcnt lgkmcnt(1)
  v_dot2_f32_bf16 v34, v44, s3, v34
  v_dot2_f32_bf16 v35, v44, v44, v35
  v_dot2_f32_bf16 v34, v45, s3, v34
  v_dot2_f32_bf16 v35, v45, v45, v35
  v_dot2_f32_bf16 v34, v46, s3, v34
  v_dot2_f32_bf16 v35, v46, v46, v35
  v_dot2_f32_bf16 v34, v47, s3, v34
  v_dot2_f32_bf16 v35, v47, v47, v35
  s_waitcnt lgkmcnt(0)
  v_dot2_f32_bf16 v34, v48, s3, v34
  v_dot2_f32_bf16 v35, v48, v48, v35
  v_dot2_f32_bf16 v34, v49, s3, v34
  v_dot2_f32_bf16 v35, v49, v49, v35
  v_dot2_f32_bf16 v34, v50, s3, v34
  v_dot2_f32_bf16 v35, v50, v50, v35
  v_dot2_f32_bf16 v34, v51, s3, v34
  v_dot2_f32_bf16 v35, v51, v51, v35
  s_add_u32 s75, s75, 43008
  s_cmp_ge_u32 s75, 129024
  s_cselect_b32 s75, 0, s75
  s_add_u32 s58, s58, 1
  s_cmp_lt_u32 s58, 7
  s_cbranch_scc1 L_h1
  s_waitcnt vmcnt(11)
  s_barrier
  s_lshl_b32 s62, s60, 7
  s_add_u32 s64, s61, s70
  s_mov_b32 m0, s64
  s_mov_b32 exec_lo, s74
  buffer_load_dwordx4 v14, s[24:27], s62 offen lds
  s_add_u32 m0, s64, 4096
  s_mov_b32 exec_lo, -1
  buffer_load_dwordx4 v15, s[24:27], s62 offen lds
  s_add_u32 m0, s64, s72
  s_add_u32 s62, s62, s71
  buffer_load_dwordx4 v15, s[24:27], s62 offen lds
  s_mul_i32 s63, s60, 245760
  s_add_u32 s64, s61, s73
  s_add_u32 m0, s64, 0
  s_nop 0
  buffer_load_dwordx4 v10, s[28:31], s63 offen lds
  s_add_u32 m0, s64, 4096
  s_add_u32 s63, s63, 30720
  buffer_load_dwordx4 v11, s[28:31], s63 offen lds
  s_add_u32 m0, s64, 8192
  s_add_u32 s63, s63, 30720
  buffer_load_dwordx4 v10, s[28:31], s63 offen lds
  s_add_u32 m0, s64, 12288
  s_add_u32 s63, s63, 30720
  buffer_load_dwordx4 v11, s[28:31], s63 offen lds
  s_add_u32 m0, s64, 16384
  s_add_u32 s63, s63, 30720
  buffer_load_dwordx4 v10, s[28:31], s63 offen lds
  s_add_u32 m0, s64, 20480
  s_add_u32 s63, s63, 30720
  buffer_load_dwordx4 v11, s[28:31], s63 offen lds
  s_add_u32 m0, s64, 24576
  s_add_u32 s63, s63, 30720
  buffer_load_dwordx4 v10, s[28:31], s63 offen lds
  s_add_u32 m0, s64, 28672
  s_add_u32 s63, s63, 30720
  buffer_load_dwordx4 v11, s[28:31], s63 offen lds
  s_add_u32 s60, s60, 1
  s_cmp_ge_u32 s60, 10
  s_cselect_b32 s60, 0, s60
  s_add_u32 s61, s61, 43008
  s_cmp_ge_u32 s61, 129024
  s_cselect_b32 s61, 0, s61
  global_load_dword v27, v24, s[22:23] sc1
  global_load_dword v26, v54, s[20:21] offset:192 sc1
  s_add_u32 s52, s75, s65
  v_add_u32 v19, s52, v17
  v_add_u32 v20, s52, v18
  v_add_u32 v21, s75, v17
  v_add_u32 v23, s75, v18
  ds_read_b128 v[36:39], v19
  ds_read_b128 v[40:43], v20
  ds_read_b128 v[44:47], v21 offset:8192
  ds_read_b128 v[48:51], v23 offset:8192
  s_waitcnt lgkmcnt(3)
  v_dot2_f32_bf16 v32, v36, s3, v32
  v_dot2_f32_bf16 v33, v36, v36, v33
  v_dot2_f32_bf16 v32, v37, s3, v32
  v_dot2_f32_bf16 v33, v37, v37, v33
  v_dot2_f32_bf16 v32, v38, s3, v32
  v_dot2_f32_bf16 v33, v38, v38, v33
  v_dot2_f32_bf16 v32, v39, s3, v32
  v_dot2_f32_bf16 v33, v39, v39, v33
  s_waitcnt lgkmcnt(2)
  v_dot2_f32_bf16 v32, v40, s3, v32
  v_dot2_f32_bf16 v33, v40, v40, v33
  v_dot2_f32_bf16 v32, v41, s3, v32
  v_dot2_f32_bf16 v33, v41, v41, v33
  v_dot2_f32_bf16 v32, v42, s3, v32
  v_dot2_f32_bf16 v33, v42, v42, v33
  v_dot2_f32_bf16 v32, v43, s3, v32
  v_dot2_f32_bf16 v33, v43, v43, v33
  s_waitcnt lgkmcnt(1)
  v_dot2_f32_bf16 v34, v44, s3, v34
  v_dot2_f32_bf16 v35, v44, v44, v35
  v_dot2_f32_bf16 v34, v45, s3, v34
  v_dot2_f32_bf16 v35, v45, v45, v35
  v_dot2_f32_bf16 v34, v46, s3, v34
  v_dot2_f32_bf16 v35, v46, v46, v35
  v_dot2_f32_bf16 v34, v47, s3, v34
  v_dot2_f32_bf16 v35, v47, v47, v35
  s_waitcnt lgkmcnt(0)
  v_dot2_f32_bf16 v34, v48, s3, v34
  v_dot2_f32_bf16 v35, v48, v48, v35
  v_dot2_f32_bf16 v34, v49, s3, v34
  v_dot2_f32_bf16 v35, v49, v49, v35
  v_dot2_f32_bf16 v34, v50, s3, v34
  v_dot2_f32_bf16 v35, v50, v50, v35
  v_dot2_f32_bf16 v34, v51, s3, v34
  v_dot2_f32_bf16 v35, v51, v51, v35
  s_add_u32 s75, s75, 43008
  s_cmp_ge_u32 s75, 129024
  s_cselect_b32 s75, 0, s75
  s_waitcnt vmcnt(13)
  s_barrier
  s_mov_b32 s88, s40
  s_mov_b32 s89, s41
  s_mov_b32 s90, s42
  s_mov_b32 s91, 0x20000
  s_add_u32 s52, s59, 4096
  s_mov_b32 s40, s16
  s_mov_b32 s41, s17
  s_cmp_ge_u32 s2, 240
  s_cselect_b32 s42, 0, 1966080
  s_mov_b32 m0, s52
  s_nop 0
  buffer_load_dwordx4 v13, s[40:43], s77 offen  lds
  s_add_u32 m0, s52, 1024
  s_add_u32 s77, s77, 128
  buffer_load_dwordx4 v13, s[40:43], s77 offen  lds
  s_lshl_b32 s52, s45, 5
  s_sub_u32 s76, s76, s52
  buffer_load_dwordx4 v[100:103], v97, s[88:91], s76 offen
  s_add_u32 s76, s76, 24576
  buffer_load_dwordx4 v[104:107], v97, s[88:91], s76 offen
  s_add_u32 s76, s76, 24576
  buffer_load_dwordx4 v[108:111], v97, s[88:91], s76 offen
  s_add_u32 s76, s76, 24576
  buffer_load_dwordx4 v[112:115], v97, s[88:91], s76 offen
  s_add_u32 s52, s75, s65
  v_add_u32 v19, s52, v17
  v_add_u32 v20, s52, v18
  v_add_u32 v21, s75, v17
  v_add_u32 v23, s75, v18
  ds_read_b128 v[36:39], v19
  ds_read_b128 v[40:43], v20
  ds_read_b128 v[44:47], v21 offset:8192
  ds_read_b128 v[48:51], v23 offset:8192
  s_waitcnt lgkmcnt(3)
  v_dot2_f32_bf16 v32, v36, s3, v32
  v_dot2_f32_bf16 v33, v36, v36, v33
  v_dot2_f32_bf16 v32, v37, s3, v32
  v_dot2_f32_bf16 v33, v37, v37, v33
  v_dot2_f32_bf16 v32, v38, s3, v32
  v_dot2_f32_bf16 v33, v38, v38, v33
  v_dot2_f32_bf16 v32, v39, s3, v32
  v_dot2_f32_bf16 v33, v39, v39, v33
  s_waitcnt lgkmcnt(2)
  v_dot2_f32_bf16 v32, v40, s3, v32
  v_dot2_f32_bf16 v33, v40, v40, v33
  v_dot2_f32_bf16 v32, v41, s3, v32
  v_dot2_f32_bf16 v33, v41, v41, v33
  v_dot2_f32_bf16 v32, v42, s3, v32
  v_dot2_f32_bf16 v33, v42, v42, v33
  v_dot2_f32_bf16 v32, v43, s3, v32
  v_dot2_f32_bf16 v33, v43, v43, v33
  s_waitcnt lgkmcnt(1)
  v_dot2_f32_bf16 v34, v44, s3, v34
  v_dot2_f32_bf16 v35, v44, v44, v35
  v_dot2_f32_bf16 v34, v45, s3, v34
  v_dot2_f32_bf16 v35, v45, v45, v35
  v_dot2_f32_bf16 v34, v46, s3, v34
  v_dot2_f32_bf16 v35, v46, v46, v35
  v_dot2_f32_bf16 v34, v47, s3, v34
  v_dot2_f32_bf16 v35, v47, v47, v35
  s_waitcnt lgkmcnt(0)
  v_dot2_f32_bf16 v34, v48, s3, v34
  v_dot2_f32_bf16 v35, v48, v48, v35
  v_dot2_f32_bf16 v34, v49, s3, v34
  v_dot2_f32_bf16 v35, v49, v49, v35
  v_dot2_f32_bf16 v34, v50, s3, v34
  v_dot2_f32_bf16 v35, v50, v50, v35
  v_dot2_f32_bf16 v34, v51, s3, v34
  v_dot2_f32_bf16 v35, v51, v51, v35
  s_add_u32 s75, s75, 43008
  s_cmp_ge_u32 s75, 129024
  s_cselect_b32 s75, 0, s75
  s_waitcnt vmcnt(8)
  s_barrier
  s_setprio 2
  s_add_u32 s52, s75, s65
  v_add_u32 v19, s52, v17
  v_add_u32 v20, s52, v18
  v_add_u32 v21, s75, v17
  v_add_u32 v23, s75, v18
  ds_read_b128 v[36:39], v19
  ds_read_b128 v[40:43], v20
  ds_read_b128 v[44:47], v21 offset:8192
  ds_read_b128 v[48:51], v23 offset:8192
  s_waitcnt lgkmcnt(3)
  v_dot2_f32_bf16 v32, v36, s3, v32
  v_dot2_f32_bf16 v33, v36, v36, v33
  v_dot2_f32_bf16 v32, v37, s3, v32
  v_dot2_f32_bf16 v33, v37, v37, v33
  v_dot2_f32_bf16 v32, v38, s3, v32
  v_dot2_f32_bf16 v33, v38, v38, v33
  v_dot2_f32_bf16 v32, v39, s3, v32
  v_dot2_f32_bf16 v33, v39, v39, v33
  s_waitcnt lgkmcnt(2)
  v_dot2_f32_bf16 v32, v40, s3, v32
  v_dot2_f32_bf16 v33, v40, v40, v33
  v_dot2_f32_bf16 v32, v41, s3, v32
  v_dot2_f32_bf16 v33, v41, v41, v33
  v_dot2_f32_bf16 v32, v42, s3, v32
  v_dot2_f32_bf16 v33, v42, v42, v33
  v_dot2_f32_bf16 v32, v43, s3, v32
  v_dot2_f32_bf16 v33, v43, v43, v33
  s_waitcnt lgkmcnt(1)
  v_dot2_f32_bf16 v34, v44, s3, v34
  v_dot2_f32_bf16 v35, v44, v44, v35
  v_dot2_f32_bf16 v34, v45, s3, v34
  v_dot2_f32_bf16 v35, v45, v45, v35
  v_dot2_f32_bf16 v34, v46, s3, v34
  v_dot2_f32_bf16 v35, v46, v46, v35
  v_dot2_f32_bf16 v34, v47, s3, v34
  v_dot2_f32_bf16 v35, v47, v47, v35
  s_waitcnt lgkmcnt(0)
  v_dot2_f32_bf16 v34, v48, s3, v34
  v_dot2_f32_bf16 v35, v48, v48, v35
  v_dot2_f32_bf16 v34, v49, s3, v34
  v_dot2_f32_bf16 v35, v49, v49, v35
  v_dot2_f32_bf16 v34, v50, s3, v34
  v_dot2_f32_bf16 v35, v50, v50, v35
  v_dot2_f32_bf16 v34, v51, s3, v34
  v_dot2_f32_bf16 v35, v51, v51, v35
  s_add_u32 s75, s75, 43008
  s_cmp_ge_u32 s75, 129024
  s_cselect_b32 s75, 0, s75
  v_mov_b32 v36, v32
  v_mov_b32 v37, v33
  v_mov_b32 v38, v34
  v_mov_b32 v39, v35
  v_permlane16_swap_b32 v32, v36
  v_permlane16_swap_b32 v33, v37
  v_permlane16_swap_b32 v34, v38
  v_permlane16_swap_b32 v35, v39
  v_add_f32 v32, v32, v36
  v_add_f32 v33, v33, v37
  v_add_f32 v34, v34, v38
  v_add_f32 v35, v35, v39
  v_mov_b32 v36, v32
  v_mov_b32 v37, v33
  v_mov_b32 v38, v34
  v_mov_b32 v39, v35
  v_permlane32_swap_b32 v32, v36
  v_permlane32_swap_b32 v33, v37
  v_permlane32_swap_b32 v34, v38
  v_permlane32_swap_b32 v35, v39
  v_add_f32 v32, v32, v36
  v_add_f32 v33, v33, v37
  v_add_f32 v34, v34, v38
  v_add_f32 v35, v35, v39
  v_mul_f32 v32, 0xbacccccd, v32
  v_mul_f32 v33, 0x3acccccd, v33
  v_fma_f32 v33, -v32, v32, v33
  v_max_f32 v33, 0, v33
  v_add_f32 v33, 0x3727c5ac, v33
  v_rsq_f32 v33, v33
  v_mul_f32 v34, 0xbacccccd, v34
  v_mul_f32 v35, 0x3acccccd, v35
  v_fma_f32 v35, -v34, v34, v35
  v_max_f32 v35, 0, v35
  v_add_f32 v35, 0x3727c5ac, v35
  v_rsq_f32 v35, v35
  v_lshlrev_b32 v19, 3, v5
  s_lshl_b32 s52, s45, 7
  s_add_u32 s52, s52, 162048
  v_add_u32 v20, s52, v19
  v_add_u32 v21, 162560, v19
  ds_write_b64 v20, v[32:33]
  ds_write_b64 v21, v[34:35]
  s_waitcnt vmcnt(4)
  ds_read_b64_tr_b16 v[80:81], v16 offset:4096
  ds_read_b64_tr_b16 v[82:83], v16 offset:4608
  ds_read_b64_tr_b16 v[84:85], v16 offset:5120
  ds_read_b64_tr_b16 v[86:87], v16 offset:5632
  s_waitcnt lgkmcnt(0)
  s_setprio 0
  s_barrier
  s_mul_i32 s52, s48, 2560
  s_mul_i32 s53, s86, 49152
  s_add_u32 s52, s52, s53
  s_add_u32 s52, s52, 14680064
  s_mov_b32 exec_lo, 0xfffff
  s_mov_b32 exec_hi, 0x0
  buffer_load_dword v52, v53, s[32:35], s52 offen sc1
  s_mov_b64 exec, -1
  v_cmp_gt_u32 vcc, 16, v26
  s_mov_b32 s57, 0
  s_cbranch_vccz L_ag39_ok
L_ag39:
  s_sleep 8
  global_load_dword v26, v54, s[20:21] offset:192 sc1
  s_waitcnt vmcnt(0)
  v_cmp_gt_u32 vcc, 16, v26
  s_add_u32 s57, s57, 1
  s_cbranch_vccz L_ag39_ok
  s_cmp_lt_u32 s57, 65536
  s_cbranch_scc1 L_ag39
L_ag39_ok:
  v_cmp_gt_u32 vcc, 1, v27
  s_mov_b32 s57, 0
  s_cbranch_vccz L_ag40_ok
L_ag40:
  s_sleep 8
  global_load_dword v27, v24, s[22:23] sc1
  s_waitcnt vmcnt(0)
  v_cmp_gt_u32 vcc, 1, v27
  s_add_u32 s57, s57, 1
  s_cbranch_vccz L_ag40_ok
  s_cmp_lt_u32 s57, 65536
  s_cbranch_scc1 L_ag40
L_ag40_ok:
  s_getreg_b32 s53, hwreg(HW_REG_XCC_ID)
  s_and_b32 s53, s53, 15
  s_add_u32 s53, s53, 1
  v_cmp_ne_u32 vcc, s53, v27
  s_cmp_eq_u64 vcc, 0
  s_cselect_b32 s53, 2, 1
  v_mov_b32 v27, s53
  ds_write_b32 v29, v27 offset:280
  s_mov_b32 s40, s22
  s_mov_b32 s41, s23
  s_cmp_ge_u32 s2, 240
  s_cselect_b32 s42, 0, 21102592
  buffer_store_dwordx4 v[80:83], v1, s[40:43], s79 offen sc1
  buffer_store_dwordx4 v[84:87], v1, s[40:43], s80 offen sc1
  s_waitcnt vmcnt(6)
  v_lshlrev_b32 v116, 16, v100
  v_and_b32 v117, 0xffff0000, v100
  v_lshlrev_b32 v118, 16, v101
  v_and_b32 v119, 0xffff0000, v101
  v_lshlrev_b32 v120, 16, v102
  v_and_b32 v121, 0xffff0000, v102
  v_lshlrev_b32 v122, 16, v103
  v_and_b32 v123, 0xffff0000, v103
  s_waitcnt vmcnt(5)
  v_lshlrev_b32 v124, 16, v104
  v_and_b32 v125, 0xffff0000, v104
  v_add_f32 v116, v116, v124
  v_add_f32 v117, v117, v125
  v_lshlrev_b32 v124, 16, v105
  v_and_b32 v125, 0xffff0000, v105
  v_add_f32 v118, v118, v124
  v_add_f32 v119, v119, v125
  v_lshlrev_b32 v124, 16, v106
  v_and_b32 v125, 0xffff0000, v106
  v_add_f32 v120, v120, v124
  v_add_f32 v121, v121, v125
  v_lshlrev_b32 v124, 16, v107
  v_and_b32 v125, 0xffff0000, v107
  v_add_f32 v122, v122, v124
  v_add_f32 v123, v123, v125
  s_waitcnt vmcnt(4)
  v_lshlrev_b32 v124, 16, v108
  v_and_b32 v125, 0xffff0000, v108
  v_add_f32 v116, v116, v124
  v_add_f32 v117, v117, v125
  v_lshlrev_b32 v124, 16, v109
  v_and_b32 v125, 0xffff0000, v109
  v_add_f32 v118, v118, v124
  v_add_f32 v119, v119, v125
  v_lshlrev_b32 v124, 16, v110
  v_and_b32 v125, 0xffff0000, v110
  v_add_f32 v120, v120, v124
  v_add_f32 v121, v121, v125
  v_lshlrev_b32 v124, 16, v111
  v_and_b32 v125, 0xffff0000, v111
  v_add_f32 v122, v122, v124
  v_add_f32 v123, v123, v125
  s_waitcnt vmcnt(3)
  v_lshlrev_b32 v124, 16, v112
  v_and_b32 v125, 0xffff0000, v112
  v_add_f32 v116, v116, v124
  v_add_f32 v117, v117, v125
  v_lshlrev_b32 v124, 16, v113
  v_and_b32 v125, 0xffff0000, v113
  v_add_f32 v118, v118, v124
  v_add_f32 v119, v119, v125
  v_lshlrev_b32 v124, 16, v114
  v_and_b32 v125, 0xffff0000, v114
  v_add_f32 v120, v120, v124
  v_add_f32 v121, v121, v125
  v_lshlrev_b32 v124, 16, v115
  v_and_b32 v125, 0xffff0000, v115
  v_add_f32 v122, v122, v124
  v_add_f32 v123, v123, v125
  v_add_f32_dpp v116, v116, v116 row_ror:8 row_mask:0xf bank_mask:0xf
  v_add_f32_dpp v117, v117, v117 row_ror:8 row_mask:0xf bank_mask:0xf
  v_add_f32_dpp v118, v118, v118 row_ror:8 row_mask:0xf bank_mask:0xf
  v_add_f32_dpp v119, v119, v119 row_ror:8 row_mask:0xf bank_mask:0xf
  v_add_f32_dpp v120, v120, v120 row_ror:8 row_mask:0xf bank_mask:0xf
  v_add_f32_dpp v121, v121, v121 row_ror:8 row_mask:0xf bank_mask:0xf
  v_add_f32_dpp v122, v122, v122 row_ror:8 row_mask:0xf bank_mask:0xf
  v_add_f32_dpp v123, v123, v123 row_ror:8 row_mask:0xf bank_mask:0xf
  v_mov_b32 v124, v116
  v_mov_b32 v125, v117
  v_mov_b32 v126, v118
  v_mov_b32 v127, v119
  v_mov_b32 v128, v120
  v_mov_b32 v129, v121
  v_mov_b32 v130, v122
  v_mov_b32 v131, v123
  v_permlane16_swap_b32 v116, v124
  v_permlane16_swap_b32 v117, v125
  v_permlane16_swap_b32 v118, v126
  v_permlane16_swap_b32 v119, v127
  v_permlane16_swap_b32 v120, v128
  v_permlane16_swap_b32 v121, v129
  v_permlane16_swap_b32 v122, v130
  v_permlane16_swap_b32 v123, v131
  v_add_f32 v116, v116, v124
  v_add_f32 v117, v117, v125
  v_add_f32 v118, v118, v126
  v_add_f32 v119, v119, v127
  v_add_f32 v120, v120, v128
  v_add_f32 v121, v121, v129
  v_add_f32 v122, v122, v130
  v_add_f32 v123, v123, v131
  v_mov_b32 v124, v116
  v_mov_b32 v125, v117
  v_mov_b32 v126, v118
  v_mov_b32 v127, v119
  v_mov_b32 v128, v120
  v_mov_b32 v129, v121
  v_mov_b32 v130, v122
  v_mov_b32 v131, v123
  v_permlane32_swap_b32 v116, v124
  v_permlane32_swap_b32 v117, v125
  v_permlane32_swap_b32 v118, v126
  v_permlane32_swap_b32 v119, v127
  v_permlane32_swap_b32 v120, v128
  v_permlane32_swap_b32 v121, v129
  v_permlane32_swap_b32 v122, v130
  v_permlane32_swap_b32 v123, v131
  v_add_f32 v116, v116, v124
  v_add_f32 v117, v117, v125
  v_add_f32 v118, v118, v126
  v_add_f32 v119, v119, v127
  v_add_f32 v120, v120, v128
  v_add_f32 v121, v121, v129
  v_add_f32 v122, v122, v130
  v_add_f32 v123, v123, v131
  s_mul_i32 s52, s2, 205
  s_lshr_b32 s52, s52, 10
  s_mul_i32 s52, s52, 5
  s_sub_u32 s52, s2, s52
  s_mul_i32 s52, s52, 36864
  s_add_u32 s81, s81, s52
  s_mul_i32 s52, s45, 12224
  s_add_u32 s81, s81, s52
  s_mov_b64 exec, 0xff
  buffer_store_dwordx4 v[116:119], v98, s[40:43], s81 offen sc1
  buffer_store_dwordx4 v[120:123], v98, s[40:43], s81 offen offset:16 sc1
  s_mov_b64 exec, -1
  s_mov_b64 exec, -1
  s_lshl_b32 s66, s45, 10
  s_mul_i32 s67, s48, 102400
  s_add_u32 s67, s67, 65536
  s_add_u32 s67, s67, s66
  s_mul_i32 s68, s49, 245760
  s_add_u32 s68, s68, 1048576
  s_add_u32 s68, s68, s66
  s_mul_i32 s69, s48, 245760
  s_add_u32 s69, s69, 5242880
  s_add_u32 s69, s69, s66
  v_add_u32 v25, 128, v25
  s_cmp_lt_u32 s45, 2
  s_cselect_b32 s72, s12, s14
  s_cselect_b32 s73, s13, s15
  s_mov_b32 s74, 1966080
  s_mov_b32 s75, 0x20000
  s_mov_b32 s68, 0
  s_mul_i32 s85, s45, 3072
  s_mul_i32 s52, s48, 5
  s_lshr_b32 s52, s52, 1
  s_lshl_b32 s52, s52, 11
  s_add_u32 s52, s52, s87
  s_mov_b32 exec_lo, 0xffffff
  s_mov_b32 exec_hi, 0x0
  buffer_load_dword v52, v53, s[36:39], s52 offen sc1
  s_mov_b64 exec, -1
  s_lshl_b32 s52, s86, 10
  s_add_u32 s52, s52, 7471104
  s_mov_b32 exec_lo, 0xff
  s_mov_b32 exec_hi, 0x0
  buffer_load_dword v52, v53, s[32:35], s52 offen sc1
  s_mov_b64 exec, -1
  s_add_u32 m0, s66, 0
  s_nop 0
  buffer_load_dwordx4 v1, s[32:35], s67 offen sc1 lds
  s_add_u32 s67, s67, 4096
  s_add_u32 m0, s66, 4096
  s_nop 0
  buffer_load_dwordx4 v1, s[32:35], s67 offen sc1 lds
  s_add_u32 s67, s67, 4096
  s_add_u32 m0, s66, 8192
  s_nop 0
  buffer_load_dwordx4 v1, s[32:35], s67 offen sc1 lds
  s_add_u32 s67, s67, 4096
  s_add_u32 m0, s66, 12288
  s_nop 0
  buffer_load_dwordx4 v1, s[32:35], s67 offen sc1 lds
  s_add_u32 s67, s67, 4096
  s_add_u32 m0, s66, 16384
  s_nop 0
  buffer_load_dwordx4 v1, s[32:35], s67 offen sc1 lds
  s_add_u32 s67, s67, 4096
  s_waitcnt vmcnt(11)
  s_add_u32 m0, s66, 20480
  s_nop 0
  buffer_load_dwordx4 v1, s[32:35], s67 offen sc1 lds
  s_add_u32 s67, s67, 4096
  s_waitcnt vmcnt(11)
  s_add_u32 m0, s66, 24576
  s_nop 0
  buffer_load_dwordx4 v1, s[32:35], s67 offen sc1 lds
  s_add_u32 s67, s67, 4096
  s_waitcnt vmcnt(11)
  s_add_u32 m0, s66, 28672
  s_nop 0
  buffer_load_dwordx4 v1, s[32:35], s67 offen sc1 lds
  s_add_u32 s67, s67, 4096
  s_waitcnt vmcnt(11)
  s_add_u32 m0, s66, 32768
  s_nop 0
  buffer_load_dwordx4 v1, s[32:35], s67 offen sc1 lds
  s_add_u32 s67, s67, 4096
  s_waitcnt vmcnt(11)
  s_add_u32 m0, s66, 36864
  s_nop 0
  buffer_load_dwordx4 v1, s[32:35], s67 offen sc1 lds
  s_add_u32 s67, s67, 4096
  s_waitcnt vmcnt(11)
  s_add_u32 m0, s66, 40960
  s_nop 0
  buffer_load_dwordx4 v1, s[32:35], s67 offen sc1 lds
  s_add_u32 s67, s67, 4096
  s_waitcnt vmcnt(11)
  s_add_u32 m0, s66, 45056
  s_nop 0
  buffer_load_dwordx4 v1, s[32:35], s67 offen sc1 lds
  s_add_u32 s67, s67, 4096
  s_waitcnt vmcnt(11)
  s_add_u32 m0, s66, 49152
  s_nop 0
  buffer_load_dwordx4 v1, s[32:35], s67 offen sc1 lds
  s_add_u32 s67, s67, 4096
  s_waitcnt vmcnt(11)
  s_add_u32 m0, s66, 53248
  s_nop 0
  buffer_load_dwordx4 v1, s[32:35], s67 offen sc1 lds
  s_add_u32 s67, s67, 4096
  s_waitcnt vmcnt(11)
  s_add_u32 m0, s66, 57344
  s_nop 0
  buffer_load_dwordx4 v1, s[32:35], s67 offen sc1 lds
  s_add_u32 s67, s67, 4096
  s_waitcnt vmcnt(11)
  s_add_u32 m0, s66, 61440
  s_nop 0
  buffer_load_dwordx4 v1, s[32:35], s67 offen sc1 lds
  s_add_u32 s67, s67, 4096
  s_waitcnt vmcnt(11)
  s_mov_b64 exec, 1
  ds_add_u32 v29, v30 offset:0
  s_mov_b64 exec, -1
  s_add_u32 m0, s66, 65536
  s_nop 0
  buffer_load_dwordx4 v1, s[32:35], s67 offen sc1 lds
  s_add_u32 s67, s67, 4096
  s_waitcnt vmcnt(11)
  s_add_u32 m0, s66, 69632
  s_nop 0
  buffer_load_dwordx4 v1, s[32:35], s67 offen sc1 lds
  s_add_u32 s67, s67, 4096
  s_waitcnt vmcnt(11)
  s_add_u32 m0, s66, 73728
  s_nop 0
  buffer_load_dwordx4 v1, s[32:35], s67 offen sc1 lds
  s_add_u32 s67, s67, 4096
  s_waitcnt vmcnt(11)
  s_add_u32 m0, s66, 77824
  s_nop 0
  buffer_load_dwordx4 v1, s[32:35], s67 offen sc1 lds
  s_add_u32 s67, s67, 4096
  s_waitcnt vmcnt(11)
  s_add_u32 m0, s66, 81920
  s_nop 0
  buffer_load_dwordx4 v1, s[32:35], s67 offen sc1 lds
  s_add_u32 s67, s67, 4096
  s_waitcnt vmcnt(11)
  s_mov_b64 exec, 1
  ds_add_u32 v29, v30 offset:4
  s_mov_b64 exec, -1
  s_add_u32 m0, s66, 86016
  s_nop 0
  buffer_load_dwordx4 v1, s[32:35], s67 offen sc1 lds
  s_add_u32 s67, s67, 4096
  s_waitcnt vmcnt(11)
  s_add_u32 m0, s66, 90112
  s_nop 0
  buffer_load_dwordx4 v1, s[32:35], s67 offen sc1 lds
  s_add_u32 s67, s67, 4096
  s_waitcnt vmcnt(11)
  s_add_u32 m0, s66, 94208
  s_nop 0
  buffer_load_dwordx4 v1, s[32:35], s67 offen sc1 lds
  s_add_u32 s67, s67, 4096
  s_waitcnt vmcnt(11)
  s_add_u32 m0, s66, 98304
  s_nop 0
  buffer_load_dwordx4 v1, s[32:35], s67 offen sc1 lds
  s_add_u32 s67, s67, 4096
  s_waitcnt vmcnt(10)
  s_mov_b64 exec, 1
  ds_add_u32 v29, v30 offset:8
  s_mov_b64 exec, -1
  s_waitcnt vmcnt(5)
  s_mov_b64 exec, 1
  ds_add_u32 v29, v30 offset:12
  s_mov_b64 exec, -1
  s_waitcnt vmcnt(0)
  s_mov_b64 exec, 1
  ds_add_u32 v29, v30 offset:16
  s_mov_b64 exec, -1
  s_mov_b64 exec, 1
  ds_add_rtn_u32 v27, v29, v30 offset:276
  s_lshl_b32 s52, s46, 10
  s_add_u32 s52, s52, 640
  v_mov_b32 v28, s52
  s_waitcnt lgkmcnt(0)
  v_readfirstlane_b32 s53, v27
  s_cmp_lg_u32 s53, 3
  s_cbranch_scc1 L_pa41
  global_atomic_add v27, v28, v30, s[22:23] sc0 sc1
  s_waitcnt vmcnt(0)
  v_readfirstlane_b32 s53, v27
  s_cmp_lg_u32 s53, 15
  s_cbranch_scc1 L_pa41
  global_atomic_add v54, v30, s[20:21] offset:196 sc1
L_pa41:
  s_mov_b64 exec, -1
  s_add_u32 m0, s85, 102400
  s_nop 0
  buffer_load_dwordx4 v88, s[72:75], s68 offen lds
  s_add_u32 m0, s85, 103424
  s_nop 0
  buffer_load_dwordx4 v89, s[72:75], s68 offen lds
  s_add_u32 m0, s85, 104448
  s_nop 0
  buffer_load_dwordx4 v90, s[72:75], s68 offen lds
  s_add_u32 s68, s68, 98304
  s_waitcnt vmcnt(0)
  s_mov_b64 exec, 1
  ds_add_u32 v29, v30 offset:20
  s_mov_b64 exec, -1
  ds_read_b32 v31, v29 offset:156
  s_waitcnt lgkmcnt(0)
  v_readfirstlane_b32 s56, v31
  s_cmp_ge_u32 s56, 4
  s_cbranch_scc1 L_fl42_ok
  s_mov_b32 s57, 0
L_fl42:
  s_sleep 1
  ds_read_b32 v31, v29 offset:156
  s_waitcnt lgkmcnt(0)
  v_readfirstlane_b32 s56, v31
  s_add_u32 s57, s57, 1
  s_cmp_ge_u32 s56, 4
  s_cbranch_scc1 L_fl42_ok
  s_cmp_lt_u32 s57, 1048576
  s_cbranch_scc1 L_fl42
L_fl42_ok:
  s_add_u32 m0, s85, 0
  s_nop 0
  buffer_load_dwordx4 v88, s[72:75], s68 offen lds
  s_add_u32 m0, s85, 1024
  s_nop 0
  buffer_load_dwordx4 v89, s[72:75], s68 offen lds
  s_add_u32 m0, s85, 2048
  s_nop 0
  buffer_load_dwordx4 v90, s[72:75], s68 offen lds
  s_add_u32 s68, s68, 98304
  s_add_u32 m0, s85, 114688
  s_nop 0
  buffer_load_dwordx4 v88, s[72:75], s68 offen lds
  s_add_u32 m0, s85, 115712
  s_nop 0
  buffer_load_dwordx4 v89, s[72:75], s68 offen lds
  s_add_u32 m0, s85, 116736
  s_nop 0
  buffer_load_dwordx4 v90, s[72:75], s68 offen lds
  s_add_u32 s68, s68, 98304
  s_add_u32 m0, s85, 126976
  s_nop 0
  buffer_load_dwordx4 v88, s[72:75], s68 offen lds
  s_add_u32 m0, s85, 128000
  s_nop 0
  buffer_load_dwordx4 v89, s[72:75], s68 offen lds
  s_add_u32 m0, s85, 129024
  s_nop 0
  buffer_load_dwordx4 v90, s[72:75], s68 offen lds
  s_add_u32 s68, s68, 98304
  s_add_u32 m0, s85, 139264
  s_nop 0
  buffer_load_dwordx4 v88, s[72:75], s68 offen lds
  s_add_u32 m0, s85, 140288
  s_nop 0
  buffer_load_dwordx4 v89, s[72:75], s68 offen lds
  s_add_u32 m0, s85, 141312
  s_nop 0
  buffer_load_dwordx4 v90, s[72:75], s68 offen lds
  s_add_u32 s68, s68, 98304
  s_waitcnt vmcnt(9)
  s_mov_b64 exec, 1
  ds_add_u32 v29, v30 offset:24
  s_mov_b64 exec, -1
  ds_read_b32 v31, v29 offset:164
  s_waitcnt lgkmcnt(0)
  v_readfirstlane_b32 s56, v31
  s_cmp_ge_u32 s56, 4
  s_cbranch_scc1 L_fl43_ok
  s_mov_b32 s57, 0
L_fl43:
  s_sleep 1
  ds_read_b32 v31, v29 offset:164
  s_waitcnt lgkmcnt(0)
  v_readfirstlane_b32 s56, v31
  s_add_u32 s57, s57, 1
  s_cmp_ge_u32 s56, 4
  s_cbranch_scc1 L_fl43_ok
  s_cmp_lt_u32 s57, 1048576
  s_cbranch_scc1 L_fl43
L_fl43_ok:
  s_add_u32 m0, s85, 12288
  s_nop 0
  buffer_load_dwordx4 v88, s[72:75], s68 offen lds
  s_add_u32 m0, s85, 13312
  s_nop 0
  buffer_load_dwordx4 v89, s[72:75], s68 offen lds
  s_add_u32 m0, s85, 14336
  s_nop 0
  buffer_load_dwordx4 v90, s[72:75], s68 offen lds
  s_add_u32 s68, s68, 98304
  s_waitcnt vmcnt(9)
  s_mov_b64 exec, 1
  ds_add_u32 v29, v30 offset:28
  s_mov_b64 exec, -1
  s_waitcnt vmcnt(6)
  s_mov_b64 exec, 1
  ds_add_u32 v29, v30 offset:32
  s_mov_b64 exec, -1
  s_waitcnt vmcnt(3)
  s_mov_b64 exec, 1
  ds_add_u32 v29, v30 offset:36
  s_mov_b64 exec, -1
  s_waitcnt vmcnt(0)
  s_mov_b64 exec, 1
  ds_add_u32 v29, v30 offset:40
  s_mov_b64 exec, -1
  global_load_dword v26, v54, s[20:21] offset:196 sc1
  ds_read_b32 v31, v29 offset:180
  s_waitcnt lgkmcnt(0)
  v_readfirstlane_b32 s56, v31
  s_cmp_ge_u32 s56, 4
  s_cbranch_scc1 L_fl44_ok
  s_mov_b32 s57, 0
L_fl44:
  s_sleep 1
  ds_read_b32 v31, v29 offset:180
  s_waitcnt lgkmcnt(0)
  v_readfirstlane_b32 s56, v31
  s_add_u32 s57, s57, 1
  s_cmp_ge_u32 s56, 4
  s_cbranch_scc1 L_fl44_ok
  s_cmp_lt_u32 s57, 1048576
  s_cbranch_scc1 L_fl44
L_fl44_ok:
  s_add_u32 m0, s85, 24576
  s_nop 0
  buffer_load_dwordx4 v88, s[72:75], s68 offen lds
  s_add_u32 m0, s85, 25600
  s_nop 0
  buffer_load_dwordx4 v89, s[72:75], s68 offen lds
  s_add_u32 m0, s85, 26624
  s_nop 0
  buffer_load_dwordx4 v90, s[72:75], s68 offen lds
  s_add_u32 s68, s68, 98304
  s_add_u32 m0, s85, 36864
  s_nop 0
  buffer_load_dwordx4 v88, s[72:75], s68 offen lds
  s_add_u32 m0, s85, 37888
  s_nop 0
  buffer_load_dwordx4 v89, s[72:75], s68 offen lds
  s_waitcnt vmcnt(5)
  s_add_u32 m0, s85, 38912
  s_nop 0
  buffer_load_dwordx4 v90, s[72:75], s68 offen lds
  s_add_u32 s68, s68, 98304
  s_waitcnt vmcnt(5)
  s_add_u32 m0, s85, 49152
  s_nop 0
  buffer_load_dwordx4 v88, s[72:75], s68 offen lds
  s_waitcnt vmcnt(5)
  s_add_u32 m0, s85, 50176
  s_nop 0
  buffer_load_dwordx4 v89, s[72:75], s68 offen lds
  s_waitcnt vmcnt(5)
  s_mov_b64 exec, 1
  ds_add_u32 v29, v30 offset:44
  s_mov_b64 exec, -1
  s_add_u32 m0, s85, 51200
  s_nop 0
  buffer_load_dwordx4 v90, s[72:75], s68 offen lds
  s_add_u32 s68, s68, 98304
  s_waitcnt vmcnt(5)
  s_add_u32 m0, s85, 61440
  s_nop 0
  buffer_load_dwordx4 v88, s[72:75], s68 offen lds
  s_waitcnt vmcnt(5)
  s_add_u32 m0, s85, 62464
  s_nop 0
  buffer_load_dwordx4 v89, s[72:75], s68 offen lds
  s_waitcnt vmcnt(5)
  s_mov_b64 exec, 1
  ds_add_u32 v29, v30 offset:48
  s_mov_b64 exec, -1
  s_add_u32 m0, s85, 63488
  s_nop 0
  buffer_load_dwordx4 v90, s[72:75], s68 offen lds
  s_add_u32 s68, s68, 98304
  s_waitcnt vmcnt(5)
  s_add_u32 m0, s85, 73728
  s_nop 0
  buffer_load_dwordx4 v88, s[72:75], s68 offen lds
  s_waitcnt vmcnt(5)
  s_add_u32 m0, s85, 74752
  s_nop 0
  buffer_load_dwordx4 v89, s[72:75], s68 offen lds
  s_waitcnt vmcnt(5)
  s_mov_b64 exec, 1
  ds_add_u32 v29, v30 offset:52
  s_mov_b64 exec, -1
  s_add_u32 m0, s85, 75776
  s_nop 0
  buffer_load_dwordx4 v90, s[72:75], s68 offen lds
  s_add_u32 s68, s68, 98304
  s_waitcnt vmcnt(5)
  s_add_u32 m0, s85, 86016
  s_nop 0
  buffer_load_dwordx4 v88, s[72:75], s68 offen lds
  s_waitcnt vmcnt(5)
  s_add_u32 m0, s85, 87040
  s_nop 0
  buffer_load_dwordx4 v89, s[72:75], s68 offen lds
  s_waitcnt vmcnt(5)
  s_mov_b64 exec, 1
  ds_add_u32 v29, v30 offset:56
  s_mov_b64 exec, -1
  s_add_u32 m0, s85, 88064
  s_nop 0
  buffer_load_dwordx4 v90, s[72:75], s68 offen lds
  s_add_u32 s68, s68, 98304
  v_cmp_gt_u32 vcc, 16, v26
  s_mov_b32 s57, 0
  s_cbranch_vccz L_ag45_ok
L_ag45:
  s_sleep 8
  global_load_dword v26, v54, s[20:21] offset:196 sc1
  s_waitcnt vmcnt(0)
  v_cmp_gt_u32 vcc, 16, v26
  s_add_u32 s57, s57, 1
  s_cbranch_vccz L_ag45_ok
  s_cmp_lt_u32 s57, 65536
  s_cbranch_scc1 L_ag45
L_ag45_ok:
  v_cmp_le_u32 vcc, 24, v0
  v_mov_b32 v20, 0
  v_mov_b32 v21, 5760
  v_cndmask_b32 v20, v20, v21, vcc
  v_add_u32 v20, v20, v1
  v_add_u32 v19, 162688, v1
  s_mul_i32 s52, s49, 384
  s_mul_i32 s53, s45, 61440
  s_add_u32 s52, s52, s53
  s_add_u32 s52, s52, 8388608
  s_mov_b32 exec_hi, 0xffff
  buffer_load_dwordx4 v[100:103], v20, s[32:35], s52 offen sc1
  s_add_u32 s52, s52, 12288
  buffer_load_dwordx4 v[104:107], v20, s[32:35], s52 offen sc1
  s_add_u32 s52, s52, 12288
  buffer_load_dwordx4 v[108:111], v20, s[32:35], s52 offen sc1
  s_add_u32 s52, s52, 12288
  buffer_load_dwordx4 v[112:115], v20, s[32:35], s52 offen sc1
  s_add_u32 s52, s52, 12288
  buffer_load_dwordx4 v[116:119], v20, s[32:35], s52 offen sc1
  s_mov_b32 exec_hi, -1
  ds_read_b32 v31, v29 offset:184
  s_waitcnt lgkmcnt(0)
  v_readfirstlane_b32 s56, v31
  s_cmp_ge_u32 s56, 4
  s_cbranch_scc1 L_fl46_ok
  s_mov_b32 s57, 0
L_fl46:
  s_sleep 1
  ds_read_b32 v31, v29 offset:184
  s_waitcnt lgkmcnt(0)
  v_readfirstlane_b32 s56, v31
  s_add_u32 s57, s57, 1
  s_cmp_ge_u32 s56, 4
  s_cbranch_scc1 L_fl46_ok
  s_cmp_lt_u32 s57, 1048576
  s_cbranch_scc1 L_fl46
L_fl46_ok:
  s_waitcnt vmcnt(5)
  s_mov_b64 exec, 1
  ds_add_u32 v29, v30 offset:60
  s_mov_b64 exec, -1
  s_mov_b64 exec, 1
  ds_add_u32 v29, v30 offset:64
  s_mov_b64 exec, -1
  s_add_u32 m0, s85, 0
  s_nop 0
  buffer_load_dwordx4 v88, s[72:75], s68 offen lds
  s_waitcnt vmcnt(5)
  s_add_u32 m0, s85, 1024
  s_nop 0
  buffer_load_dwordx4 v89, s[72:75], s68 offen lds
  s_waitcnt vmcnt(5)
  s_add_u32 m0, s85, 2048
  s_nop 0
  buffer_load_dwordx4 v90, s[72:75], s68 offen lds
  s_add_u32 s68, s68, 98304
  s_waitcnt vmcnt(5)
  s_add_u32 m0, s85, 98304
  s_nop 0
  buffer_load_dwordx4 v88, s[72:75], s68 offen lds
  s_waitcnt vmcnt(5)
  s_add_u32 m0, s85, 99328
  s_nop 0
  buffer_load_dwordx4 v89, s[72:75], s68 offen lds
  s_waitcnt vmcnt(5)
  s_add_u32 m0, s85, 100352
  s_nop 0
  buffer_load_dwordx4 v90, s[72:75], s68 offen lds
  s_add_u32 s68, s68, 98304
  ds_read_b32 v31, v29 offset:188
  s_waitcnt lgkmcnt(0)
  v_readfirstlane_b32 s56, v31
  s_cmp_ge_u32 s56, 4
  s_cbranch_scc1 L_fl47_ok
  s_mov_b32 s57, 0
L_fl47:
  s_sleep 1
  ds_read_b32 v31, v29 offset:188
  s_waitcnt lgkmcnt(0)
  v_readfirstlane_b32 s56, v31
  s_add_u32 s57, s57, 1
  s_cmp_ge_u32 s56, 4
  s_cbranch_scc1 L_fl47_ok
  s_cmp_lt_u32 s57, 1048576
  s_cbranch_scc1 L_fl47
L_fl47_ok:
  s_waitcnt vmcnt(5)
  s_add_u32 m0, s85, 110592
  s_nop 0
  buffer_load_dwordx4 v88, s[72:75], s68 offen lds
  s_waitcnt vmcnt(5)
  s_add_u32 m0, s85, 111616
  s_nop 0
  buffer_load_dwordx4 v89, s[72:75], s68 offen lds
  s_waitcnt vmcnt(5)
  s_mov_b64 exec, 1
  ds_add_u32 v29, v30 offset:68
  s_mov_b64 exec, -1
  s_add_u32 m0, s85, 112640
  s_nop 0
  buffer_load_dwordx4 v90, s[72:75], s68 offen lds
  s_add_u32 s68, s68, 98304
  s_waitcnt vmcnt(5)
  s_add_u32 m0, s85, 122880
  s_nop 0
  buffer_load_dwordx4 v88, s[72:75], s68 offen lds
  s_waitcnt vmcnt(5)
  s_add_u32 m0, s85, 123904
  s_nop 0
  buffer_load_dwordx4 v89, s[72:75], s68 offen lds
  s_waitcnt vmcnt(5)
  s_mov_b64 exec, 1
  ds_add_u32 v29, v30 offset:72
  s_mov_b64 exec, -1
  s_add_u32 m0, s85, 124928
  s_nop 0
  buffer_load_dwordx4 v90, s[72:75], s68 offen lds
  s_add_u32 s68, s68, 98304
  v_add_f32 v100, v100, v104
  v_add_f32 v101, v101, v105
  v_add_f32 v102, v102, v106
  v_add_f32 v103, v103, v107
  v_add_f32 v100, v100, v108
  v_add_f32 v101, v101, v109
  v_add_f32 v102, v102, v110
  v_add_f32 v103, v103, v111
  v_add_f32 v100, v100, v112
  v_add_f32 v101, v101, v113
  v_add_f32 v102, v102, v114
  v_add_f32 v103, v103, v115
  v_add_f32 v100, v100, v116
  v_add_f32 v101, v101, v117
  v_add_f32 v102, v102, v118
  v_add_f32 v103, v103, v119
  s_mul_i32 s52, s45, 768
  v_add_u32 v21, 158720, v1
  v_add_u32 v20, s52, v21
  s_mov_b32 exec_hi, 0xffff
  ds_write_b128 v20, v[100:103]
  s_mov_b32 exec_hi, -1
  s_mov_b64 exec, 1
  ds_add_u32 v29, v30 offset:316
  s_mov_b64 exec, -1
  ds_read_b32 v31, v29 offset:316
  s_waitcnt lgkmcnt(0)
  v_readfirstlane_b32 s56, v31
  s_cmp_ge_u32 s56, 4
  s_cbranch_scc1 L_fl48_ok
  s_mov_b32 s57, 0
L_fl48:
  ds_read_b32 v31, v29 offset:316
  s_waitcnt lgkmcnt(0)
  v_readfirstlane_b32 s56, v31
  s_add_u32 s57, s57, 1
  s_cmp_ge_u32 s56, 4
  s_cbranch_scc1 L_fl48_ok
  s_cmp_lt_u32 s57, 1048576
  s_cbranch_scc1 L_fl48
L_fl48_ok:
  ds_read_b128 v[104:107], v21 offset:0
  ds_read_b128 v[108:111], v21 offset:768
  ds_read_b128 v[112:115], v21 offset:1536
  ds_read_b128 v[116:119], v21 offset:2304
  s_waitcnt lgkmcnt(0)
  v_add_f32 v104, v104, v108
  v_add_f32 v112, v112, v116
  v_add_f32 v104, v104, v112
  v_add_f32 v105, v105, v109
  v_add_f32 v113, v113, v117
  v_add_f32 v105, v105, v113
  v_add_f32 v106, v106, v110
  v_add_f32 v114, v114, v118
  v_add_f32 v106, v106, v114
  v_add_f32 v107, v107, v111
  v_add_f32 v115, v115, v119
  v_add_f32 v107, v107, v115
  s_mov_b32 exec_hi, 0xffff
  ds_write_b128 v19, v[104:107]
  s_mov_b32 exec_hi, -1
  s_mov_b64 exec, 1
  ds_add_u32 v29, v30 offset:272
  s_mov_b64 exec, -1
  ds_read_b32 v31, v29 offset:192
  s_waitcnt lgkmcnt(0)
  v_readfirstlane_b32 s56, v31
  s_cmp_ge_u32 s56, 4
  s_cbranch_scc1 L_fl49_ok
  s_mov_b32 s57, 0
L_fl49:
  s_sleep 1
  ds_read_b32 v31, v29 offset:192
  s_waitcnt lgkmcnt(0)
  v_readfirstlane_b32 s56, v31
  s_add_u32 s57, s57, 1
  s_cmp_ge_u32 s56, 4
  s_cbranch_scc1 L_fl49_ok
  s_cmp_lt_u32 s57, 1048576
  s_cbranch_scc1 L_fl49
L_fl49_ok:
  s_waitcnt vmcnt(5)
  s_add_u32 m0, s85, 12288
  s_nop 0
  buffer_load_dwordx4 v88, s[72:75], s68 offen lds
  s_waitcnt vmcnt(5)
  s_add_u32 m0, s85, 13312
  s_nop 0
  buffer_load_dwordx4 v89, s[72:75], s68 offen lds
  s_waitcnt vmcnt(5)
  s_mov_b64 exec, 1
  ds_add_u32 v29, v30 offset:76
  s_mov_b64 exec, -1
  s_add_u32 m0, s85, 14336
  s_nop 0
  buffer_load_dwordx4 v90, s[72:75], s68 offen lds
  s_add_u32 s68, s68, 98304
  s_waitcnt vmcnt(5)
  s_add_u32 m0, s85, 135168
  s_nop 0
  buffer_load_dwordx4 v88, s[72:75], s68 offen lds
  s_waitcnt vmcnt(5)
  s_add_u32 m0, s85, 136192
  s_nop 0
  buffer_load_dwordx4 v89, s[72:75], s68 offen lds
  s_waitcnt vmcnt(5)
  s_mov_b64 exec, 1
  ds_add_u32 v29, v30 offset:80
  s_mov_b64 exec, -1
  s_add_u32 m0, s85, 137216
  s_nop 0
  buffer_load_dwordx4 v90, s[72:75], s68 offen lds
  s_add_u32 s68, s68, 98304
  ds_read_b32 v31, v29 offset:196
  s_waitcnt lgkmcnt(0)
  v_readfirstlane_b32 s56, v31
  s_cmp_ge_u32 s56, 4
  s_cbranch_scc1 L_fl50_ok
  s_mov_b32 s57, 0
L_fl50:
  s_sleep 1
  ds_read_b32 v31, v29 offset:196
  s_waitcnt lgkmcnt(0)
  v_readfirstlane_b32 s56, v31
  s_add_u32 s57, s57, 1
  s_cmp_ge_u32 s56, 4
  s_cbranch_scc1 L_fl50_ok
  s_cmp_lt_u32 s57, 1048576
  s_cbranch_scc1 L_fl50
L_fl50_ok:
  s_waitcnt vmcnt(5)
  s_add_u32 m0, s85, 24576
  s_nop 0
  buffer_load_dwordx4 v88, s[72:75], s68 offen lds
  s_waitcnt vmcnt(5)
  s_add_u32 m0, s85, 25600
  s_nop 0
  buffer_load_dwordx4 v89, s[72:75], s68 offen lds
  s_waitcnt vmcnt(5)
  s_mov_b64 exec, 1
  ds_add_u32 v29, v30 offset:84
  s_mov_b64 exec, -1
  s_add_u32 m0, s85, 26624
  s_nop 0
  buffer_load_dwordx4 v90, s[72:75], s68 offen lds
  s_add_u32 s68, s68, 98304
  s_waitcnt vmcnt(5)
  s_add_u32 m0, s85, 36864
  s_nop 0
  buffer_load_dwordx4 v88, s[72:75], s68 offen lds
  s_waitcnt vmcnt(5)
  s_add_u32 m0, s85, 37888
  s_nop 0
  buffer_load_dwordx4 v89, s[72:75], s68 offen lds
  s_waitcnt vmcnt(5)
  s_mov_b64 exec, 1
  ds_add_u32 v29, v30 offset:88
  s_mov_b64 exec, -1
  s_add_u32 m0, s85, 38912
  s_nop 0
  buffer_load_dwordx4 v90, s[72:75], s68 offen lds
  s_add_u32 s68, s68, 98304
  s_waitcnt vmcnt(3)
  s_mov_b64 exec, 1
  ds_add_u32 v29, v30 offset:92
  s_mov_b64 exec, -1
  s_waitcnt vmcnt(0)
  s_mov_b64 exec, 1
  ds_add_u32 v29, v30 offset:96
  s_mov_b64 exec, -1
  ds_read_b32 v31, v29 offset:204
  s_waitcnt lgkmcnt(0)
  v_readfirstlane_b32 s56, v31
  s_cmp_ge_u32 s56, 4
  s_cbranch_scc1 L_fl51_ok
  s_mov_b32 s57, 0
L_fl51:
  s_sleep 1
  ds_read_b32 v31, v29 offset:204
  s_waitcnt lgkmcnt(0)
  v_readfirstlane_b32 s56, v31
  s_add_u32 s57, s57, 1
  s_cmp_ge_u32 s56, 4
  s_cbranch_scc1 L_fl51_ok
  s_cmp_lt_u32 s57, 1048576
  s_cbranch_scc1 L_fl51
L_fl51_ok:
  s_add_u32 m0, s66, 49152
  s_nop 0
  buffer_load_dwordx4 v1, s[32:35], s69 offen sc1 lds
  s_add_u32 s69, s69, 4096
  s_add_u32 m0, s66, 53248
  s_nop 0
  buffer_load_dwordx4 v1, s[32:35], s69 offen sc1 lds
  s_add_u32 s69, s69, 4096
  s_add_u32 m0, s66, 57344
  s_nop 0
  buffer_load_dwordx4 v1, s[32:35], s69 offen sc1 lds
  s_add_u32 s69, s69, 4096
  s_add_u32 m0, s66, 61440
  s_nop 0
  buffer_load_dwordx4 v1, s[32:35], s69 offen sc1 lds
  s_add_u32 s69, s69, 4096
  s_add_u32 m0, s66, 65536
  s_nop 0
  buffer_load_dwordx4 v1, s[32:35], s69 offen sc1 lds
  s_add_u32 s69, s69, 4096
  s_add_u32 m0, s66, 69632
  s_nop 0
  buffer_load_dwordx4 v1, s[32:35], s69 offen sc1 lds
  s_add_u32 s69, s69, 4096
  s_waitcnt vmcnt(5)
  s_add_u32 m0, s66, 73728
  s_nop 0
  buffer_load_dwordx4 v1, s[32:35], s69 offen sc1 lds
  s_add_u32 s69, s69, 4096
  s_waitcnt vmcnt(5)
  s_add_u32 m0, s66, 77824
  s_nop 0
  buffer_load_dwordx4 v1, s[32:35], s69 offen sc1 lds
  s_add_u32 s69, s69, 4096
  s_waitcnt vmcnt(5)
  s_add_u32 m0, s66, 81920
  s_nop 0
  buffer_load_dwordx4 v1, s[32:35], s69 offen sc1 lds
  s_add_u32 s69, s69, 4096
  s_waitcnt vmcnt(5)
  s_add_u32 m0, s66, 86016
  s_nop 0
  buffer_load_dwordx4 v1, s[32:35], s69 offen sc1 lds
  s_add_u32 s69, s69, 4096
  ds_read_b32 v31, v29 offset:208
  s_waitcnt lgkmcnt(0)
  v_readfirstlane_b32 s56, v31
  s_cmp_ge_u32 s56, 4
  s_cbranch_scc1 L_fl52_ok
  s_mov_b32 s57, 0
L_fl52:
  s_sleep 1
  ds_read_b32 v31, v29 offset:208
  s_waitcnt lgkmcnt(0)
  v_readfirstlane_b32 s56, v31
  s_add_u32 s57, s57, 1
  s_cmp_ge_u32 s56, 4
  s_cbranch_scc1 L_fl52_ok
  s_cmp_lt_u32 s57, 1048576
  s_cbranch_scc1 L_fl52
L_fl52_ok:
  s_add_u32 m0, s66, 90112
  s_nop 0
  buffer_load_dwordx4 v1, s[32:35], s69 offen sc1 lds
  s_add_u32 s69, s69, 4096
  s_add_u32 m0, s66, 94208
  s_nop 0
  buffer_load_dwordx4 v1, s[32:35], s69 offen sc1 lds
  s_add_u32 s69, s69, 4096
  s_add_u32 m0, s66, 98304
  s_nop 0
  buffer_load_dwordx4 v1, s[32:35], s69 offen sc1 lds
  s_add_u32 s69, s69, 4096
  s_add_u32 m0, s66, 102400
  s_nop 0
  buffer_load_dwordx4 v1, s[32:35], s69 offen sc1 lds
  s_add_u32 s69, s69, 4096
  s_add_u32 m0, s66, 106496
  s_nop 0
  buffer_load_dwordx4 v1, s[32:35], s69 offen sc1 lds
  s_add_u32 s69, s69, 4096
  ds_read_b32 v31, v29 offset:212
  s_waitcnt lgkmcnt(0)
  v_readfirstlane_b32 s56, v31
  s_cmp_ge_u32 s56, 4
  s_cbranch_scc1 L_fl53_ok
  s_mov_b32 s57, 0
L_fl53:
  s_sleep 1
  ds_read_b32 v31, v29 offset:212
  s_waitcnt lgkmcnt(0)
  v_readfirstlane_b32 s56, v31
  s_add_u32 s57, s57, 1
  s_cmp_ge_u32 s56, 4
  s_cbranch_scc1 L_fl53_ok
  s_cmp_lt_u32 s57, 1048576
  s_cbranch_scc1 L_fl53
L_fl53_ok:
  s_add_u32 m0, s66, 110592
  s_nop 0
  buffer_load_dwordx4 v1, s[32:35], s69 offen sc1 lds
  s_add_u32 s69, s69, 4096
  s_waitcnt vmcnt(11)
  s_mov_b64 exec, 1
  ds_add_u32 v29, v30 offset:100
  s_mov_b64 exec, -1
  s_add_u32 m0, s66, 114688
  s_nop 0
  buffer_load_dwordx4 v1, s[32:35], s69 offen sc1 lds
  s_add_u32 s69, s69, 4096
  s_waitcnt vmcnt(11)
  s_add_u32 m0, s66, 118784
  s_nop 0
  buffer_load_dwordx4 v1, s[32:35], s69 offen sc1 lds
  s_add_u32 s69, s69, 4096
  s_waitcnt vmcnt(11)
  s_add_u32 m0, s66, 122880
  s_nop 0
  buffer_load_dwordx4 v1, s[32:35], s69 offen sc1 lds
  s_add_u32 s69, s69, 4096
  s_waitcnt vmcnt(11)
  s_add_u32 m0, s66, 126976
  s_nop 0
  buffer_load_dwordx4 v1, s[32:35], s69 offen sc1 lds
  s_add_u32 s69, s69, 4096
  ds_read_b32 v31, v29 offset:216
  s_waitcnt lgkmcnt(0)
  v_readfirstlane_b32 s56, v31
  s_cmp_ge_u32 s56, 4
  s_cbranch_scc1 L_fl54_ok
  s_mov_b32 s57, 0
L_fl54:
  s_sleep 1
  ds_read_b32 v31, v29 offset:216
  s_waitcnt lgkmcnt(0)
  v_readfirstlane_b32 s56, v31
  s_add_u32 s57, s57, 1
  s_cmp_ge_u32 s56, 4
  s_cbranch_scc1 L_fl54_ok
  s_cmp_lt_u32 s57, 1048576
  s_cbranch_scc1 L_fl54
L_fl54_ok:
  s_waitcnt vmcnt(11)
  s_add_u32 m0, s66, 0
  s_nop 0
  buffer_load_dwordx4 v1, s[32:35], s69 offen sc1 lds
  s_add_u32 s69, s69, 4096
  s_waitcnt vmcnt(11)
  s_mov_b64 exec, 1
  ds_add_u32 v29, v30 offset:104
  s_mov_b64 exec, -1
  s_add_u32 m0, s66, 4096
  s_nop 0
  buffer_load_dwordx4 v1, s[32:35], s69 offen sc1 lds
  s_add_u32 s69, s69, 4096
  s_waitcnt vmcnt(11)
  s_add_u32 m0, s66, 8192
  s_nop 0
  buffer_load_dwordx4 v1, s[32:35], s69 offen sc1 lds
  s_add_u32 s69, s69, 4096
  s_waitcnt vmcnt(11)
  s_add_u32 m0, s66, 12288
  s_nop 0
  buffer_load_dwordx4 v1, s[32:35], s69 offen sc1 lds
  s_add_u32 s69, s69, 4096
  s_waitcnt vmcnt(11)
  s_add_u32 m0, s66, 16384
  s_nop 0
  buffer_load_dwordx4 v1, s[32:35], s69 offen sc1 lds
  s_add_u32 s69, s69, 4096
  s_waitcnt vmcnt(11)
  s_add_u32 m0, s66, 131072
  s_nop 0
  buffer_load_dwordx4 v1, s[32:35], s69 offen sc1 lds
  s_add_u32 s69, s69, 4096
  s_waitcnt vmcnt(11)
  s_mov_b64 exec, 1
  ds_add_u32 v29, v30 offset:108
  s_mov_b64 exec, -1
  s_add_u32 m0, s66, 135168
  s_nop 0
  buffer_load_dwordx4 v1, s[32:35], s69 offen sc1 lds
  s_add_u32 s69, s69, 4096
  s_waitcnt vmcnt(11)
  s_add_u32 m0, s66, 139264
  s_nop 0
  buffer_load_dwordx4 v1, s[32:35], s69 offen sc1 lds
  s_add_u32 s69, s69, 4096
  s_waitcnt vmcnt(11)
  s_add_u32 m0, s66, 143360
  s_nop 0
  buffer_load_dwordx4 v1, s[32:35], s69 offen sc1 lds
  s_add_u32 s69, s69, 4096
  s_waitcnt vmcnt(11)
  s_add_u32 m0, s66, 147456
  s_nop 0
  buffer_load_dwordx4 v1, s[32:35], s69 offen sc1 lds
  s_add_u32 s69, s69, 4096
  ds_read_b32 v31, v29 offset:220
  s_waitcnt lgkmcnt(0)
  v_readfirstlane_b32 s56, v31
  s_cmp_ge_u32 s56, 4
  s_cbranch_scc1 L_fl55_ok
  s_mov_b32 s57, 0
L_fl55:
  s_sleep 1
  ds_read_b32 v31, v29 offset:220
  s_waitcnt lgkmcnt(0)
  v_readfirstlane_b32 s56, v31
  s_add_u32 s57, s57, 1
  s_cmp_ge_u32 s56, 4
  s_cbranch_scc1 L_fl55_ok
  s_cmp_lt_u32 s57, 1048576
  s_cbranch_scc1 L_fl55
L_fl55_ok:
  s_waitcnt vmcnt(11)
  s_add_u32 m0, s66, 20480
  s_nop 0
  buffer_load_dwordx4 v1, s[32:35], s69 offen sc1 lds
  s_add_u32 s69, s69, 4096
  s_waitcnt vmcnt(11)
  s_mov_b64 exec, 1
  ds_add_u32 v29, v30 offset:112
  s_mov_b64 exec, -1
  s_add_u32 m0, s66, 24576
  s_nop 0
  buffer_load_dwordx4 v1, s[32:35], s69 offen sc1 lds
  s_add_u32 s69, s69, 4096
  s_waitcnt vmcnt(11)
  s_add_u32 m0, s66, 28672
  s_nop 0
  buffer_load_dwordx4 v1, s[32:35], s69 offen sc1 lds
  s_add_u32 s69, s69, 4096
  s_waitcnt vmcnt(11)
  s_add_u32 m0, s66, 32768
  s_nop 0
  buffer_load_dwordx4 v1, s[32:35], s69 offen sc1 lds
  s_add_u32 s69, s69, 4096
  s_waitcnt vmcnt(11)
  s_add_u32 m0, s66, 36864
  s_nop 0
  buffer_load_dwordx4 v1, s[32:35], s69 offen sc1 lds
  s_add_u32 s69, s69, 4096
  s_waitcnt vmcnt(10)
  s_mov_b64 exec, 1
  ds_add_u32 v29, v30 offset:116
  s_mov_b64 exec, -1
  s_waitcnt vmcnt(5)
  s_mov_b64 exec, 1
  ds_add_u32 v29, v30 offset:120
  s_mov_b64 exec, -1
  s_waitcnt vmcnt(0)
  s_mov_b64 exec, 1
  ds_add_u32 v29, v30 offset:124
  s_mov_b64 exec, -1
  ds_read_b32 v31, v29 offset:228
  s_waitcnt lgkmcnt(0)
  v_readfirstlane_b32 s56, v31
  s_cmp_ge_u32 s56, 4
  s_cbranch_scc1 L_fl56_ok
  s_mov_b32 s57, 0
L_fl56:
  s_sleep 1
  ds_read_b32 v31, v29 offset:228
  s_waitcnt lgkmcnt(0)
  v_readfirstlane_b32 s56, v31
  s_add_u32 s57, s57, 1
  s_cmp_ge_u32 s56, 4
  s_cbranch_scc1 L_fl56_ok
  s_cmp_lt_u32 s57, 1048576
  s_cbranch_scc1 L_fl56
L_fl56_ok:
  s_add_u32 m0, s66, 40960
  s_nop 0
  buffer_load_dwordx4 v1, s[32:35], s69 offen sc1 lds
  s_add_u32 s69, s69, 4096
  s_add_u32 m0, s66, 45056
  s_nop 0
  buffer_load_dwordx4 v1, s[32:35], s69 offen sc1 lds
  s_add_u32 s69, s69, 4096
  s_add_u32 m0, s66, 49152
  s_nop 0
  buffer_load_dwordx4 v1, s[32:35], s69 offen sc1 lds
  s_add_u32 s69, s69, 4096
  s_add_u32 m0, s66, 53248
  s_nop 0
  buffer_load_dwordx4 v1, s[32:35], s69 offen sc1 lds
  s_add_u32 s69, s69, 4096
  s_add_u32 m0, s66, 57344
  s_nop 0
  buffer_load_dwordx4 v1, s[32:35], s69 offen sc1 lds
  s_add_u32 s69, s69, 4096
  ds_read_b32 v31, v29 offset:232
  s_waitcnt lgkmcnt(0)
  v_readfirstlane_b32 s56, v31
  s_cmp_ge_u32 s56, 4
  s_cbranch_scc1 L_fl57_ok
  s_mov_b32 s57, 0
L_fl57:
  s_sleep 1
  ds_read_b32 v31, v29 offset:232
  s_waitcnt lgkmcnt(0)
  v_readfirstlane_b32 s56, v31
  s_add_u32 s57, s57, 1
  s_cmp_ge_u32 s56, 4
  s_cbranch_scc1 L_fl57_ok
  s_cmp_lt_u32 s57, 1048576
  s_cbranch_scc1 L_fl57
L_fl57_ok:
  s_add_u32 m0, s66, 61440
  s_nop 0
  buffer_load_dwordx4 v1, s[32:35], s69 offen sc1 lds
  s_add_u32 s69, s69, 4096
  s_add_u32 m0, s66, 65536
  s_nop 0
  buffer_load_dwordx4 v1, s[32:35], s69 offen sc1 lds
  s_add_u32 s69, s69, 4096
  s_add_u32 m0, s66, 69632
  s_nop 0
  buffer_load_dwordx4 v1, s[32:35], s69 offen sc1 lds
  s_add_u32 s69, s69, 4096
  s_add_u32 m0, s66, 73728
  s_nop 0
  buffer_load_dwordx4 v1, s[32:35], s69 offen sc1 lds
  s_add_u32 s69, s69, 4096
  s_add_u32 m0, s66, 77824
  s_nop 0
  buffer_load_dwordx4 v1, s[32:35], s69 offen sc1 lds
  s_add_u32 s69, s69, 4096
  ds_read_b32 v31, v29 offset:236
  s_waitcnt lgkmcnt(0)
  v_readfirstlane_b32 s56, v31
  s_cmp_ge_u32 s56, 4
  s_cbranch_scc1 L_fl58_ok
  s_mov_b32 s57, 0
L_fl58:
  s_sleep 1
  ds_read_b32 v31, v29 offset:236
  s_waitcnt lgkmcnt(0)
  v_readfirstlane_b32 s56, v31
  s_add_u32 s57, s57, 1
  s_cmp_ge_u32 s56, 4
  s_cbranch_scc1 L_fl58_ok
  s_cmp_lt_u32 s57, 1048576
  s_cbranch_scc1 L_fl58
L_fl58_ok:
  s_add_u32 m0, s66, 81920
  s_nop 0
  buffer_load_dwordx4 v1, s[32:35], s69 offen sc1 lds
  s_add_u32 s69, s69, 4096
  s_add_u32 m0, s66, 86016
  s_nop 0
  buffer_load_dwordx4 v1, s[32:35], s69 offen sc1 lds
  s_add_u32 s69, s69, 4096
  s_waitcnt vmcnt(11)
  s_add_u32 m0, s66, 90112
  s_nop 0
  buffer_load_dwordx4 v1, s[32:35], s69 offen sc1 lds
  s_add_u32 s69, s69, 4096
  s_waitcnt vmcnt(11)
  s_add_u32 m0, s66, 94208
  s_nop 0
  buffer_load_dwordx4 v1, s[32:35], s69 offen sc1 lds
  s_add_u32 s69, s69, 4096
  s_waitcnt vmcnt(11)
  s_add_u32 m0, s66, 98304
  s_nop 0
  buffer_load_dwordx4 v1, s[32:35], s69 offen sc1 lds
  s_add_u32 s69, s69, 4096
  ds_read_b32 v31, v29 offset:240
  s_waitcnt lgkmcnt(0)
  v_readfirstlane_b32 s56, v31
  s_cmp_ge_u32 s56, 4
  s_cbranch_scc1 L_fl59_ok
  s_mov_b32 s57, 0
L_fl59:
  s_sleep 1
  ds_read_b32 v31, v29 offset:240
  s_waitcnt lgkmcnt(0)
  v_readfirstlane_b32 s56, v31
  s_add_u32 s57, s57, 1
  s_cmp_ge_u32 s56, 4
  s_cbranch_scc1 L_fl59_ok
  s_cmp_lt_u32 s57, 1048576
  s_cbranch_scc1 L_fl59
L_fl59_ok:
  s_waitcnt vmcnt(11)
  s_add_u32 m0, s66, 102400
  s_nop 0
  buffer_load_dwordx4 v1, s[32:35], s69 offen sc1 lds
  s_add_u32 s69, s69, 4096
  s_waitcnt vmcnt(11)
  s_mov_b64 exec, 1
  ds_add_u32 v29, v30 offset:128
  s_mov_b64 exec, -1
  s_add_u32 m0, s66, 106496
  s_nop 0
  buffer_load_dwordx4 v1, s[32:35], s69 offen sc1 lds
  s_add_u32 s69, s69, 4096
  s_waitcnt vmcnt(11)
  s_add_u32 m0, s66, 110592
  s_nop 0
  buffer_load_dwordx4 v1, s[32:35], s69 offen sc1 lds
  s_add_u32 s69, s69, 4096
  s_waitcnt vmcnt(11)
  s_add_u32 m0, s66, 114688
  s_nop 0
  buffer_load_dwordx4 v1, s[32:35], s69 offen sc1 lds
  s_add_u32 s69, s69, 4096
  s_waitcnt vmcnt(11)
  s_add_u32 m0, s66, 118784
  s_nop 0
  buffer_load_dwordx4 v1, s[32:35], s69 offen sc1 lds
  s_add_u32 s69, s69, 4096
  ds_read_b32 v31, v29 offset:244
  s_waitcnt lgkmcnt(0)
  v_readfirstlane_b32 s56, v31
  s_cmp_ge_u32 s56, 4
  s_cbranch_scc1 L_fl60_ok
  s_mov_b32 s57, 0
L_fl60:
  s_sleep 1
  ds_read_b32 v31, v29 offset:244
  s_waitcnt lgkmcnt(0)
  v_readfirstlane_b32 s56, v31
  s_add_u32 s57, s57, 1
  s_cmp_ge_u32 s56, 4
  s_cbranch_scc1 L_fl60_ok
  s_cmp_lt_u32 s57, 1048576
  s_cbranch_scc1 L_fl60
L_fl60_ok:
  s_waitcnt vmcnt(11)
  s_add_u32 m0, s66, 0
  s_nop 0
  buffer_load_dwordx4 v1, s[32:35], s69 offen sc1 lds
  s_add_u32 s69, s69, 4096
  s_waitcnt vmcnt(11)
  s_mov_b64 exec, 1
  ds_add_u32 v29, v30 offset:132
  s_mov_b64 exec, -1
  s_add_u32 m0, s66, 4096
  s_nop 0
  buffer_load_dwordx4 v1, s[32:35], s69 offen sc1 lds
  s_add_u32 s69, s69, 4096
  s_waitcnt vmcnt(11)
  s_add_u32 m0, s66, 8192
  s_nop 0
  buffer_load_dwordx4 v1, s[32:35], s69 offen sc1 lds
  s_add_u32 s69, s69, 4096
  s_waitcnt vmcnt(11)
  s_add_u32 m0, s66, 12288
  s_nop 0
  buffer_load_dwordx4 v1, s[32:35], s69 offen sc1 lds
  s_add_u32 s69, s69, 4096
  s_waitcnt vmcnt(11)
  s_add_u32 m0, s66, 16384
  s_nop 0
  buffer_load_dwordx4 v1, s[32:35], s69 offen sc1 lds
  s_add_u32 s69, s69, 4096
  s_waitcnt vmcnt(10)
  s_mov_b64 exec, 1
  ds_add_u32 v29, v30 offset:136
  s_mov_b64 exec, -1
  s_waitcnt vmcnt(5)
  s_mov_b64 exec, 1
  ds_add_u32 v29, v30 offset:140
  s_mov_b64 exec, -1
  s_waitcnt vmcnt(0)
  s_mov_b64 exec, 1
  ds_add_u32 v29, v30 offset:144
  s_mov_b64 exec, -1
  s_branch L_fin
L_crest:
  s_add_u32 s52, s49, s45
  s_cmp_lg_u32 s52, 0
  s_cselect_b32 s69, 0, 1
  s_cbranch_scc1 L_noinit
  v_mov_b32 v204, 0
  v_mov_b32 v205, 0
  v_mov_b32 v206, 0
  v_mov_b32 v207, 0
  s_lshl_b32 s52, s46, 10
  buffer_store_dwordx4 v[204:207], v1, s[32:35], s52 offen sc1
  s_add_u32 s52, s52, 0x8000
  buffer_store_dwordx4 v[204:207], v1, s[32:35], s52 offen sc1
L_noinit:
  s_cmp_ge_u32 s2, 200
  s_cbranch_scc1 L_nowo1
  v_lshrrev_b32 v6, 1, v0
  v_and_b32 v7, 1, v0
  v_lshlrev_b32 v7, 4, v7
  v_mul_u32_u24 v9, 1280, v6
  v_add_u32 v9, v9, v7
  s_mul_i32 s60, s2, 205
  s_lshr_b32 s60, s60, 11
  s_mul_i32 s61, s60, 10
  s_sub_u32 s61, s2, s61
  s_mov_b32 s40, s8
  s_mov_b32 s41, s9
  s_mov_b32 s42, 819200
  s_mul_i32 s56, s60, 40960
  s_lshl_b32 s57, s61, 7
  s_add_u32 s56, s56, s57
  s_lshl_b32 s58, s45, 5
  s_add_u32 s56, s56, s58
  s_lshl_b32 s59, s45, 10
  s_add_u32 s59, s59, 129024
  s_mov_b32 m0, s59
  v_lshl_add_u32 v26, v2, 3, v3
  buffer_load_dwordx4 v9, s[40:43], s56 offen lds
  v_lshlrev_b32 v26, 5, v26
  v_lshl_add_u32 v26, v4, 3, v26
  v_add_u32 v26, s59, v26
  s_mul_i32 s62, s60, 5120
  s_lshl_b32 s63, s61, 2
  s_add_u32 s63, s63, s45
  s_mul_i32 s64, s63, 205
  s_lshr_b32 s64, s64, 10
  s_mul_i32 s65, s64, 5
  s_sub_u32 s65, s63, s65
  s_mul_i32 s64, s64, 102400
  s_lshl_b32 s65, s65, 10
  s_add_u32 s64, s64, s65
  s_add_u32 s64, s64, s62
  s_add_u32 s68, s64, 65536
L_nowo1:
  v_and_b32 v6, 1, v2
  v_lshl_add_u32 v6, v6, 2, v3
  v_lshl_add_u32 v7, v2, 3, v3
  v_lshlrev_b32 v7, 9, v7
  v_lshl_add_u32 v7, v4, 3, v7
  v_add_u32 v7, 10240, v7
  s_lshl_b32 s52, s45, 2
  s_add_u32 s53, s52, 0
  v_xor_b32 v8, s53, v6
  v_lshl_add_u32 v10, v8, 5, v7
  s_mul_i32 s54, s53, 52
  s_lshr_b32 s54, s54, 8
  s_mul_i32 s55, s54, 5
  s_sub_u32 s55, s53, s55
  s_lshl_b32 s55, s55, 4
  s_cmp_eq_u32 s54, 3
  s_cselect_b32 s56, 512, 0
  s_mul_i32 s57, s54, 40
  s_cmp_eq_u32 s54, 0
  s_cselect_b32 s54, 0, 8
  s_add_u32 s54, s54, s57
  s_max_u32 s54, s54, s56
  v_lshl_add_u32 v8, v2, 2, s55
  v_mul_u32_u24 v9, 205, v8
  v_lshrrev_b32 v9, 12, v9
  v_mul_u32_u24 v9, 88, v9
  v_lshl_add_u32 v8, v8, 1, v9
  v_add_u32 v8, s54, v8
  v_min_u32 v8, 520, v8
  v_mul_u32_u24 v9, 528, v5
  v_add_u32 v22, v8, v9
  v_add_u32 v22, 114688, v22
  s_add_u32 s53, s52, 1
  v_xor_b32 v8, s53, v6
  v_lshl_add_u32 v11, v8, 5, v7
  s_mul_i32 s54, s53, 52
  s_lshr_b32 s54, s54, 8
  s_mul_i32 s55, s54, 5
  s_sub_u32 s55, s53, s55
  s_lshl_b32 s55, s55, 4
  s_cmp_eq_u32 s54, 3
  s_cselect_b32 s56, 512, 0
  s_mul_i32 s57, s54, 40
  s_cmp_eq_u32 s54, 0
  s_cselect_b32 s54, 0, 8
  s_add_u32 s54, s54, s57
  s_max_u32 s54, s54, s56
  v_lshl_add_u32 v8, v2, 2, s55
  v_mul_u32_u24 v9, 205, v8
  v_lshrrev_b32 v9, 12, v9
  v_mul_u32_u24 v9, 88, v9
  v_lshl_add_u32 v8, v8, 1, v9
  v_add_u32 v8, s54, v8
  v_min_u32 v8, 520, v8
  v_mul_u32_u24 v9, 528, v5
  v_add_u32 v23, v8, v9
  v_add_u32 v23, 114688, v23
  s_add_u32 s53, s52, 2
  v_xor_b32 v8, s53, v6
  v_lshl_add_u32 v12, v8, 5, v7
  s_mul_i32 s54, s53, 52
  s_lshr_b32 s54, s54, 8
  s_mul_i32 s55, s54, 5
  s_sub_u32 s55, s53, s55
  s_lshl_b32 s55, s55, 4
  s_cmp_eq_u32 s54, 3
  s_cselect_b32 s56, 512, 0
  s_mul_i32 s57, s54, 40
  s_cmp_eq_u32 s54, 0
  s_cselect_b32 s54, 0, 8
  s_add_u32 s54, s54, s57
  s_max_u32 s54, s54, s56
  v_lshl_add_u32 v8, v2, 2, s55
  v_mul_u32_u24 v9, 205, v8
  v_lshrrev_b32 v9, 12, v9
  v_mul_u32_u24 v9, 88, v9
  v_lshl_add_u32 v8, v8, 1, v9
  v_add_u32 v8, s54, v8
  v_min_u32 v8, 520, v8
  v_mul_u32_u24 v9, 528, v5
  v_add_u32 v24, v8, v9
  v_add_u32 v24, 114688, v24
  s_add_u32 s53, s52, 3
  v_xor_b32 v8, s53, v6
  v_lshl_add_u32 v13, v8, 5, v7
  s_mul_i32 s54, s53, 52
  s_lshr_b32 s54, s54, 8
  s_mul_i32 s55, s54, 5
  s_sub_u32 s55, s53, s55
  s_lshl_b32 s55, s55, 4
  s_cmp_eq_u32 s54, 3
  s_cselect_b32 s56, 512, 0
  s_mul_i32 s57, s54, 40
  s_cmp_eq_u32 s54, 0
  s_cselect_b32 s54, 0, 8
  s_add_u32 s54, s54, s57
  s_max_u32 s54, s54, s56
  v_lshl_add_u32 v8, v2, 2, s55
  v_mul_u32_u24 v9, 205, v8
  v_lshrrev_b32 v9, 12, v9
  v_mul_u32_u24 v9, 88, v9
  v_lshl_add_u32 v8, v8, 1, v9
  v_add_u32 v8, s54, v8
  v_min_u32 v8, 520, v8
  v_mul_u32_u24 v9, 528, v5
  v_add_u32 v25, v8, v9
  v_add_u32 v25, 114688, v25
  v_lshrrev_b32 v8, 1, v5
  v_xor_b32 v9, v2, v8
  v_lshlrev_b32 v9, 4, v9
  v_lshl_add_u32 v14, v5, 7, v9
  v_xor_b32 v15, 64, v14
  v_mov_b32 v32, 0
  v_mov_b32 v33, 0
  v_mov_b32 v34, 0
  v_mov_b32 v35, 0
  v_mov_b32 v36, 0
  v_mov_b32 v37, 0
  v_mov_b32 v38, 0
  v_mov_b32 v39, 0
  v_mov_b32 v40, 0
  v_mov_b32 v41, 0
  v_mov_b32 v42, 0
  v_mov_b32 v43, 0
  v_mov_b32 v44, 0
  v_mov_b32 v45, 0
  v_mov_b32 v46, 0
  v_mov_b32 v47, 0
  v_mov_b32 v48, 0
  v_mov_b32 v49, 0
  v_mov_b32 v50, 0
  v_mov_b32 v51, 0
  v_mov_b32 v52, 0
  v_mov_b32 v53, 0
  v_mov_b32 v54, 0
  v_mov_b32 v55, 0
  v_mov_b32 v56, 0
  v_mov_b32 v57, 0
  v_mov_b32 v58, 0
  v_mov_b32 v59, 0
  v_mov_b32 v60, 0
  v_mov_b32 v61, 0
  v_mov_b32 v62, 0
  v_mov_b32 v63, 0
  v_mov_b32 v64, 0
  v_mov_b32 v65, 0
  v_mov_b32 v66, 0
  v_mov_b32 v67, 0
  v_mov_b32 v68, 0
  v_mov_b32 v69, 0
  v_mov_b32 v70, 0
  v_mov_b32 v71, 0
  v_mov_b32 v72, 0
  v_mov_b32 v73, 0
  v_mov_b32 v74, 0
  v_mov_b32 v75, 0
  v_mov_b32 v76, 0
  v_mov_b32 v77, 0
  v_mov_b32 v78, 0
  v_mov_b32 v79, 0
  v_mov_b32 v80, 0
  v_mov_b32 v81, 0
  v_mov_b32 v82, 0
  v_mov_b32 v83, 0
  v_mov_b32 v84, 0
  v_mov_b32 v85, 0
  v_mov_b32 v86, 0
  v_mov_b32 v87, 0
  v_mov_b32 v88, 0
  v_mov_b32 v89, 0
  v_mov_b32 v90, 0
  v_mov_b32 v91, 0
  v_mov_b32 v92, 0
  v_mov_b32 v93, 0
  v_mov_b32 v94, 0
  v_mov_b32 v95, 0
  v_mov_b32 v96, 0
  v_mov_b32 v97, 0
  v_mov_b32 v98, 0
  v_mov_b32 v99, 0
  v_mov_b32 v100, 0
  v_mov_b32 v101, 0
  v_mov_b32 v102, 0
  v_mov_b32 v103, 0
  v_mov_b32 v104, 0
  v_mov_b32 v105, 0
  v_mov_b32 v106, 0
  v_mov_b32 v107, 0
  v_mov_b32 v108, 0
  v_mov_b32 v109, 0
  v_mov_b32 v110, 0
  v_mov_b32 v111, 0
  v_mov_b32 v148, 0
  v_mov_b32 v149, 0
  v_mov_b32 v150, 0
  v_mov_b32 v151, 0
  v_mov_b32 v152, 0
  v_mov_b32 v153, 0
  v_mov_b32 v154, 0
  v_mov_b32 v155, 0
  v_mov_b32 v156, 0
  v_mov_b32 v157, 0
  v_mov_b32 v158, 0
  v_mov_b32 v159, 0
  v_mov_b32 v160, 0
  v_mov_b32 v161, 0
  v_mov_b32 v162, 0
  v_mov_b32 v163, 0
  v_mov_b32 v164, 0
  v_mov_b32 v165, 0
  v_mov_b32 v166, 0
  v_mov_b32 v167, 0
  v_mov_b32 v184, 0
  v_mov_b32 v185, 0
  v_mov_b32 v186, 0
  v_mov_b32 v187, 0
  v_mov_b32 v188, 0
  v_mov_b32 v189, 0
  v_mov_b32 v190, 0
  v_mov_b32 v191, 0
  v_mov_b32 v192, 0
  v_mov_b32 v193, 0
  v_mov_b32 v194, 0
  v_mov_b32 v195, 0
  v_mov_b32 v196, 0
  v_mov_b32 v197, 0
  v_mov_b32 v198, 0
  v_mov_b32 v199, 0
  s_lshl_b32 s52, s46, 2
  v_mov_b32 v27, s52
  s_waitcnt vmcnt(0)
  s_cmp_eq_u32 s69, 0
  s_cbranch_scc1 L_noflag
  s_mov_b64 exec, 1
  global_store_dword v27, v30, s[20:21] offset:128 sc1
  s_mov_b64 exec, -1
L_noflag:
  s_cmp_ge_u32 s2, 200
  s_cbranch_scc1 L_nowo2
  ds_read_b64_tr_b16 v[200:201], v26
  ds_read_b64_tr_b16 v[202:203], v26 offset:128
  s_waitcnt lgkmcnt(0)
  buffer_store_dwordx4 v[200:203], v1, s[32:35], s68 offen sc1
L_nowo2:
  s_mov_b32 s60, 0
  s_mov_b32 s61, 0
  s_setprio 1
.p2align 3
L_p1:
  s_barrier
  v_add_u32 v20, s61, v14
  v_add_u32 v21, s61, v15
  v_add_u32 v16, s61, v10
  v_add_u32 v17, s61, v11
  v_add_u32 v18, s61, v12
  v_add_u32 v19, s61, v13
  v_mfma_f32_16x16x32_bf16 v[32:35], v[184:187], v[148:151], v[32:35]
  ds_read_b64_tr_b16 v[168:169], v16 offset:0
  v_mfma_f32_16x16x32_bf16 v[36:39], v[184:187], v[152:155], v[36:39]
  ds_read_b64_tr_b16 v[170:171], v16 offset:2048
  v_mfma_f32_16x16x32_bf16 v[40:43], v[184:187], v[156:159], v[40:43]
  ds_read_b128 v[128:131], v20 offset:0
  v_mfma_f32_16x16x32_bf16 v[44:47], v[184:187], v[160:163], v[44:47]
  ds_read_b128 v[132:135], v20 offset:2048
  v_mfma_f32_16x16x32_bf16 v[48:51], v[184:187], v[164:167], v[48:51]
  ds_read_b128 v[136:139], v20 offset:4096
  v_mfma_f32_16x16x32_bf16 v[52:55], v[188:191], v[148:151], v[52:55]
  ds_read_b128 v[140:143], v20 offset:6144
  v_mfma_f32_16x16x32_bf16 v[56:59], v[188:191], v[152:155], v[56:59]
  ds_read_b128 v[144:147], v20 offset:8192
  v_mfma_f32_16x16x32_bf16 v[60:63], v[188:191], v[156:159], v[60:63]
  ds_read_b64_tr_b16 v[172:173], v17 offset:0
  v_mfma_f32_16x16x32_bf16 v[64:67], v[188:191], v[160:163], v[64:67]
  ds_read_b64_tr_b16 v[174:175], v17 offset:2048
  v_mfma_f32_16x16x32_bf16 v[68:71], v[188:191], v[164:167], v[68:71]
  ds_read_b64_tr_b16 v[176:177], v18 offset:0
  v_mfma_f32_16x16x32_bf16 v[72:75], v[192:195], v[148:151], v[72:75]
  ds_read_b64_tr_b16 v[178:179], v18 offset:2048
  v_mfma_f32_16x16x32_bf16 v[76:79], v[192:195], v[152:155], v[76:79]
  ds_read_b64_tr_b16 v[180:181], v19 offset:0
  v_mfma_f32_16x16x32_bf16 v[80:83], v[192:195], v[156:159], v[80:83]
  ds_read_b64_tr_b16 v[182:183], v19 offset:2048
  v_mfma_f32_16x16x32_bf16 v[84:87], v[192:195], v[160:163], v[84:87]
  v_mfma_f32_16x16x32_bf16 v[88:91], v[192:195], v[164:167], v[88:91]
  v_mfma_f32_16x16x32_bf16 v[92:95], v[196:199], v[148:151], v[92:95]
  v_mfma_f32_16x16x32_bf16 v[96:99], v[196:199], v[152:155], v[96:99]
  v_mfma_f32_16x16x32_bf16 v[100:103], v[196:199], v[156:159], v[100:103]
  v_mfma_f32_16x16x32_bf16 v[104:107], v[196:199], v[160:163], v[104:107]
  v_mfma_f32_16x16x32_bf16 v[108:111], v[196:199], v[164:167], v[108:111]
  s_waitcnt lgkmcnt(10)
  v_mfma_f32_16x16x32_bf16 v[32:35], v[168:171], v[128:131], v[32:35]
  ds_read_b64_tr_b16 v[184:185], v16 offset:16384
  s_waitcnt lgkmcnt(10)
  v_mfma_f32_16x16x32_bf16 v[36:39], v[168:171], v[132:135], v[36:39]
  ds_read_b64_tr_b16 v[186:187], v16 offset:18432
  s_waitcnt lgkmcnt(10)
  v_mfma_f32_16x16x32_bf16 v[40:43], v[168:171], v[136:139], v[40:43]
  ds_read_b128 v[148:151], v21 offset:0
  s_waitcnt lgkmcnt(10)
  v_mfma_f32_16x16x32_bf16 v[44:47], v[168:171], v[140:143], v[44:47]
  ds_read_b128 v[152:155], v21 offset:2048
  s_waitcnt lgkmcnt(10)
  v_mfma_f32_16x16x32_bf16 v[48:51], v[168:171], v[144:147], v[48:51]
  ds_read_b128 v[156:159], v21 offset:4096
  s_waitcnt lgkmcnt(9)
  v_mfma_f32_16x16x32_bf16 v[52:55], v[172:175], v[128:131], v[52:55]
  ds_read_b128 v[160:163], v21 offset:6144
  v_mfma_f32_16x16x32_bf16 v[56:59], v[172:175], v[132:135], v[56:59]
  ds_read_b128 v[164:167], v21 offset:8192
  v_mfma_f32_16x16x32_bf16 v[60:63], v[172:175], v[136:139], v[60:63]
  ds_read_b64_tr_b16 v[188:189], v17 offset:16384
  v_mfma_f32_16x16x32_bf16 v[64:67], v[172:175], v[140:143], v[64:67]
  ds_read_b64_tr_b16 v[190:191], v17 offset:18432
  v_mfma_f32_16x16x32_bf16 v[68:71], v[172:175], v[144:147], v[68:71]
  ds_read_b64_tr_b16 v[192:193], v18 offset:16384
  s_waitcnt lgkmcnt(12)
  v_mfma_f32_16x16x32_bf16 v[72:75], v[176:179], v[128:131], v[72:75]
  ds_read_b64_tr_b16 v[194:195], v18 offset:18432
  v_mfma_f32_16x16x32_bf16 v[76:79], v[176:179], v[132:135], v[76:79]
  ds_read_b64_tr_b16 v[196:197], v19 offset:16384
  v_mfma_f32_16x16x32_bf16 v[80:83], v[176:179], v[136:139], v[80:83]
  ds_read_b64_tr_b16 v[198:199], v19 offset:18432
  v_mfma_f32_16x16x32_bf16 v[84:87], v[176:179], v[140:143], v[84:87]
  v_mfma_f32_16x16x32_bf16 v[88:91], v[176:179], v[144:147], v[88:91]
  s_waitcnt lgkmcnt(13)
  v_mfma_f32_16x16x32_bf16 v[92:95], v[180:183], v[128:131], v[92:95]
  v_mfma_f32_16x16x32_bf16 v[96:99], v[180:183], v[132:135], v[96:99]
  v_mfma_f32_16x16x32_bf16 v[100:103], v[180:183], v[136:139], v[100:103]
  v_mfma_f32_16x16x32_bf16 v[104:107], v[180:183], v[140:143], v[104:107]
  v_mfma_f32_16x16x32_bf16 v[108:111], v[180:183], v[144:147], v[108:111]
  s_cmp_gt_u32 s60, 3
  s_cbranch_scc1 L_p1_x
  s_cmp_eq_u32 s60, 0
  s_cbranch_scc0 L_p1_arr
  s_waitcnt vmcnt(0)
  s_cmp_lg_u32 s44, 0
  s_cbranch_scc1 L_p1_x
  global_load_dword v28, v27, s[20:21] offset:128 sc1
  s_branch L_p1_x
L_p1_arr:
  s_cmp_lg_u32 s44, 0
  s_cbranch_scc1 L_p1_x
  s_cmp_eq_u32 s60, 2
  s_cbranch_scc1 L_p1_x
  s_waitcnt vmcnt(0)
  s_cmp_eq_u32 s60, 3
  s_cbranch_scc1 L_p1_arr3
  v_readfirstlane_b32 s53, v28
  s_cmp_ge_u32 s53, 1
  s_cbranch_scc1 L_p1_arr2
  s_mov_b32 s52, 0
L_gp1:
  global_load_dword v28, v27, s[20:21] offset:128 sc1
  s_waitcnt vmcnt(0)
  v_readfirstlane_b32 s53, v28
  s_add_u32 s52, s52, 1
  s_cmp_ge_u32 s53, 1
  s_cbranch_scc1 L_gp1_ok
  s_cmp_lt_u32 s52, 65536
  s_cbranch_scc1 L_gp1
L_gp1_ok:
L_p1_arr2:
  s_lshl_b32 s52, s46, 10
  s_add_u32 s52, s52, 512
  v_mov_b32 v27, s52
  s_getreg_b32 s53, hwreg(HW_REG_XCC_ID)
  s_and_b32 s53, s53, 15
  s_add_u32 s53, s53, 1
  s_lshl_b32 s54, s49, 2
  s_add_u32 s54, s54, s52
  v_mov_b32 v28, s53
  v_mov_b32 v26, s54
  s_mov_b64 exec, 1
  global_store_dword v26, v28, s[22:23] offset:256 sc1
  global_atomic_add v200, v27, v30, s[22:23] sc0 sc1
  s_mov_b64 exec, -1
  s_branch L_p1_x
L_p1_arr3:
  v_readfirstlane_b32 s53, v200
  s_cmp_lg_u32 s53, 15
  s_cbranch_scc1 L_p1_x
  v_mov_b32 v27, 0
  s_mov_b64 exec, 1
  global_atomic_add v27, v30, s[20:21] offset:192 sc1
  s_mov_b64 exec, -1
L_p1_x:
  s_waitcnt lgkmcnt(0)
  s_add_u32 s61, s61, 43008
  s_cmp_ge_u32 s61, 129024
  s_cselect_b32 s61, 0, s61
  s_add_u32 s60, s60, 1
  s_cmp_lt_u32 s60, 10
  s_cbranch_scc1 L_p1
  v_mul_u32_u24 v6, 1280, v5
  v_lshl_add_u32 v6, v2, 3, v6
  s_lshl_b32 s62, s45, 4
  s_add_u32 s62, s62, s50
  s_mul_i32 s63, s62, 1280
  s_mul_i32 s64, s48, 160
  s_add_u32 s63, s63, s64
  buffer_load_dwordx2 v[246:247], v6, s[24:27], s63 offen offset:0
  buffer_load_dwordx2 v[248:249], v6, s[24:27], s63 offen offset:32
  buffer_load_dwordx2 v[250:251], v6, s[24:27], s63 offen offset:64
  buffer_load_dwordx2 v[252:253], v6, s[24:27], s63 offen offset:96
  buffer_load_dwordx2 v[254:255], v6, s[24:27], s63 offen offset:128
  v_mfma_f32_16x16x32_bf16 v[32:35], v[184:187], v[148:151], v[32:35]
  v_mfma_f32_16x16x32_bf16 v[36:39], v[184:187], v[152:155], v[36:39]
  v_mfma_f32_16x16x32_bf16 v[40:43], v[184:187], v[156:159], v[40:43]
  v_mfma_f32_16x16x32_bf16 v[44:47], v[184:187], v[160:163], v[44:47]
  v_mfma_f32_16x16x32_bf16 v[48:51], v[184:187], v[164:167], v[48:51]
  v_mfma_f32_16x16x32_bf16 v[52:55], v[188:191], v[148:151], v[52:55]
  v_mfma_f32_16x16x32_bf16 v[56:59], v[188:191], v[152:155], v[56:59]
  v_mfma_f32_16x16x32_bf16 v[60:63], v[188:191], v[156:159], v[60:63]
  v_mfma_f32_16x16x32_bf16 v[64:67], v[188:191], v[160:163], v[64:67]
  v_mfma_f32_16x16x32_bf16 v[68:71], v[188:191], v[164:167], v[68:71]
  v_mfma_f32_16x16x32_bf16 v[72:75], v[192:195], v[148:151], v[72:75]
  v_mfma_f32_16x16x32_bf16 v[76:79], v[192:195], v[152:155], v[76:79]
  v_mfma_f32_16x16x32_bf16 v[80:83], v[192:195], v[156:159], v[80:83]
  v_mfma_f32_16x16x32_bf16 v[84:87], v[192:195], v[160:163], v[84:87]
  v_mfma_f32_16x16x32_bf16 v[88:91], v[192:195], v[164:167], v[88:91]
  v_mfma_f32_16x16x32_bf16 v[92:95], v[196:199], v[148:151], v[92:95]
  v_mfma_f32_16x16x32_bf16 v[96:99], v[196:199], v[152:155], v[96:99]
  v_mfma_f32_16x16x32_bf16 v[100:103], v[196:199], v[156:159], v[100:103]
  v_mfma_f32_16x16x32_bf16 v[104:107], v[196:199], v[160:163], v[104:107]
  v_mfma_f32_16x16x32_bf16 v[108:111], v[196:199], v[164:167], v[108:111]
  v_lshlrev_b32 v7, 3, v5
  v_add_u32 v7, 162048, v7
  s_barrier
  ds_read_b64 v[144:145], v7 offset:0
  ds_read_b64 v[146:147], v7 offset:128
  ds_read_b64 v[148:149], v7 offset:256
  ds_read_b64 v[150:151], v7 offset:384
  ds_read_b64 v[152:153], v7 offset:512
  v_mov_b32_dpp v128, v32 row_newbcast:0 row_mask:0xf bank_mask:0xf
  v_mov_b32_dpp v129, v33 row_newbcast:0 row_mask:0xf bank_mask:0xf
  v_mov_b32_dpp v130, v34 row_newbcast:0 row_mask:0xf bank_mask:0xf
  v_mov_b32_dpp v131, v35 row_newbcast:0 row_mask:0xf bank_mask:0xf
  v_mov_b32_dpp v132, v52 row_newbcast:0 row_mask:0xf bank_mask:0xf
  v_mov_b32_dpp v133, v53 row_newbcast:0 row_mask:0xf bank_mask:0xf
  v_mov_b32_dpp v134, v54 row_newbcast:0 row_mask:0xf bank_mask:0xf
  v_mov_b32_dpp v135, v55 row_newbcast:0 row_mask:0xf bank_mask:0xf
  v_mov_b32_dpp v136, v72 row_newbcast:0 row_mask:0xf bank_mask:0xf
  v_mov_b32_dpp v137, v73 row_newbcast:0 row_mask:0xf bank_mask:0xf
  v_mov_b32_dpp v138, v74 row_newbcast:0 row_mask:0xf bank_mask:0xf
  v_mov_b32_dpp v139, v75 row_newbcast:0 row_mask:0xf bank_mask:0xf
  v_mov_b32_dpp v140, v92 row_newbcast:0 row_mask:0xf bank_mask:0xf
  v_mov_b32_dpp v141, v93 row_newbcast:0 row_mask:0xf bank_mask:0xf
  v_mov_b32_dpp v142, v94 row_newbcast:0 row_mask:0xf bank_mask:0xf
  v_mov_b32_dpp v143, v95 row_newbcast:0 row_mask:0xf bank_mask:0xf
  s_waitcnt lgkmcnt(4)
  v_pk_fma_f32 v[32:33], v[128:129], v[144:145], v[32:33] op_sel_hi:[1,0,1]
  v_pk_fma_f32 v[34:35], v[130:131], v[144:145], v[34:35] op_sel_hi:[1,0,1]
  v_pk_mul_f32 v[32:33], v[32:33], v[144:145] op_sel:[0,1] op_sel_hi:[1,1]
  v_pk_mul_f32 v[34:35], v[34:35], v[144:145] op_sel:[0,1] op_sel_hi:[1,1]
  v_cvt_pk_bf16_f32 v32, v32, v33
  v_cvt_pk_bf16_f32 v33, v34, v35
  ds_write_b64 v22, v[32:33] offset:0
  v_pk_fma_f32 v[52:53], v[132:133], v[144:145], v[52:53] op_sel_hi:[1,0,1]
  v_pk_fma_f32 v[54:55], v[134:135], v[144:145], v[54:55] op_sel_hi:[1,0,1]
  v_pk_mul_f32 v[52:53], v[52:53], v[144:145] op_sel:[0,1] op_sel_hi:[1,1]
  v_pk_mul_f32 v[54:55], v[54:55], v[144:145] op_sel:[0,1] op_sel_hi:[1,1]
  v_cvt_pk_bf16_f32 v52, v52, v53
  v_cvt_pk_bf16_f32 v53, v54, v55
  ds_write_b64 v23, v[52:53] offset:0
  v_pk_fma_f32 v[72:73], v[136:137], v[144:145], v[72:73] op_sel_hi:[1,0,1]
  v_pk_fma_f32 v[74:75], v[138:139], v[144:145], v[74:75] op_sel_hi:[1,0,1]
  v_pk_mul_f32 v[72:73], v[72:73], v[144:145] op_sel:[0,1] op_sel_hi:[1,1]
  v_pk_mul_f32 v[74:75], v[74:75], v[144:145] op_sel:[0,1] op_sel_hi:[1,1]
  v_cvt_pk_bf16_f32 v72, v72, v73
  v_cvt_pk_bf16_f32 v73, v74, v75
  ds_write_b64 v24, v[72:73] offset:0
  v_pk_fma_f32 v[92:93], v[140:141], v[144:145], v[92:93] op_sel_hi:[1,0,1]
  v_pk_fma_f32 v[94:95], v[142:143], v[144:145], v[94:95] op_sel_hi:[1,0,1]
  v_pk_mul_f32 v[92:93], v[92:93], v[144:145] op_sel:[0,1] op_sel_hi:[1,1]
  v_pk_mul_f32 v[94:95], v[94:95], v[144:145] op_sel:[0,1] op_sel_hi:[1,1]
  v_cvt_pk_bf16_f32 v92, v92, v93
  v_cvt_pk_bf16_f32 v93, v94, v95
  ds_write_b64 v25, v[92:93] offset:0
  s_waitcnt lgkmcnt(7)
  v_pk_fma_f32 v[36:37], v[128:129], v[146:147], v[36:37] op_sel_hi:[1,0,1]
  v_pk_fma_f32 v[38:39], v[130:131], v[146:147], v[38:39] op_sel_hi:[1,0,1]
  v_pk_mul_f32 v[36:37], v[36:37], v[146:147] op_sel:[0,1] op_sel_hi:[1,1]
  v_pk_mul_f32 v[38:39], v[38:39], v[146:147] op_sel:[0,1] op_sel_hi:[1,1]
  v_cvt_pk_bf16_f32 v36, v36, v37
  v_cvt_pk_bf16_f32 v37, v38, v39
  ds_write_b64 v22, v[36:37] offset:8448
  v_pk_fma_f32 v[56:57], v[132:133], v[146:147], v[56:57] op_sel_hi:[1,0,1]
  v_pk_fma_f32 v[58:59], v[134:135], v[146:147], v[58:59] op_sel_hi:[1,0,1]
  v_pk_mul_f32 v[56:57], v[56:57], v[146:147] op_sel:[0,1] op_sel_hi:[1,1]
  v_pk_mul_f32 v[58:59], v[58:59], v[146:147] op_sel:[0,1] op_sel_hi:[1,1]
  v_cvt_pk_bf16_f32 v56, v56, v57
  v_cvt_pk_bf16_f32 v57, v58, v59
  ds_write_b64 v23, v[56:57] offset:8448
  v_pk_fma_f32 v[76:77], v[136:137], v[146:147], v[76:77] op_sel_hi:[1,0,1]
  v_pk_fma_f32 v[78:79], v[138:139], v[146:147], v[78:79] op_sel_hi:[1,0,1]
  v_pk_mul_f32 v[76:77], v[76:77], v[146:147] op_sel:[0,1] op_sel_hi:[1,1]
  v_pk_mul_f32 v[78:79], v[78:79], v[146:147] op_sel:[0,1] op_sel_hi:[1,1]
  v_cvt_pk_bf16_f32 v76, v76, v77
  v_cvt_pk_bf16_f32 v77, v78, v79
  ds_write_b64 v24, v[76:77] offset:8448
  v_pk_fma_f32 v[96:97], v[140:141], v[146:147], v[96:97] op_sel_hi:[1,0,1]
  v_pk_fma_f32 v[98:99], v[142:143], v[146:147], v[98:99] op_sel_hi:[1,0,1]
  v_pk_mul_f32 v[96:97], v[96:97], v[146:147] op_sel:[0,1] op_sel_hi:[1,1]
  v_pk_mul_f32 v[98:99], v[98:99], v[146:147] op_sel:[0,1] op_sel_hi:[1,1]
  v_cvt_pk_bf16_f32 v96, v96, v97
  v_cvt_pk_bf16_f32 v97, v98, v99
  ds_write_b64 v25, v[96:97] offset:8448
  s_waitcnt lgkmcnt(10)
  v_pk_fma_f32 v[40:41], v[128:129], v[148:149], v[40:41] op_sel_hi:[1,0,1]
  v_pk_fma_f32 v[42:43], v[130:131], v[148:149], v[42:43] op_sel_hi:[1,0,1]
  v_pk_mul_f32 v[40:41], v[40:41], v[148:149] op_sel:[0,1] op_sel_hi:[1,1]
  v_pk_mul_f32 v[42:43], v[42:43], v[148:149] op_sel:[0,1] op_sel_hi:[1,1]
  v_cvt_pk_bf16_f32 v40, v40, v41
  v_cvt_pk_bf16_f32 v41, v42, v43
  ds_write_b64 v22, v[40:41] offset:16896
  v_pk_fma_f32 v[60:61], v[132:133], v[148:149], v[60:61] op_sel_hi:[1,0,1]
  v_pk_fma_f32 v[62:63], v[134:135], v[148:149], v[62:63] op_sel_hi:[1,0,1]
  v_pk_mul_f32 v[60:61], v[60:61], v[148:149] op_sel:[0,1] op_sel_hi:[1,1]
  v_pk_mul_f32 v[62:63], v[62:63], v[148:149] op_sel:[0,1] op_sel_hi:[1,1]
  v_cvt_pk_bf16_f32 v60, v60, v61
  v_cvt_pk_bf16_f32 v61, v62, v63
  ds_write_b64 v23, v[60:61] offset:16896
  v_pk_fma_f32 v[80:81], v[136:137], v[148:149], v[80:81] op_sel_hi:[1,0,1]
  v_pk_fma_f32 v[82:83], v[138:139], v[148:149], v[82:83] op_sel_hi:[1,0,1]
  v_pk_mul_f32 v[80:81], v[80:81], v[148:149] op_sel:[0,1] op_sel_hi:[1,1]
  v_pk_mul_f32 v[82:83], v[82:83], v[148:149] op_sel:[0,1] op_sel_hi:[1,1]
  v_cvt_pk_bf16_f32 v80, v80, v81
  v_cvt_pk_bf16_f32 v81, v82, v83
  ds_write_b64 v24, v[80:81] offset:16896
  v_pk_fma_f32 v[100:101], v[140:141], v[148:149], v[100:101] op_sel_hi:[1,0,1]
  v_pk_fma_f32 v[102:103], v[142:143], v[148:149], v[102:103] op_sel_hi:[1,0,1]
  v_pk_mul_f32 v[100:101], v[100:101], v[148:149] op_sel:[0,1] op_sel_hi:[1,1]
  v_pk_mul_f32 v[102:103], v[102:103], v[148:149] op_sel:[0,1] op_sel_hi:[1,1]
  v_cvt_pk_bf16_f32 v100, v100, v101
  v_cvt_pk_bf16_f32 v101, v102, v103
  ds_write_b64 v25, v[100:101] offset:16896
  s_waitcnt lgkmcnt(13)
  v_pk_fma_f32 v[44:45], v[128:129], v[150:151], v[44:45] op_sel_hi:[1,0,1]
  v_pk_fma_f32 v[46:47], v[130:131], v[150:151], v[46:47] op_sel_hi:[1,0,1]
  v_pk_mul_f32 v[44:45], v[44:45], v[150:151] op_sel:[0,1] op_sel_hi:[1,1]
  v_pk_mul_f32 v[46:47], v[46:47], v[150:151] op_sel:[0,1] op_sel_hi:[1,1]
  v_cvt_pk_bf16_f32 v44, v44, v45
  v_cvt_pk_bf16_f32 v45, v46, v47
  ds_write_b64 v22, v[44:45] offset:25344
  v_pk_fma_f32 v[64:65], v[132:133], v[150:151], v[64:65] op_sel_hi:[1,0,1]
  v_pk_fma_f32 v[66:67], v[134:135], v[150:151], v[66:67] op_sel_hi:[1,0,1]
  v_pk_mul_f32 v[64:65], v[64:65], v[150:151] op_sel:[0,1] op_sel_hi:[1,1]
  v_pk_mul_f32 v[66:67], v[66:67], v[150:151] op_sel:[0,1] op_sel_hi:[1,1]
  v_cvt_pk_bf16_f32 v64, v64, v65
  v_cvt_pk_bf16_f32 v65, v66, v67
  ds_write_b64 v23, v[64:65] offset:25344
  v_pk_fma_f32 v[84:85], v[136:137], v[150:151], v[84:85] op_sel_hi:[1,0,1]
  v_pk_fma_f32 v[86:87], v[138:139], v[150:151], v[86:87] op_sel_hi:[1,0,1]
  v_pk_mul_f32 v[84:85], v[84:85], v[150:151] op_sel:[0,1] op_sel_hi:[1,1]
  v_pk_mul_f32 v[86:87], v[86:87], v[150:151] op_sel:[0,1] op_sel_hi:[1,1]
  v_cvt_pk_bf16_f32 v84, v84, v85
  v_cvt_pk_bf16_f32 v85, v86, v87
  s_waitcnt lgkmcnt(14)
  ds_write_b64 v24, v[84:85] offset:25344
  v_pk_fma_f32 v[104:105], v[140:141], v[150:151], v[104:105] op_sel_hi:[1,0,1]
  v_pk_fma_f32 v[106:107], v[142:143], v[150:151], v[106:107] op_sel_hi:[1,0,1]
  v_pk_mul_f32 v[104:105], v[104:105], v[150:151] op_sel:[0,1] op_sel_hi:[1,1]
  v_pk_mul_f32 v[106:107], v[106:107], v[150:151] op_sel:[0,1] op_sel_hi:[1,1]
  v_cvt_pk_bf16_f32 v104, v104, v105
  v_cvt_pk_bf16_f32 v105, v106, v107
  s_waitcnt lgkmcnt(14)
  ds_write_b64 v25, v[104:105] offset:25344
  v_pk_fma_f32 v[48:49], v[128:129], v[152:153], v[48:49] op_sel_hi:[1,0,1]
  v_pk_fma_f32 v[50:51], v[130:131], v[152:153], v[50:51] op_sel_hi:[1,0,1]
  v_pk_mul_f32 v[48:49], v[48:49], v[152:153] op_sel:[0,1] op_sel_hi:[1,1]
  v_pk_mul_f32 v[50:51], v[50:51], v[152:153] op_sel:[0,1] op_sel_hi:[1,1]
  v_cvt_pk_bf16_f32 v48, v48, v49
  v_cvt_pk_bf16_f32 v49, v50, v51
  s_waitcnt lgkmcnt(14)
  ds_write_b64 v22, v[48:49] offset:33792
  v_pk_fma_f32 v[68:69], v[132:133], v[152:153], v[68:69] op_sel_hi:[1,0,1]
  v_pk_fma_f32 v[70:71], v[134:135], v[152:153], v[70:71] op_sel_hi:[1,0,1]
  v_pk_mul_f32 v[68:69], v[68:69], v[152:153] op_sel:[0,1] op_sel_hi:[1,1]
  v_pk_mul_f32 v[70:71], v[70:71], v[152:153] op_sel:[0,1] op_sel_hi:[1,1]
  v_cvt_pk_bf16_f32 v68, v68, v69
  v_cvt_pk_bf16_f32 v69, v70, v71
  s_waitcnt lgkmcnt(14)
  ds_write_b64 v23, v[68:69] offset:33792
  v_pk_fma_f32 v[88:89], v[136:137], v[152:153], v[88:89] op_sel_hi:[1,0,1]
  v_pk_fma_f32 v[90:91], v[138:139], v[152:153], v[90:91] op_sel_hi:[1,0,1]
  v_pk_mul_f32 v[88:89], v[88:89], v[152:153] op_sel:[0,1] op_sel_hi:[1,1]
  v_pk_mul_f32 v[90:91], v[90:91], v[152:153] op_sel:[0,1] op_sel_hi:[1,1]
  v_cvt_pk_bf16_f32 v88, v88, v89
  v_cvt_pk_bf16_f32 v89, v90, v91
  s_waitcnt lgkmcnt(14)
  ds_write_b64 v24, v[88:89] offset:33792
  v_pk_fma_f32 v[108:109], v[140:141], v[152:153], v[108:109] op_sel_hi:[1,0,1]
  v_pk_fma_f32 v[110:111], v[142:143], v[152:153], v[110:111] op_sel_hi:[1,0,1]
  v_pk_mul_f32 v[108:109], v[108:109], v[152:153] op_sel:[0,1] op_sel_hi:[1,1]
  v_pk_mul_f32 v[110:111], v[110:111], v[152:153] op_sel:[0,1] op_sel_hi:[1,1]
  v_cvt_pk_bf16_f32 v108, v108, v109
  v_cvt_pk_bf16_f32 v109, v110, v111
  s_waitcnt lgkmcnt(14)
  ds_write_b64 v25, v[108:109] offset:33792
  s_mov_b64 exec, 1
  s_waitcnt lgkmcnt(14)
  ds_add_u32 v29, v30 offset:256
  s_mov_b64 exec, -1
  v_add_u32 v7, 2, v0
  v_mul_u32_u24 v7, 528, v7
  s_lshl_b32 s52, s45, 7
  s_add_u32 s52, s52, 114688
  v_add_u32 v7, s52, v7
  s_waitcnt lgkmcnt(14)
  ds_read_b32 v31, v29 offset:256
  s_waitcnt lgkmcnt(0)
  v_readfirstlane_b32 s56, v31
  s_cmp_ge_u32 s56, 4
  s_cbranch_scc1 L_fl2_ok
  s_mov_b32 s57, 0
L_fl2:
  ds_read_b32 v31, v29 offset:256
  s_waitcnt lgkmcnt(0)
  v_readfirstlane_b32 s56, v31
  s_add_u32 s57, s57, 1
  s_cmp_ge_u32 s56, 4
  s_cbranch_scc1 L_fl2_ok
  s_cmp_lt_u32 s57, 1048576
  s_cbranch_scc1 L_fl2
L_fl2_ok:
  ds_read_b128 v[32:35], v7 offset:7392
  ds_read_b128 v[36:39], v7 offset:7408
  ds_read_b64 v[40:41], v7 offset:7424
  ds_read_b128 v[76:79], v7 offset:7440
  ds_read_b128 v[80:83], v7 offset:7456
  ds_read_b128 v[84:87], v7 offset:7472
  ds_read_b128 v[96:99], v7 offset:6384
  ds_read_b128 v[100:103], v7 offset:6400
  ds_read_b128 v[104:107], v7 offset:6416
  ds_read_b128 v[116:119], v7 offset:5328
  ds_read_b128 v[120:123], v7 offset:5344
  ds_read_b128 v[124:127], v7 offset:5360
  ds_read_b128 v[136:139], v7 offset:4272
  ds_read_b128 v[140:143], v7 offset:4288
  ds_read_b128 v[144:147], v7 offset:4304
  s_waitcnt lgkmcnt(9)
  ds_read_b128 v[156:159], v7 offset:3216
  ds_read_b128 v[160:163], v7 offset:3232
  ds_read_b128 v[164:167], v7 offset:3248
  v_dot2_f32_bf16 v10, v32, v76, 0
  v_dot2_f32_bf16 v10, v33, v77, v10
  v_dot2_f32_bf16 v10, v34, v78, v10
  v_dot2_f32_bf16 v10, v35, v79, v10
  v_dot2_f32_bf16 v10, v36, v80, v10
  v_dot2_f32_bf16 v10, v37, v81, v10
  v_dot2_f32_bf16 v10, v38, v82, v10
  v_dot2_f32_bf16 v10, v39, v83, v10
  v_dot2_f32_bf16 v10, v40, v84, v10
  v_dot2_f32_bf16 v10, v41, v85, v10
  s_waitcnt lgkmcnt(9)
  ds_read_b128 v[176:179], v7 offset:2160
  ds_read_b128 v[180:183], v7 offset:2176
  ds_read_b128 v[184:187], v7 offset:2192
  v_dot2_f32_bf16 v11, v32, v96, 0
  v_dot2_f32_bf16 v11, v33, v97, v11
  v_dot2_f32_bf16 v11, v34, v98, v11
  v_dot2_f32_bf16 v11, v35, v99, v11
  v_dot2_f32_bf16 v11, v36, v100, v11
  v_dot2_f32_bf16 v11, v37, v101, v11
  v_dot2_f32_bf16 v11, v38, v102, v11
  v_dot2_f32_bf16 v11, v39, v103, v11
  v_dot2_f32_bf16 v11, v40, v104, v11
  v_dot2_f32_bf16 v11, v41, v105, v11
  s_waitcnt lgkmcnt(9)
  ds_read_b128 v[196:199], v7 offset:1104
  ds_read_b128 v[200:203], v7 offset:1120
  ds_read_b128 v[204:207], v7 offset:1136
  v_dot2_f32_bf16 v12, v32, v116, 0
  v_dot2_f32_bf16 v12, v33, v117, v12
  v_dot2_f32_bf16 v12, v34, v118, v12
  v_dot2_f32_bf16 v12, v35, v119, v12
  v_dot2_f32_bf16 v12, v36, v120, v12
  v_dot2_f32_bf16 v12, v37, v121, v12
  v_dot2_f32_bf16 v12, v38, v122, v12
  v_dot2_f32_bf16 v12, v39, v123, v12
  v_dot2_f32_bf16 v12, v40, v124, v12
  v_dot2_f32_bf16 v12, v41, v125, v12
  s_waitcnt lgkmcnt(9)
  ds_read_b128 v[216:219], v7 offset:48
  ds_read_b128 v[220:223], v7 offset:64
  ds_read_b128 v[224:227], v7 offset:80
  v_dot2_f32_bf16 v13, v32, v136, 0
  v_dot2_f32_bf16 v13, v33, v137, v13
  v_dot2_f32_bf16 v13, v34, v138, v13
  v_dot2_f32_bf16 v13, v35, v139, v13
  v_dot2_f32_bf16 v13, v36, v140, v13
  v_dot2_f32_bf16 v13, v37, v141, v13
  v_dot2_f32_bf16 v13, v38, v142, v13
  v_dot2_f32_bf16 v13, v39, v143, v13
  v_dot2_f32_bf16 v13, v40, v144, v13
  v_dot2_f32_bf16 v13, v41, v145, v13
  s_waitcnt lgkmcnt(9)
  ds_read_b128 v[88:91], v7 offset:7488
  ds_read_b128 v[92:95], v7 offset:7504
  ds_read_b128 v[108:111], v7 offset:6432
  ds_read_b128 v[112:115], v7 offset:6448
  v_dot2_f32_bf16 v14, v32, v156, 0
  v_dot2_f32_bf16 v14, v33, v157, v14
  v_dot2_f32_bf16 v14, v34, v158, v14
  v_dot2_f32_bf16 v14, v35, v159, v14
  v_dot2_f32_bf16 v14, v36, v160, v14
  v_dot2_f32_bf16 v14, v37, v161, v14
  v_dot2_f32_bf16 v14, v38, v162, v14
  v_dot2_f32_bf16 v14, v39, v163, v14
  v_dot2_f32_bf16 v14, v40, v164, v14
  v_dot2_f32_bf16 v14, v41, v165, v14
  s_waitcnt lgkmcnt(10)
  ds_read_b128 v[128:131], v7 offset:5376
  ds_read_b128 v[132:135], v7 offset:5392
  ds_read_b128 v[148:151], v7 offset:4320
  ds_read_b128 v[152:155], v7 offset:4336
  v_dot2_f32_bf16 v15, v32, v176, 0
  v_dot2_f32_bf16 v15, v33, v177, v15
  v_dot2_f32_bf16 v15, v34, v178, v15
  v_dot2_f32_bf16 v15, v35, v179, v15
  v_dot2_f32_bf16 v15, v36, v180, v15
  v_dot2_f32_bf16 v15, v37, v181, v15
  v_dot2_f32_bf16 v15, v38, v182, v15
  v_dot2_f32_bf16 v15, v39, v183, v15
  v_dot2_f32_bf16 v15, v40, v184, v15
  v_dot2_f32_bf16 v15, v41, v185, v15
  s_waitcnt lgkmcnt(11)
  ds_read_b128 v[168:171], v7 offset:3264
  ds_read_b128 v[172:175], v7 offset:3280
  ds_read_b128 v[188:191], v7 offset:2208
  ds_read_b128 v[192:195], v7 offset:2224
  v_dot2_f32_bf16 v16, v32, v196, 0
  v_dot2_f32_bf16 v16, v33, v197, v16
  v_dot2_f32_bf16 v16, v34, v198, v16
  v_dot2_f32_bf16 v16, v35, v199, v16
  v_dot2_f32_bf16 v16, v36, v200, v16
  v_dot2_f32_bf16 v16, v37, v201, v16
  v_dot2_f32_bf16 v16, v38, v202, v16
  v_dot2_f32_bf16 v16, v39, v203, v16
  v_dot2_f32_bf16 v16, v40, v204, v16
  v_dot2_f32_bf16 v16, v41, v205, v16
  s_waitcnt lgkmcnt(12)
  ds_read_b128 v[208:211], v7 offset:1152
  ds_read_b128 v[212:215], v7 offset:1168
  ds_read_b128 v[228:231], v7 offset:96
  s_waitcnt lgkmcnt(14)
  ds_read_b128 v[232:235], v7 offset:112
  v_dot2_f32_bf16 v17, v32, v216, 0
  v_dot2_f32_bf16 v17, v33, v217, v17
  v_dot2_f32_bf16 v17, v34, v218, v17
  v_dot2_f32_bf16 v17, v35, v219, v17
  v_dot2_f32_bf16 v17, v36, v220, v17
  v_dot2_f32_bf16 v17, v37, v221, v17
  v_dot2_f32_bf16 v17, v38, v222, v17
  v_dot2_f32_bf16 v17, v39, v223, v17
  v_dot2_f32_bf16 v17, v40, v224, v17
  v_dot2_f32_bf16 v17, v41, v225, v17
  s_mov_b64 exec, 1
  s_waitcnt lgkmcnt(14)
  ds_add_u32 v29, v30 offset:152
  s_mov_b64 exec, -1
  s_cmp_lg_u32 s47, 0
  s_cbranch_scc1 L_nomask
  v_mov_b32 v18, 0xf149f2ca
  v_cmp_gt_u32 vcc, 2, v0
  s_nop 1
  v_cndmask_b32 v11, v11, v18, vcc
  v_cmp_gt_u32 vcc, 4, v0
  s_nop 1
  v_cndmask_b32 v12, v12, v18, vcc
  v_cmp_gt_u32 vcc, 6, v0
  s_nop 1
  v_cndmask_b32 v13, v13, v18, vcc
  v_cmp_gt_u32 vcc, 8, v0
  s_nop 1
  v_cndmask_b32 v14, v14, v18, vcc
  v_cmp_gt_u32 vcc, 10, v0
  s_nop 1
  v_cndmask_b32 v15, v15, v18, vcc
  v_cmp_gt_u32 vcc, 12, v0
  s_nop 1
  v_cndmask_b32 v16, v16, v18, vcc
  v_cmp_gt_u32 vcc, 14, v0
  s_nop 1
  v_cndmask_b32 v17, v17, v18, vcc
L_nomask:
  v_max3_f32 v18, v10, v11, v12
  v_max3_f32 v19, v13, v14, v15
  v_max3_f32 v18, v18, v16, v17
  v_max_f32 v18, v18, v19
  s_mov_b32 s52, 0x3ea52b5c
  v_mul_f32 v18, 0xbea52b5c, v18
  v_fma_f32 v10, v10, s52, v18
  v_fma_f32 v11, v11, s52, v18
  v_fma_f32 v12, v12, s52, v18
  v_fma_f32 v13, v13, s52, v18
  v_fma_f32 v14, v14, s52, v18
  v_fma_f32 v15, v15, s52, v18
  v_fma_f32 v16, v16, s52, v18
  v_fma_f32 v17, v17, s52, v18
  v_exp_f32 v10, v10
  v_exp_f32 v11, v11
  v_exp_f32 v12, v12
  v_exp_f32 v13, v13
  v_exp_f32 v14, v14
  v_exp_f32 v15, v15
  v_exp_f32 v16, v16
  v_exp_f32 v17, v17
  v_add_f32 v18, v10, v11
  v_add_f32 v19, v12, v13
  v_add_f32 v20, v14, v15
  v_add_f32 v21, v16, v17
  v_add_f32 v18, v18, v19
  v_add_f32 v20, v20, v21
  v_add_f32 v18, v18, v20
  v_rcp_f32 v18, v18
  s_nop 0
  v_mul_f32 v10, v10, v18
  v_mul_f32 v11, v11, v18
  v_mul_f32 v12, v12, v18
  v_mul_f32 v13, v13, v18
  v_mul_f32 v14, v14, v18
  v_mul_f32 v15, v15, v18
  v_mul_f32 v16, v16, v18
  v_mul_f32 v17, v17, v18
  v_cvt_pk_bf16_f32 v32, v10, 0
  v_cvt_pk_bf16_f32 v40, 0, v10
  v_cvt_pk_bf16_f32 v33, v11, 0
  v_cvt_pk_bf16_f32 v41, 0, v11
  v_cvt_pk_bf16_f32 v34, v12, 0
  v_cvt_pk_bf16_f32 v42, 0, v12
  v_cvt_pk_bf16_f32 v35, v13, 0
  v_cvt_pk_bf16_f32 v43, 0, v13
  v_cvt_pk_bf16_f32 v36, v14, 0
  v_cvt_pk_bf16_f32 v44, 0, v14
  v_cvt_pk_bf16_f32 v37, v15, 0
  v_cvt_pk_bf16_f32 v45, 0, v15
  v_cvt_pk_bf16_f32 v38, v16, 0
  v_cvt_pk_bf16_f32 v46, 0, v16
  v_cvt_pk_bf16_f32 v39, v17, 0
  v_cvt_pk_bf16_f32 v47, 0, v17
  s_waitcnt lgkmcnt(14)
  ds_read_b32 v31, v29 offset:280
  v_dot2_f32_bf16 v48, v86, v32, 0
  v_dot2_f32_bf16 v49, v86, v40, 0
  v_dot2_f32_bf16 v50, v87, v32, 0
  v_dot2_f32_bf16 v51, v87, v40, 0
  v_dot2_f32_bf16 v52, v88, v32, 0
  v_dot2_f32_bf16 v53, v88, v40, 0
  v_dot2_f32_bf16 v54, v89, v32, 0
  v_dot2_f32_bf16 v55, v89, v40, 0
  v_dot2_f32_bf16 v56, v90, v32, 0
  v_dot2_f32_bf16 v57, v90, v40, 0
  v_dot2_f32_bf16 v58, v91, v32, 0
  v_dot2_f32_bf16 v59, v91, v40, 0
  v_dot2_f32_bf16 v60, v92, v32, 0
  v_dot2_f32_bf16 v61, v92, v40, 0
  v_dot2_f32_bf16 v62, v93, v32, 0
  v_dot2_f32_bf16 v63, v93, v40, 0
  v_dot2_f32_bf16 v64, v94, v32, 0
  v_dot2_f32_bf16 v65, v94, v40, 0
  v_dot2_f32_bf16 v66, v95, v32, 0
  v_dot2_f32_bf16 v67, v95, v40, 0
  s_waitcnt lgkmcnt(14)
  v_dot2_f32_bf16 v48, v106, v33, v48
  v_dot2_f32_bf16 v49, v106, v41, v49
  v_dot2_f32_bf16 v50, v107, v33, v50
  v_dot2_f32_bf16 v51, v107, v41, v51
  v_dot2_f32_bf16 v52, v108, v33, v52
  v_dot2_f32_bf16 v53, v108, v41, v53
  v_dot2_f32_bf16 v54, v109, v33, v54
  v_dot2_f32_bf16 v55, v109, v41, v55
  v_dot2_f32_bf16 v56, v110, v33, v56
  v_dot2_f32_bf16 v57, v110, v41, v57
  v_dot2_f32_bf16 v58, v111, v33, v58
  v_dot2_f32_bf16 v59, v111, v41, v59
  v_dot2_f32_bf16 v60, v112, v33, v60
  v_dot2_f32_bf16 v61, v112, v41, v61
  v_dot2_f32_bf16 v62, v113, v33, v62
  v_dot2_f32_bf16 v63, v113, v41, v63
  v_dot2_f32_bf16 v64, v114, v33, v64
  v_dot2_f32_bf16 v65, v114, v41, v65
  v_dot2_f32_bf16 v66, v115, v33, v66
  v_dot2_f32_bf16 v67, v115, v41, v67
  s_waitcnt lgkmcnt(12)
  v_dot2_f32_bf16 v48, v126, v34, v48
  v_dot2_f32_bf16 v49, v126, v42, v49
  v_dot2_f32_bf16 v50, v127, v34, v50
  v_dot2_f32_bf16 v51, v127, v42, v51
  v_dot2_f32_bf16 v52, v128, v34, v52
  v_dot2_f32_bf16 v53, v128, v42, v53
  v_dot2_f32_bf16 v54, v129, v34, v54
  v_dot2_f32_bf16 v55, v129, v42, v55
  v_dot2_f32_bf16 v56, v130, v34, v56
  v_dot2_f32_bf16 v57, v130, v42, v57
  v_dot2_f32_bf16 v58, v131, v34, v58
  v_dot2_f32_bf16 v59, v131, v42, v59
  v_dot2_f32_bf16 v60, v132, v34, v60
  v_dot2_f32_bf16 v61, v132, v42, v61
  v_dot2_f32_bf16 v62, v133, v34, v62
  v_dot2_f32_bf16 v63, v133, v42, v63
  v_dot2_f32_bf16 v64, v134, v34, v64
  v_dot2_f32_bf16 v65, v134, v42, v65
  v_dot2_f32_bf16 v66, v135, v34, v66
  v_dot2_f32_bf16 v67, v135, v42, v67
  s_waitcnt lgkmcnt(10)
  v_dot2_f32_bf16 v48, v146, v35, v48
  v_dot2_f32_bf16 v49, v146, v43, v49
  v_dot2_f32_bf16 v50, v147, v35, v50
  v_dot2_f32_bf16 v51, v147, v43, v51
  v_dot2_f32_bf16 v52, v148, v35, v52
  v_dot2_f32_bf16 v53, v148, v43, v53
  v_dot2_f32_bf16 v54, v149, v35, v54
  v_dot2_f32_bf16 v55, v149, v43, v55
  v_dot2_f32_bf16 v56, v150, v35, v56
  v_dot2_f32_bf16 v57, v150, v43, v57
  v_dot2_f32_bf16 v58, v151, v35, v58
  v_dot2_f32_bf16 v59, v151, v43, v59
  v_dot2_f32_bf16 v60, v152, v35, v60
  v_dot2_f32_bf16 v61, v152, v43, v61
  v_dot2_f32_bf16 v62, v153, v35, v62
  v_dot2_f32_bf16 v63, v153, v43, v63
  v_dot2_f32_bf16 v64, v154, v35, v64
  v_dot2_f32_bf16 v65, v154, v43, v65
  v_dot2_f32_bf16 v66, v155, v35, v66
  v_dot2_f32_bf16 v67, v155, v43, v67
  s_waitcnt lgkmcnt(8)
  v_dot2_f32_bf16 v48, v166, v36, v48
  v_dot2_f32_bf16 v49, v166, v44, v49
  v_dot2_f32_bf16 v50, v167, v36, v50
  v_dot2_f32_bf16 v51, v167, v44, v51
  v_dot2_f32_bf16 v52, v168, v36, v52
  v_dot2_f32_bf16 v53, v168, v44, v53
  v_dot2_f32_bf16 v54, v169, v36, v54
  v_dot2_f32_bf16 v55, v169, v44, v55
  v_dot2_f32_bf16 v56, v170, v36, v56
  v_dot2_f32_bf16 v57, v170, v44, v57
  v_dot2_f32_bf16 v58, v171, v36, v58
  v_dot2_f32_bf16 v59, v171, v44, v59
  v_dot2_f32_bf16 v60, v172, v36, v60
  v_dot2_f32_bf16 v61, v172, v44, v61
  v_dot2_f32_bf16 v62, v173, v36, v62
  v_dot2_f32_bf16 v63, v173, v44, v63
  v_dot2_f32_bf16 v64, v174, v36, v64
  v_dot2_f32_bf16 v65, v174, v44, v65
  v_dot2_f32_bf16 v66, v175, v36, v66
  v_dot2_f32_bf16 v67, v175, v44, v67
  s_waitcnt lgkmcnt(6)
  v_dot2_f32_bf16 v48, v186, v37, v48
  v_dot2_f32_bf16 v49, v186, v45, v49
  v_dot2_f32_bf16 v50, v187, v37, v50
  v_dot2_f32_bf16 v51, v187, v45, v51
  v_dot2_f32_bf16 v52, v188, v37, v52
  v_dot2_f32_bf16 v53, v188, v45, v53
  v_dot2_f32_bf16 v54, v189, v37, v54
  v_dot2_f32_bf16 v55, v189, v45, v55
  v_dot2_f32_bf16 v56, v190, v37, v56
  v_dot2_f32_bf16 v57, v190, v45, v57
  v_dot2_f32_bf16 v58, v191, v37, v58
  v_dot2_f32_bf16 v59, v191, v45, v59
  v_dot2_f32_bf16 v60, v192, v37, v60
  v_dot2_f32_bf16 v61, v192, v45, v61
  v_dot2_f32_bf16 v62, v193, v37, v62
  v_dot2_f32_bf16 v63, v193, v45, v63
  v_dot2_f32_bf16 v64, v194, v37, v64
  v_dot2_f32_bf16 v65, v194, v45, v65
  v_dot2_f32_bf16 v66, v195, v37, v66
  v_dot2_f32_bf16 v67, v195, v45, v67
  s_waitcnt lgkmcnt(4)
  v_dot2_f32_bf16 v48, v206, v38, v48
  v_dot2_f32_bf16 v49, v206, v46, v49
  v_dot2_f32_bf16 v50, v207, v38, v50
  v_dot2_f32_bf16 v51, v207, v46, v51
  v_dot2_f32_bf16 v52, v208, v38, v52
  v_dot2_f32_bf16 v53, v208, v46, v53
  v_dot2_f32_bf16 v54, v209, v38, v54
  v_dot2_f32_bf16 v55, v209, v46, v55
  v_dot2_f32_bf16 v56, v210, v38, v56
  v_dot2_f32_bf16 v57, v210, v46, v57
  v_dot2_f32_bf16 v58, v211, v38, v58
  v_dot2_f32_bf16 v59, v211, v46, v59
  v_dot2_f32_bf16 v60, v212, v38, v60
  v_dot2_f32_bf16 v61, v212, v46, v61
  v_dot2_f32_bf16 v62, v213, v38, v62
  v_dot2_f32_bf16 v63, v213, v46, v63
  v_dot2_f32_bf16 v64, v214, v38, v64
  v_dot2_f32_bf16 v65, v214, v46, v65
  v_dot2_f32_bf16 v66, v215, v38, v66
  v_dot2_f32_bf16 v67, v215, v46, v67
  s_waitcnt lgkmcnt(2)
  v_dot2_f32_bf16 v48, v226, v39, v48
  v_dot2_f32_bf16 v49, v226, v47, v49
  v_dot2_f32_bf16 v50, v227, v39, v50
  v_dot2_f32_bf16 v51, v227, v47, v51
  v_dot2_f32_bf16 v52, v228, v39, v52
  v_dot2_f32_bf16 v53, v228, v47, v53
  v_dot2_f32_bf16 v54, v229, v39, v54
  v_dot2_f32_bf16 v55, v229, v47, v55
  v_dot2_f32_bf16 v56, v230, v39, v56
  v_dot2_f32_bf16 v57, v230, v47, v57
  v_dot2_f32_bf16 v58, v231, v39, v58
  v_dot2_f32_bf16 v59, v231, v47, v59
  v_dot2_f32_bf16 v60, v232, v39, v60
  v_dot2_f32_bf16 v61, v232, v47, v61
  v_dot2_f32_bf16 v62, v233, v39, v62
  v_dot2_f32_bf16 v63, v233, v47, v63
  v_dot2_f32_bf16 v64, v234, v39, v64
  v_dot2_f32_bf16 v65, v234, v47, v65
  v_dot2_f32_bf16 v66, v235, v39, v66
  v_dot2_f32_bf16 v67, v235, v47, v67
  s_waitcnt lgkmcnt(0)
  v_readfirstlane_b32 s56, v31
  s_cmp_ge_u32 s56, 1
  s_cbranch_scc1 L_fl3_ok
  s_mov_b32 s57, 0
L_fl3:
  ds_read_b32 v31, v29 offset:280
  s_waitcnt lgkmcnt(0)
  v_readfirstlane_b32 s56, v31
  s_add_u32 s57, s57, 1
  s_cmp_ge_u32 s56, 1
  s_cbranch_scc1 L_fl3_ok
  s_cmp_lt_u32 s57, 1048576
  s_cbranch_scc1 L_fl3
L_fl3_ok:
  s_sub_u32 s51, s56, 1
  v_mul_u32_u24 v8, 49152, v2
  v_lshl_add_u32 v8, v5, 4, v8
  s_lshl_b32 s52, s48, 2
  s_add_u32 s52, s52, s45
  s_mul_i32 s52, s52, 5
  s_lshr_b32 s52, s52, 1
  s_mul_i32 s53, s47, 196608
  s_add_u32 s53, s53, 14680064
  s_lshl_b32 s52, s52, 8
  s_add_u32 s53, s53, s52
  v_cvt_pk_bf16_f32 v76, v48, v49
  v_cvt_pk_bf16_f32 v77, v50, v51
  v_cvt_pk_bf16_f32 v78, v52, v53
  v_cvt_pk_bf16_f32 v79, v54, v55
  v_cvt_pk_bf16_f32 v80, v56, v57
  v_cvt_pk_bf16_f32 v81, v58, v59
  v_cvt_pk_bf16_f32 v82, v60, v61
  v_cvt_pk_bf16_f32 v83, v62, v63
  v_cvt_pk_bf16_f32 v84, v64, v65
  v_cvt_pk_bf16_f32 v85, v66, v67
  s_bitcmp1_b32 s45, 0
  s_cbranch_scc1 L_oodd
  s_cmp_eq_u32 s51, 0
  s_cbranch_scc1 L_ms4_g
  buffer_store_dwordx4 v[76:79], v8, s[32:35], s53 offen
  buffer_store_dwordx4 v[80:83], v8, s[32:35], s53 offen offset:256
  buffer_store_dwordx2 v[84:85], v8, s[32:35], s53 offen offset:512
  s_branch L_ms4_d
L_ms4_g:
  buffer_store_dwordx4 v[76:79], v8, s[32:35], s53 offen sc1
  buffer_store_dwordx4 v[80:83], v8, s[32:35], s53 offen offset:256 sc1
  buffer_store_dwordx2 v[84:85], v8, s[32:35], s53 offen offset:512 sc1
L_ms4_d:
  s_branch L_odone
L_oodd:
  s_cmp_eq_u32 s51, 0
  s_cbranch_scc1 L_ms5_g
  buffer_store_dwordx2 v[76:77], v8, s[32:35], s53 offen offset:8
  buffer_store_dwordx4 v[78:81], v8, s[32:35], s53 offen offset:256
  buffer_store_dwordx4 v[82:85], v8, s[32:35], s53 offen offset:512
  s_branch L_ms5_d
L_ms5_g:
  buffer_store_dwordx2 v[76:77], v8, s[32:35], s53 offen offset:8 sc1
  buffer_store_dwordx4 v[78:81], v8, s[32:35], s53 offen offset:256 sc1
  buffer_store_dwordx4 v[82:85], v8, s[32:35], s53 offen offset:512 sc1
L_ms5_d:
L_odone:
  v_add_u32 v13, 0x10000, v1
  v_add_u32 v14, 0x20000, v1
  v_lshlrev_b32 v15, 9, v2
  v_lshl_add_u32 v15, v5, 4, v15
  s_lshl_b32 s52, s47, 1
  s_lshr_b32 s53, s45, 1
  s_add_u32 s52, s52, s53
  s_mul_i32 s64, s52, 40960
  s_mul_i32 s53, s48, 5
  s_lshr_b32 s53, s53, 1
  s_lshl_b32 s53, s53, 11
  s_add_u32 s64, s64, s53
  s_and_b32 s53, s45, 1
  s_lshl_b32 s53, s53, 8
  s_add_u32 s64, s64, s53
  s_add_u32 s65, s64, 4096
  s_lshl_b32 s53, s49, 4
  s_lshl_b32 s52, s45, 2
  s_add_u32 s53, s53, s52
  s_lshl_b32 s52, s47, 7
  s_and_b32 s52, s52, 128
  s_lshl_b32 s54, s46, 10
  s_add_u32 s54, s54, 0x8000
  s_add_u32 s52, s52, s54
  s_add_u32 s53, s53, s54
  v_lshl_add_u32 v26, v0, 2, s52
  v_mov_b32 v25, s53
  s_lshl_b32 s54, s47, 2
  s_add_u32 s54, s54, s45
  s_mul_i32 s66, s54, 49152
  s_add_u32 s66, s66, 14680064
  s_waitcnt vmcnt(0)
  s_mov_b64 exec, 1
  s_cmp_eq_u32 s51, 0
  s_cbranch_scc1 L_ms7_g
  global_store_dword v25, v30, s[22:23]
  s_branch L_ms7_d
L_ms7_g:
  global_store_dword v25, v30, s[22:23] sc1
L_ms7_d:
  s_mov_b32 exec_lo, 0xffffffff
  s_mov_b32 s57, 0
L_sy6_p:
  global_load_dword v28, v26, s[22:23] sc1
  s_add_u32 s57, s57, 1
  s_waitcnt vmcnt(0)
  v_cmp_eq_u32 vcc, 0, v28
  s_cbranch_vccz L_sy6_q
  s_cmp_lt_u32 s57, 65536
  s_cbranch_scc1 L_sy6_p
L_sy6_q:
  s_mov_b64 exec, -1
  ds_read_b32 v31, v29 offset:16
  buffer_load_dwordx4 v[112:115], v1, s[32:35], s66 offen offset:0 sc1
  buffer_load_dwordx4 v[116:119], v1, s[32:35], s66 offen offset:1024 sc1
  buffer_load_dwordx4 v[120:123], v1, s[32:35], s66 offen offset:2048 sc1
  buffer_load_dwordx4 v[124:127], v1, s[32:35], s66 offen offset:3072 sc1
  s_add_u32 s66, s66, 4096
  buffer_load_dwordx4 v[128:131], v1, s[32:35], s66 offen offset:0 sc1
  buffer_load_dwordx4 v[132:135], v1, s[32:35], s66 offen offset:1024 sc1
  buffer_load_dwordx4 v[136:139], v1, s[32:35], s66 offen offset:2048 sc1
  buffer_load_dwordx4 v[140:143], v1, s[32:35], s66 offen offset:3072 sc1
  v_lshlrev_b32 v212, 16, v246
  v_and_b32 v213, 0xffff0000, v246
  v_lshlrev_b32 v214, 16, v247
  v_and_b32 v215, 0xffff0000, v247
  v_lshlrev_b32 v216, 16, v248
  v_and_b32 v217, 0xffff0000, v248
  v_lshlrev_b32 v218, 16, v249
  v_and_b32 v219, 0xffff0000, v249
  v_lshlrev_b32 v220, 16, v250
  v_and_b32 v221, 0xffff0000, v250
  v_lshlrev_b32 v222, 16, v251
  v_and_b32 v223, 0xffff0000, v251
  v_lshlrev_b32 v224, 16, v252
  v_and_b32 v225, 0xffff0000, v252
  v_lshlrev_b32 v226, 16, v253
  v_and_b32 v227, 0xffff0000, v253
  v_lshlrev_b32 v228, 16, v254
  v_and_b32 v229, 0xffff0000, v254
  v_lshlrev_b32 v230, 16, v255
  v_and_b32 v231, 0xffff0000, v255
  s_waitcnt lgkmcnt(0)
  v_readfirstlane_b32 s56, v31
  s_cmp_ge_u32 s56, 4
  s_cbranch_scc1 L_fl8_ok
  s_mov_b32 s57, 0
L_fl8:
  ds_read_b32 v31, v29 offset:16
  s_waitcnt lgkmcnt(0)
  v_readfirstlane_b32 s56, v31
  s_add_u32 s57, s57, 1
  s_cmp_ge_u32 s56, 4
  s_cbranch_scc1 L_fl8_ok
  s_cmp_lt_u32 s57, 1048576
  s_cbranch_scc1 L_fl8
L_fl8_ok:
  ds_read_b128 v[52:55], v1 offset:0
  ds_read_b128 v[56:59], v1 offset:1024
  ds_read_b128 v[60:63], v1 offset:2048
  ds_read_b128 v[64:67], v1 offset:3072
  ds_read_b128 v[68:71], v1 offset:4096
  ds_read_b128 v[72:75], v1 offset:5120
  ds_read_b128 v[76:79], v1 offset:6144
  ds_read_b128 v[80:83], v1 offset:7168
  ds_read_b128 v[84:87], v1 offset:8192
  ds_read_b128 v[88:91], v1 offset:9216
  s_waitcnt vmcnt(7)
  s_waitcnt lgkmcnt(5)
  v_mfma_f32_16x16x32_bf16 v[32:35], v[52:55], v[112:115], 0
  ds_read_b128 v[92:95], v1 offset:10240
  v_mfma_f32_16x16x32_bf16 v[36:39], v[56:59], v[112:115], 0
  ds_read_b128 v[96:99], v1 offset:11264
  s_add_u32 s66, s66, 4096
  buffer_load_dwordx4 v[144:147], v1, s[32:35], s66 offen offset:0 sc1
  v_mfma_f32_16x16x32_bf16 v[40:43], v[60:63], v[112:115], 0
  ds_read_b128 v[100:103], v1 offset:12288
  v_mfma_f32_16x16x32_bf16 v[44:47], v[64:67], v[112:115], 0
  ds_read_b128 v[104:107], v1 offset:13312
  buffer_load_dwordx4 v[148:151], v1, s[32:35], s66 offen offset:1024 sc1
  v_mfma_f32_16x16x32_bf16 v[48:51], v[68:71], v[112:115], 0
  ds_read_b128 v[108:111], v1 offset:14336
  s_waitcnt vmcnt(8)
  s_waitcnt lgkmcnt(5)
  v_mfma_f32_16x16x32_bf16 v[32:35], v[72:75], v[116:119], v[32:35]
  ds_read_b128 v[52:55], v1 offset:15360
  v_mfma_f32_16x16x32_bf16 v[36:39], v[76:79], v[116:119], v[36:39]
  ds_read_b128 v[56:59], v1 offset:16384
  buffer_load_dwordx4 v[152:155], v1, s[32:35], s66 offen offset:2048 sc1
  v_mfma_f32_16x16x32_bf16 v[40:43], v[80:83], v[116:119], v[40:43]
  ds_read_b128 v[60:63], v1 offset:17408
  v_mfma_f32_16x16x32_bf16 v[44:47], v[84:87], v[116:119], v[44:47]
  ds_read_b128 v[64:67], v1 offset:18432
  buffer_load_dwordx4 v[156:159], v1, s[32:35], s66 offen offset:3072 sc1
  v_mfma_f32_16x16x32_bf16 v[48:51], v[88:91], v[116:119], v[48:51]
  ds_read_b128 v[68:71], v1 offset:19456
  s_mov_b64 exec, 1
  ds_add_u32 v29, v30 offset:160
  s_mov_b64 exec, -1
  s_waitcnt vmcnt(9)
  s_waitcnt lgkmcnt(6)
  v_mfma_f32_16x16x32_bf16 v[32:35], v[92:95], v[120:123], v[32:35]
  ds_read_b128 v[72:75], v1 offset:20480
  v_mfma_f32_16x16x32_bf16 v[36:39], v[96:99], v[120:123], v[36:39]
  ds_read_b128 v[76:79], v1 offset:21504
  s_add_u32 s66, s66, 4096
  buffer_load_dwordx4 v[160:163], v1, s[32:35], s66 offen offset:0 sc1
  v_mfma_f32_16x16x32_bf16 v[40:43], v[100:103], v[120:123], v[40:43]
  ds_read_b128 v[80:83], v1 offset:22528
  v_mfma_f32_16x16x32_bf16 v[44:47], v[104:107], v[120:123], v[44:47]
  ds_read_b128 v[84:87], v1 offset:23552
  buffer_load_dwordx4 v[164:167], v1, s[32:35], s66 offen offset:1024 sc1
  v_mfma_f32_16x16x32_bf16 v[48:51], v[108:111], v[120:123], v[48:51]
  ds_read_b128 v[88:91], v1 offset:24576
  s_waitcnt vmcnt(10)
  s_waitcnt lgkmcnt(6)
  v_mfma_f32_16x16x32_bf16 v[32:35], v[52:55], v[124:127], v[32:35]
  ds_read_b128 v[92:95], v1 offset:25600
  v_mfma_f32_16x16x32_bf16 v[36:39], v[56:59], v[124:127], v[36:39]
  ds_read_b128 v[96:99], v1 offset:26624
  buffer_load_dwordx4 v[168:171], v1, s[32:35], s66 offen offset:2048 sc1
  v_mfma_f32_16x16x32_bf16 v[40:43], v[60:63], v[124:127], v[40:43]
  ds_read_b128 v[100:103], v1 offset:27648
  v_mfma_f32_16x16x32_bf16 v[44:47], v[64:67], v[124:127], v[44:47]
  ds_read_b128 v[104:107], v1 offset:28672
  buffer_load_dwordx4 v[172:175], v1, s[32:35], s66 offen offset:3072 sc1
  v_mfma_f32_16x16x32_bf16 v[48:51], v[68:71], v[124:127], v[48:51]
  ds_read_b128 v[108:111], v1 offset:29696
  s_waitcnt vmcnt(11)
  s_waitcnt lgkmcnt(5)
  v_mfma_f32_16x16x32_bf16 v[32:35], v[72:75], v[128:131], v[32:35]
  ds_read_b128 v[52:55], v1 offset:30720
  v_mfma_f32_16x16x32_bf16 v[36:39], v[76:79], v[128:131], v[36:39]
  ds_read_b128 v[56:59], v1 offset:31744
  s_add_u32 s66, s66, 4096
  buffer_load_dwordx4 v[176:179], v1, s[32:35], s66 offen offset:0 sc1
  v_mfma_f32_16x16x32_bf16 v[40:43], v[80:83], v[128:131], v[40:43]
  ds_read_b128 v[60:63], v1 offset:32768
  v_mfma_f32_16x16x32_bf16 v[44:47], v[84:87], v[128:131], v[44:47]
  ds_read_b128 v[64:67], v1 offset:33792
  buffer_load_dwordx4 v[180:183], v1, s[32:35], s66 offen offset:1024 sc1
  v_mfma_f32_16x16x32_bf16 v[48:51], v[88:91], v[128:131], v[48:51]
  ds_read_b128 v[68:71], v1 offset:34816
  s_waitcnt vmcnt(12)
  s_waitcnt lgkmcnt(5)
  v_mfma_f32_16x16x32_bf16 v[32:35], v[92:95], v[132:135], v[32:35]
  ds_read_b128 v[72:75], v1 offset:35840
  v_mfma_f32_16x16x32_bf16 v[36:39], v[96:99], v[132:135], v[36:39]
  ds_read_b128 v[76:79], v1 offset:36864
  buffer_load_dwordx4 v[184:187], v1, s[32:35], s66 offen offset:2048 sc1
  v_mfma_f32_16x16x32_bf16 v[40:43], v[100:103], v[132:135], v[40:43]
  ds_read_b128 v[80:83], v1 offset:37888
  v_mfma_f32_16x16x32_bf16 v[44:47], v[104:107], v[132:135], v[44:47]
  ds_read_b128 v[84:87], v1 offset:38912
  buffer_load_dwordx4 v[188:191], v1, s[32:35], s66 offen offset:3072 sc1
  s_mov_b64 exec, 1
  ds_add_u32 v29, v30 offset:156
  s_mov_b64 exec, -1
  v_mfma_f32_16x16x32_bf16 v[48:51], v[108:111], v[132:135], v[48:51]
  ds_read_b128 v[88:91], v1 offset:39936
  s_mov_b64 exec, 1
  ds_add_u32 v29, v30 offset:164
  s_mov_b64 exec, -1
  s_waitcnt vmcnt(13)
  s_waitcnt lgkmcnt(7)
  v_mfma_f32_16x16x32_bf16 v[32:35], v[52:55], v[136:139], v[32:35]
  ds_read_b128 v[92:95], v1 offset:40960
  v_mfma_f32_16x16x32_bf16 v[36:39], v[56:59], v[136:139], v[36:39]
  ds_read_b128 v[96:99], v1 offset:41984
  v_mfma_f32_16x16x32_bf16 v[40:43], v[60:63], v[136:139], v[40:43]
  ds_read_b128 v[100:103], v1 offset:43008
  v_mfma_f32_16x16x32_bf16 v[44:47], v[64:67], v[136:139], v[44:47]
  ds_read_b128 v[104:107], v1 offset:44032
  v_mfma_f32_16x16x32_bf16 v[48:51], v[68:71], v[136:139], v[48:51]
  ds_read_b128 v[108:111], v1 offset:45056
  s_waitcnt vmcnt(12)
  s_waitcnt lgkmcnt(6)
  v_mfma_f32_16x16x32_bf16 v[32:35], v[72:75], v[140:143], v[32:35]
  ds_read_b128 v[52:55], v1 offset:46080
  v_mfma_f32_16x16x32_bf16 v[36:39], v[76:79], v[140:143], v[36:39]
  ds_read_b128 v[56:59], v1 offset:47104
  v_mfma_f32_16x16x32_bf16 v[40:43], v[80:83], v[140:143], v[40:43]
  ds_read_b128 v[60:63], v1 offset:48128
  v_mfma_f32_16x16x32_bf16 v[44:47], v[84:87], v[140:143], v[44:47]
  ds_read_b128 v[64:67], v1 offset:49152
  v_mfma_f32_16x16x32_bf16 v[48:51], v[88:91], v[140:143], v[48:51]
  ds_read_b128 v[68:71], v1 offset:50176
  s_waitcnt vmcnt(11)
  s_waitcnt lgkmcnt(5)
  v_mfma_f32_16x16x32_bf16 v[32:35], v[92:95], v[144:147], v[32:35]
  ds_read_b128 v[72:75], v1 offset:51200
  v_mfma_f32_16x16x32_bf16 v[36:39], v[96:99], v[144:147], v[36:39]
  ds_read_b128 v[76:79], v1 offset:52224
  v_mfma_f32_16x16x32_bf16 v[40:43], v[100:103], v[144:147], v[40:43]
  ds_read_b128 v[80:83], v1 offset:53248
  v_mfma_f32_16x16x32_bf16 v[44:47], v[104:107], v[144:147], v[44:47]
  ds_read_b128 v[84:87], v1 offset:54272
  v_mfma_f32_16x16x32_bf16 v[48:51], v[108:111], v[144:147], v[48:51]
  ds_read_b128 v[88:91], v1 offset:55296
  s_waitcnt vmcnt(10)
  s_waitcnt lgkmcnt(5)
  v_mfma_f32_16x16x32_bf16 v[32:35], v[52:55], v[148:151], v[32:35]
  ds_read_b128 v[92:95], v1 offset:56320
  v_mfma_f32_16x16x32_bf16 v[36:39], v[56:59], v[148:151], v[36:39]
  ds_read_b128 v[96:99], v1 offset:57344
  v_mfma_f32_16x16x32_bf16 v[40:43], v[60:63], v[148:151], v[40:43]
  ds_read_b128 v[100:103], v1 offset:58368
  v_mfma_f32_16x16x32_bf16 v[44:47], v[64:67], v[148:151], v[44:47]
  ds_read_b128 v[104:107], v1 offset:59392
  v_mfma_f32_16x16x32_bf16 v[48:51], v[68:71], v[148:151], v[48:51]
  ds_read_b128 v[108:111], v1 offset:60416
  s_mov_b64 exec, 1
  ds_add_u32 v29, v30 offset:168
  s_mov_b64 exec, -1
  s_waitcnt vmcnt(9)
  s_waitcnt lgkmcnt(6)
  v_mfma_f32_16x16x32_bf16 v[32:35], v[72:75], v[152:155], v[32:35]
  ds_read_b128 v[52:55], v1 offset:61440
  v_mfma_f32_16x16x32_bf16 v[36:39], v[76:79], v[152:155], v[36:39]
  ds_read_b128 v[56:59], v1 offset:62464
  v_mfma_f32_16x16x32_bf16 v[40:43], v[80:83], v[152:155], v[40:43]
  ds_read_b128 v[60:63], v1 offset:63488
  v_mfma_f32_16x16x32_bf16 v[44:47], v[84:87], v[152:155], v[44:47]
  ds_read_b128 v[64:67], v1 offset:64512
  v_mfma_f32_16x16x32_bf16 v[48:51], v[88:91], v[152:155], v[48:51]
  ds_read_b128 v[68:71], v13 offset:0
  s_waitcnt vmcnt(8)
  s_waitcnt lgkmcnt(6)
  v_mfma_f32_16x16x32_bf16 v[32:35], v[92:95], v[156:159], v[32:35]
  ds_read_b128 v[72:75], v13 offset:1024
  v_mfma_f32_16x16x32_bf16 v[36:39], v[96:99], v[156:159], v[36:39]
  ds_read_b128 v[76:79], v13 offset:2048
  v_mfma_f32_16x16x32_bf16 v[40:43], v[100:103], v[156:159], v[40:43]
  ds_read_b128 v[80:83], v13 offset:3072
  v_mfma_f32_16x16x32_bf16 v[44:47], v[104:107], v[156:159], v[44:47]
  ds_read_b128 v[84:87], v13 offset:4096
  v_mfma_f32_16x16x32_bf16 v[48:51], v[108:111], v[156:159], v[48:51]
  ds_read_b128 v[88:91], v13 offset:5120
  s_waitcnt vmcnt(7)
  s_waitcnt lgkmcnt(5)
  v_mfma_f32_16x16x32_bf16 v[32:35], v[52:55], v[160:163], v[32:35]
  ds_read_b128 v[92:95], v13 offset:6144
  v_mfma_f32_16x16x32_bf16 v[36:39], v[56:59], v[160:163], v[36:39]
  ds_read_b128 v[96:99], v13 offset:7168
  v_mfma_f32_16x16x32_bf16 v[40:43], v[60:63], v[160:163], v[40:43]
  ds_read_b128 v[100:103], v13 offset:8192
  v_mfma_f32_16x16x32_bf16 v[44:47], v[64:67], v[160:163], v[44:47]
  ds_read_b128 v[104:107], v13 offset:9216
  v_mfma_f32_16x16x32_bf16 v[48:51], v[68:71], v[160:163], v[48:51]
  ds_read_b128 v[108:111], v13 offset:10240
  s_waitcnt vmcnt(6)
  s_waitcnt lgkmcnt(5)
  v_mfma_f32_16x16x32_bf16 v[32:35], v[72:75], v[164:167], v[32:35]
  ds_read_b128 v[52:55], v13 offset:11264
  v_mfma_f32_16x16x32_bf16 v[36:39], v[76:79], v[164:167], v[36:39]
  ds_read_b128 v[56:59], v13 offset:12288
  v_mfma_f32_16x16x32_bf16 v[40:43], v[80:83], v[164:167], v[40:43]
  ds_read_b128 v[60:63], v13 offset:13312
  v_mfma_f32_16x16x32_bf16 v[44:47], v[84:87], v[164:167], v[44:47]
  ds_read_b128 v[64:67], v13 offset:14336
  v_mfma_f32_16x16x32_bf16 v[48:51], v[88:91], v[164:167], v[48:51]
  ds_read_b128 v[68:71], v13 offset:15360
  s_mov_b64 exec, 1
  ds_add_u32 v29, v30 offset:172
  s_mov_b64 exec, -1
  s_waitcnt vmcnt(5)
  s_waitcnt lgkmcnt(6)
  v_mfma_f32_16x16x32_bf16 v[32:35], v[92:95], v[168:171], v[32:35]
  ds_read_b128 v[72:75], v13 offset:16384
  v_mfma_f32_16x16x32_bf16 v[36:39], v[96:99], v[168:171], v[36:39]
  ds_read_b128 v[76:79], v13 offset:17408
  v_mfma_f32_16x16x32_bf16 v[40:43], v[100:103], v[168:171], v[40:43]
  ds_read_b128 v[80:83], v13 offset:18432
  v_mfma_f32_16x16x32_bf16 v[44:47], v[104:107], v[168:171], v[44:47]
  ds_read_b128 v[84:87], v13 offset:19456
  v_mfma_f32_16x16x32_bf16 v[48:51], v[108:111], v[168:171], v[48:51]
  ds_read_b128 v[88:91], v13 offset:20480
  s_waitcnt vmcnt(4)
  s_waitcnt lgkmcnt(6)
  v_mfma_f32_16x16x32_bf16 v[32:35], v[52:55], v[172:175], v[32:35]
  ds_read_b128 v[92:95], v13 offset:21504
  v_mfma_f32_16x16x32_bf16 v[36:39], v[56:59], v[172:175], v[36:39]
  ds_read_b128 v[96:99], v13 offset:22528
  v_mfma_f32_16x16x32_bf16 v[40:43], v[60:63], v[172:175], v[40:43]
  ds_read_b128 v[100:103], v13 offset:23552
  v_mfma_f32_16x16x32_bf16 v[44:47], v[64:67], v[172:175], v[44:47]
  ds_read_b128 v[104:107], v13 offset:24576
  v_mfma_f32_16x16x32_bf16 v[48:51], v[68:71], v[172:175], v[48:51]
  ds_read_b128 v[108:111], v13 offset:25600
  s_waitcnt vmcnt(3)
  s_waitcnt lgkmcnt(5)
  v_mfma_f32_16x16x32_bf16 v[32:35], v[72:75], v[176:179], v[32:35]
  ds_read_b128 v[52:55], v13 offset:26624
  v_mfma_f32_16x16x32_bf16 v[36:39], v[76:79], v[176:179], v[36:39]
  ds_read_b128 v[56:59], v13 offset:27648
  v_mfma_f32_16x16x32_bf16 v[40:43], v[80:83], v[176:179], v[40:43]
  ds_read_b128 v[60:63], v13 offset:28672
  v_mfma_f32_16x16x32_bf16 v[44:47], v[84:87], v[176:179], v[44:47]
  ds_read_b128 v[64:67], v13 offset:29696
  v_mfma_f32_16x16x32_bf16 v[48:51], v[88:91], v[176:179], v[48:51]
  ds_read_b128 v[68:71], v13 offset:30720
  s_waitcnt vmcnt(2)
  s_waitcnt lgkmcnt(5)
  v_mfma_f32_16x16x32_bf16 v[32:35], v[92:95], v[180:183], v[32:35]
  ds_read_b128 v[72:75], v13 offset:31744
  v_mfma_f32_16x16x32_bf16 v[36:39], v[96:99], v[180:183], v[36:39]
  ds_read_b128 v[76:79], v13 offset:32768
  v_mfma_f32_16x16x32_bf16 v[40:43], v[100:103], v[180:183], v[40:43]
  ds_read_b128 v[80:83], v13 offset:33792
  v_mfma_f32_16x16x32_bf16 v[44:47], v[104:107], v[180:183], v[44:47]
  ds_read_b128 v[84:87], v13 offset:34816
  v_mfma_f32_16x16x32_bf16 v[48:51], v[108:111], v[180:183], v[48:51]
  ds_read_b128 v[88:91], v13 offset:35840
  s_mov_b64 exec, 1
  ds_add_u32 v29, v30 offset:176
  s_mov_b64 exec, -1
  s_waitcnt vmcnt(1)
  s_waitcnt lgkmcnt(6)
  v_mfma_f32_16x16x32_bf16 v[32:35], v[52:55], v[184:187], v[32:35]
  v_mfma_f32_16x16x32_bf16 v[36:39], v[56:59], v[184:187], v[36:39]
  v_mfma_f32_16x16x32_bf16 v[40:43], v[60:63], v[184:187], v[40:43]
  v_mfma_f32_16x16x32_bf16 v[44:47], v[64:67], v[184:187], v[44:47]
  v_mfma_f32_16x16x32_bf16 v[48:51], v[68:71], v[184:187], v[48:51]
  s_waitcnt vmcnt(0)
  s_waitcnt lgkmcnt(1)
  v_mfma_f32_16x16x32_bf16 v[32:35], v[72:75], v[188:191], v[32:35]
  v_mfma_f32_16x16x32_bf16 v[36:39], v[76:79], v[188:191], v[36:39]
  v_mfma_f32_16x16x32_bf16 v[40:43], v[80:83], v[188:191], v[40:43]
  v_mfma_f32_16x16x32_bf16 v[44:47], v[84:87], v[188:191], v[44:47]
  v_mfma_f32_16x16x32_bf16 v[48:51], v[88:91], v[188:191], v[48:51]
  s_nop 3
  v_pk_add_f32 v[32:33], v[32:33], v[212:213]
  v_pk_add_f32 v[34:35], v[34:35], v[214:215]
  v_cvt_pk_bf16_f32 v246, v32, v33
  v_cvt_pk_bf16_f32 v247, v34, v35
  v_pk_add_f32 v[36:37], v[36:37], v[216:217]
  v_pk_add_f32 v[38:39], v[38:39], v[218:219]
  v_cvt_pk_bf16_f32 v248, v36, v37
  v_cvt_pk_bf16_f32 v249, v38, v39
  v_pk_add_f32 v[40:41], v[40:41], v[220:221]
  v_pk_add_f32 v[42:43], v[42:43], v[222:223]
  v_cvt_pk_bf16_f32 v250, v40, v41
  v_cvt_pk_bf16_f32 v251, v42, v43
  v_pk_add_f32 v[44:45], v[44:45], v[224:225]
  v_pk_add_f32 v[46:47], v[46:47], v[226:227]
  v_cvt_pk_bf16_f32 v252, v44, v45
  v_cvt_pk_bf16_f32 v253, v46, v47
  v_pk_add_f32 v[48:49], v[48:49], v[228:229]
  v_pk_add_f32 v[50:51], v[50:51], v[230:231]
  v_cvt_pk_bf16_f32 v254, v48, v49
  v_cvt_pk_bf16_f32 v255, v50, v51
  s_bitcmp1_b32 s48, 0
  s_cbranch_scc1 L_hodd
  s_cmp_eq_u32 s51, 0
  s_cbranch_scc1 L_ms9_g
  buffer_store_dwordx4 v[246:249], v15, s[36:39], s64 offen
  buffer_store_dwordx4 v[250:253], v15, s[36:39], s64 offen offset:2048
  buffer_store_dwordx2 v[254:255], v15, s[36:39], s65 offen
  s_branch L_ms9_d
L_ms9_g:
  buffer_store_dwordx4 v[246:249], v15, s[36:39], s64 offen sc1
  buffer_store_dwordx4 v[250:253], v15, s[36:39], s64 offen offset:2048 sc1
  buffer_store_dwordx2 v[254:255], v15, s[36:39], s65 offen sc1
L_ms9_d:
  s_branch L_hdone
L_hodd:
  s_cmp_eq_u32 s51, 0
  s_cbranch_scc1 L_ms10_g
  buffer_store_dwordx2 v[246:247], v15, s[36:39], s64 offen offset:8
  buffer_store_dwordx4 v[248:251], v15, s[36:39], s64 offen offset:2048
  buffer_store_dwordx4 v[252:255], v15, s[36:39], s65 offen
  s_branch L_ms10_d
L_ms10_g:
  buffer_store_dwordx2 v[246:247], v15, s[36:39], s64 offen offset:8 sc1
  buffer_store_dwordx4 v[248:251], v15, s[36:39], s64 offen offset:2048 sc1
  buffer_store_dwordx4 v[252:255], v15, s[36:39], s65 offen sc1
L_ms10_d:
L_hdone:
  v_dot2_f32_bf16 v16, v246, s3, 0
  v_dot2_f32_bf16 v17, v246, v246, 0
  v_dot2_f32_bf16 v16, v247, s3, v16
  v_dot2_f32_bf16 v17, v247, v247, v17
  v_dot2_f32_bf16 v16, v248, s3, v16
  v_dot2_f32_bf16 v17, v248, v248, v17
  v_dot2_f32_bf16 v16, v249, s3, v16
  v_dot2_f32_bf16 v17, v249, v249, v17
  v_dot2_f32_bf16 v16, v250, s3, v16
  v_dot2_f32_bf16 v17, v250, v250, v17
  v_dot2_f32_bf16 v16, v251, s3, v16
  v_dot2_f32_bf16 v17, v251, v251, v17
  v_dot2_f32_bf16 v16, v252, s3, v16
  v_dot2_f32_bf16 v17, v252, v252, v17
  v_dot2_f32_bf16 v16, v253, s3, v16
  v_dot2_f32_bf16 v17, v253, v253, v17
  v_dot2_f32_bf16 v16, v254, s3, v16
  v_dot2_f32_bf16 v17, v254, v254, v17
  v_dot2_f32_bf16 v16, v255, s3, v16
  v_dot2_f32_bf16 v17, v255, v255, v17
  s_nop 1
  v_mov_b32 v18, v16
  v_mov_b32 v19, v17
  s_nop 0
  v_permlane16_swap_b32 v16, v18
  v_permlane16_swap_b32 v17, v19
  v_add_f32 v16, v16, v18
  v_add_f32 v17, v17, v19
  v_mov_b32 v18, v16
  v_mov_b32 v19, v17
  s_nop 0
  v_permlane32_swap_b32 v16, v18
  v_permlane32_swap_b32 v17, v19
  v_add_f32 v16, v16, v18
  v_add_f32 v17, v17, v19
  v_lshlrev_b32 v18, 6, v5
  s_lshl_b32 s52, s62, 6
  s_lshl_b32 s53, s48, 3
  s_add_u32 s52, s52, s53
  s_add_u32 s52, s52, 7471104
  s_mov_b32 exec_lo, 0xffff
  s_mov_b32 exec_hi, 0
  s_cmp_eq_u32 s51, 0
  s_cbranch_scc1 L_ms11_g
  buffer_store_dwordx2 v[16:17], v18, s[32:35], s52 offen
  s_branch L_ms11_d
L_ms11_g:
  buffer_store_dwordx2 v[16:17], v18, s[32:35], s52 offen sc1
L_ms11_d:
  s_mov_b64 exec, -1
  s_lshl_b32 s53, s47, 7
  s_and_b32 s53, s53, 128
  s_lshr_b32 s52, s45, 1
  s_lshl_b32 s52, s52, 6
  s_add_u32 s53, s53, s52
  s_lshl_b32 s52, s48, 3
  s_add_u32 s53, s53, s52
  s_and_b32 s52, s45, 1
  s_lshl_b32 s52, s52, 2
  s_add_u32 s53, s53, s52
  s_add_u32 s53, s53, 256
  s_lshl_b32 s52, s45, 6
  s_add_u32 s52, s52, 256
  s_lshl_b32 s54, s46, 10
  s_add_u32 s54, s54, 0x8000
  s_add_u32 s52, s52, s54
  s_add_u32 s53, s53, s54
  v_lshl_add_u32 v26, v0, 2, s52
  v_mov_b32 v25, s53
  s_lshl_b32 s54, s46, 3
  s_lshl_b32 s53, s45, 1
  s_add_u32 s54, s54, s53
  s_mul_i32 s66, s54, 20480
  s_add_u32 s67, s66, 256
  v_lshrrev_b32 v19, 1, v2
  v_mul_u32_u24 v10, 6144, v19
  v_and_b32 v19, 1, v2
  v_lshl_add_u32 v10, v19, 9, v10
  v_lshl_add_u32 v10, v5, 4, v10
  v_lshl_add_u32 v10, v2, 2, v3
  v_mul_u32_u24 v10, 192, v10
  v_lshl_add_u32 v10, v4, 3, v10
  v_lshlrev_b32 v19, 5, v19
  v_sub_u32 v7, v10, v19
  v_add_u32 v7, 32, v7
  v_add_u32 v10, v10, v19
  v_add_u32 v8, 0x10000, v7
  v_add_u32 v9, 0x20000, v7
  v_add_u32 v11, 0x10000, v10
  v_add_u32 v12, 0x20000, v10
  s_lshl_b32 s69, s54, 10
  s_add_u32 s69, s69, 7471104
  s_mul_i32 s68, s54, 49152
  s_mul_i32 s54, s49, 3072
  s_add_u32 s68, s68, s54
  s_add_u32 s68, s68, 14680064
  v_lshl_add_u32 v18, v2, 4, v18
  s_waitcnt vmcnt(0)
  s_mov_b64 exec, 1
  s_cmp_eq_u32 s51, 0
  s_cbranch_scc1 L_ms13_g
  global_store_dword v25, v30, s[22:23]
  s_branch L_ms13_d
L_ms13_g:
  global_store_dword v25, v30, s[22:23] sc1
L_ms13_d:
  s_mov_b32 exec_lo, 0xffff
  s_mov_b32 s57, 0
L_sy12_p:
  global_load_dword v28, v26, s[22:23] sc1
  s_add_u32 s57, s57, 1
  s_waitcnt vmcnt(0)
  v_cmp_eq_u32 vcc, 0, v28
  s_cbranch_vccz L_sy12_q
  s_cmp_lt_u32 s57, 65536
  s_cbranch_scc1 L_sy12_p
L_sy12_q:
  s_mov_b64 exec, -1
  ds_read_b32 v31, v29 offset:24
  buffer_load_dwordx4 v[176:179], v15, s[36:39], s66 offen offset:0 sc1
  buffer_load_dwordx4 v[180:183], v15, s[36:39], s67 offen offset:0 sc1
  buffer_load_dwordx4 v[20:23], v18, s[32:35], s69 offen offset:0 sc1
  buffer_load_dwordx4 v[24:27], v18, s[32:35], s69 offen offset:1024 sc1
  buffer_load_dwordx4 v[184:187], v15, s[36:39], s66 offen offset:2048 sc1
  buffer_load_dwordx4 v[188:191], v15, s[36:39], s67 offen offset:2048 sc1
  s_add_u32 s66, s66, 4096
  s_add_u32 s67, s67, 4096
  buffer_load_dwordx4 v[192:195], v15, s[36:39], s66 offen offset:0 sc1
  buffer_load_dwordx4 v[196:199], v15, s[36:39], s67 offen offset:0 sc1
  buffer_load_dwordx4 v[200:203], v15, s[36:39], s66 offen offset:2048 sc1
  buffer_load_dwordx4 v[204:207], v15, s[36:39], s67 offen offset:2048 sc1
  s_mov_b64 exec, 1
  ds_add_u32 v29, v30 offset:180
  s_mov_b64 exec, -1
  s_waitcnt lgkmcnt(1)
  v_readfirstlane_b32 s56, v31
  s_cmp_ge_u32 s56, 4
  s_cbranch_scc1 L_fl14_ok
  s_mov_b32 s57, 0
L_fl14:
  ds_read_b32 v31, v29 offset:24
  s_waitcnt lgkmcnt(0)
  v_readfirstlane_b32 s56, v31
  s_add_u32 s57, s57, 1
  s_cmp_ge_u32 s56, 4
  s_cbranch_scc1 L_fl14_ok
  s_cmp_lt_u32 s57, 1048576
  s_cbranch_scc1 L_fl14
L_fl14_ok:
  ds_read_b64_tr_b16 v[128:129], v11 offset:36864
  ds_read_b64_tr_b16 v[130:131], v11 offset:39936
  ds_read_b64_tr_b16 v[132:133], v11 offset:43008
  ds_read_b64_tr_b16 v[134:135], v11 offset:46080
  ds_read_b64_tr_b16 v[136:137], v8 offset:36864
  ds_read_b64_tr_b16 v[138:139], v8 offset:39936
  ds_read_b64_tr_b16 v[140:141], v8 offset:43008
  ds_read_b64_tr_b16 v[142:143], v8 offset:46080
  ds_read_b64_tr_b16 v[144:145], v11 offset:36928
  ds_read_b64_tr_b16 v[146:147], v11 offset:40000
  ds_read_b64_tr_b16 v[148:149], v11 offset:43072
  ds_read_b64_tr_b16 v[150:151], v11 offset:46144
  s_waitcnt lgkmcnt(8)
  s_waitcnt vmcnt(8)
  v_mfma_f32_16x16x32_bf16 v[32:35], v[128:131], v[176:179], 0
  ds_read_b64_tr_b16 v[152:153], v8 offset:36928
  v_mfma_f32_16x16x32_bf16 v[80:83], v[128:131], v[180:183], 0
  ds_read_b64_tr_b16 v[154:155], v8 offset:40000
  v_mfma_f32_16x16x32_bf16 v[36:39], v[132:135], v[176:179], 0
  ds_read_b64_tr_b16 v[156:157], v8 offset:43072
  v_mfma_f32_16x16x32_bf16 v[84:87], v[132:135], v[180:183], 0
  ds_read_b64_tr_b16 v[158:159], v8 offset:46144
  s_add_u32 s66, s66, 4096
  s_add_u32 s67, s67, 4096
  buffer_load_dwordx4 v[208:211], v15, s[36:39], s66 offen offset:0 sc1
  s_waitcnt lgkmcnt(8)
  v_mfma_f32_16x16x32_bf16 v[40:43], v[136:139], v[176:179], 0
  ds_read_b64_tr_b16 v[160:161], v11 offset:36992
  v_mfma_f32_16x16x32_bf16 v[88:91], v[136:139], v[180:183], 0
  ds_read_b64_tr_b16 v[162:163], v11 offset:40064
  v_mfma_f32_16x16x32_bf16 v[44:47], v[140:143], v[176:179], 0
  ds_read_b64_tr_b16 v[164:165], v11 offset:43136
  v_mfma_f32_16x16x32_bf16 v[92:95], v[140:143], v[180:183], 0
  ds_read_b64_tr_b16 v[166:167], v11 offset:46208
  s_waitcnt lgkmcnt(8)
  v_mfma_f32_16x16x32_bf16 v[48:51], v[144:147], v[176:179], 0
  ds_read_b64_tr_b16 v[168:169], v8 offset:36992
  v_mfma_f32_16x16x32_bf16 v[96:99], v[144:147], v[180:183], 0
  ds_read_b64_tr_b16 v[170:171], v8 offset:40064
  buffer_load_dwordx4 v[212:215], v15, s[36:39], s67 offen offset:0 sc1
  v_mfma_f32_16x16x32_bf16 v[52:55], v[148:151], v[176:179], 0
  ds_read_b64_tr_b16 v[172:173], v8 offset:43136
  v_mfma_f32_16x16x32_bf16 v[100:103], v[148:151], v[180:183], 0
  ds_read_b64_tr_b16 v[174:175], v8 offset:46208
  s_waitcnt lgkmcnt(8)
  v_mfma_f32_16x16x32_bf16 v[56:59], v[152:155], v[176:179], 0
  ds_read_b64_tr_b16 v[128:129], v10 offset:0
  v_mfma_f32_16x16x32_bf16 v[104:107], v[152:155], v[180:183], 0
  ds_read_b64_tr_b16 v[130:131], v10 offset:3072
  v_mfma_f32_16x16x32_bf16 v[60:63], v[156:159], v[176:179], 0
  ds_read_b64_tr_b16 v[132:133], v10 offset:6144
  v_mfma_f32_16x16x32_bf16 v[108:111], v[156:159], v[180:183], 0
  ds_read_b64_tr_b16 v[134:135], v10 offset:9216
  buffer_load_dwordx4 v[216:219], v15, s[36:39], s66 offen offset:2048 sc1
  s_waitcnt lgkmcnt(8)
  v_mfma_f32_16x16x32_bf16 v[64:67], v[160:163], v[176:179], 0
  ds_read_b64_tr_b16 v[136:137], v7 offset:0
  v_mfma_f32_16x16x32_bf16 v[112:115], v[160:163], v[180:183], 0
  ds_read_b64_tr_b16 v[138:139], v7 offset:3072
  v_mfma_f32_16x16x32_bf16 v[68:71], v[164:167], v[176:179], 0
  ds_read_b64_tr_b16 v[140:141], v7 offset:6144
  v_mfma_f32_16x16x32_bf16 v[116:119], v[164:167], v[180:183], 0
  ds_read_b64_tr_b16 v[142:143], v7 offset:9216
  s_waitcnt lgkmcnt(8)
  v_mfma_f32_16x16x32_bf16 v[72:75], v[168:171], v[176:179], 0
  ds_read_b64_tr_b16 v[144:145], v10 offset:64
  v_mfma_f32_16x16x32_bf16 v[120:123], v[168:171], v[180:183], 0
  ds_read_b64_tr_b16 v[146:147], v10 offset:3136
  buffer_load_dwordx4 v[220:223], v15, s[36:39], s67 offen offset:2048 sc1
  v_mfma_f32_16x16x32_bf16 v[76:79], v[172:175], v[176:179], 0
  ds_read_b64_tr_b16 v[148:149], v10 offset:6208
  v_mfma_f32_16x16x32_bf16 v[124:127], v[172:175], v[180:183], 0
  ds_read_b64_tr_b16 v[150:151], v10 offset:9280
  ds_read_b32 v31, v29 offset:32
  s_waitcnt lgkmcnt(9)
  s_waitcnt vmcnt(8)
  v_mfma_f32_16x16x32_bf16 v[32:35], v[128:131], v[184:187], v[32:35]
  ds_read_b64_tr_b16 v[152:153], v7 offset:64
  v_mfma_f32_16x16x32_bf16 v[80:83], v[128:131], v[188:191], v[80:83]
  ds_read_b64_tr_b16 v[154:155], v7 offset:3136
  v_mfma_f32_16x16x32_bf16 v[36:39], v[132:135], v[184:187], v[36:39]
  ds_read_b64_tr_b16 v[156:157], v7 offset:6208
  v_mfma_f32_16x16x32_bf16 v[84:87], v[132:135], v[188:191], v[84:87]
  ds_read_b64_tr_b16 v[158:159], v7 offset:9280
  s_add_u32 s66, s66, 4096
  s_add_u32 s67, s67, 4096
  buffer_load_dwordx4 v[224:227], v15, s[36:39], s66 offen offset:0 sc1
  s_waitcnt lgkmcnt(9)
  v_mfma_f32_16x16x32_bf16 v[40:43], v[136:139], v[184:187], v[40:43]
  ds_read_b64_tr_b16 v[160:161], v10 offset:128
  v_mfma_f32_16x16x32_bf16 v[88:91], v[136:139], v[188:191], v[88:91]
  ds_read_b64_tr_b16 v[162:163], v10 offset:3200
  v_mfma_f32_16x16x32_bf16 v[44:47], v[140:143], v[184:187], v[44:47]
  ds_read_b64_tr_b16 v[164:165], v10 offset:6272
  v_mfma_f32_16x16x32_bf16 v[92:95], v[140:143], v[188:191], v[92:95]
  ds_read_b64_tr_b16 v[166:167], v10 offset:9344
  s_waitcnt lgkmcnt(9)
  v_mfma_f32_16x16x32_bf16 v[48:51], v[144:147], v[184:187], v[48:51]
  ds_read_b64_tr_b16 v[168:169], v7 offset:128
  v_mfma_f32_16x16x32_bf16 v[96:99], v[144:147], v[188:191], v[96:99]
  ds_read_b64_tr_b16 v[170:171], v7 offset:3200
  buffer_load_dwordx4 v[228:231], v15, s[36:39], s67 offen offset:0 sc1
  v_mfma_f32_16x16x32_bf16 v[52:55], v[148:151], v[184:187], v[52:55]
  ds_read_b64_tr_b16 v[172:173], v7 offset:6272
  v_mfma_f32_16x16x32_bf16 v[100:103], v[148:151], v[188:191], v[100:103]
  ds_read_b64_tr_b16 v[174:175], v7 offset:9344
  s_mov_b64 exec, 1
  ds_add_u32 v29, v30 offset:184
  s_mov_b64 exec, -1
  s_waitcnt lgkmcnt(13)
  v_readfirstlane_b32 s56, v31
  s_cmp_ge_u32 s56, 4
  s_cbranch_scc1 L_fl15_ok
  s_mov_b32 s57, 0
L_fl15:
  ds_read_b32 v31, v29 offset:32
  s_waitcnt lgkmcnt(0)
  v_readfirstlane_b32 s56, v31
  s_add_u32 s57, s57, 1
  s_cmp_ge_u32 s56, 4
  s_cbranch_scc1 L_fl15_ok
  s_cmp_lt_u32 s57, 1048576
  s_cbranch_scc1 L_fl15
L_fl15_ok:
  s_waitcnt lgkmcnt(9)
  v_mfma_f32_16x16x32_bf16 v[56:59], v[152:155], v[184:187], v[56:59]
  ds_read_b64_tr_b16 v[128:129], v11 offset:49152
  v_mfma_f32_16x16x32_bf16 v[104:107], v[152:155], v[188:191], v[104:107]
  ds_read_b64_tr_b16 v[130:131], v11 offset:52224
  v_mfma_f32_16x16x32_bf16 v[60:63], v[156:159], v[184:187], v[60:63]
  ds_read_b64_tr_b16 v[132:133], v11 offset:55296
  v_mfma_f32_16x16x32_bf16 v[108:111], v[156:159], v[188:191], v[108:111]
  ds_read_b64_tr_b16 v[134:135], v11 offset:58368
  buffer_load_dwordx4 v[232:235], v15, s[36:39], s66 offen offset:2048 sc1
  s_waitcnt lgkmcnt(9)
  v_mfma_f32_16x16x32_bf16 v[64:67], v[160:163], v[184:187], v[64:67]
  ds_read_b64_tr_b16 v[136:137], v8 offset:49152
  v_mfma_f32_16x16x32_bf16 v[112:115], v[160:163], v[188:191], v[112:115]
  ds_read_b64_tr_b16 v[138:139], v8 offset:52224
  v_mfma_f32_16x16x32_bf16 v[68:71], v[164:167], v[184:187], v[68:71]
  ds_read_b64_tr_b16 v[140:141], v8 offset:55296
  v_mfma_f32_16x16x32_bf16 v[116:119], v[164:167], v[188:191], v[116:119]
  ds_read_b64_tr_b16 v[142:143], v8 offset:58368
  s_waitcnt lgkmcnt(9)
  v_mfma_f32_16x16x32_bf16 v[72:75], v[168:171], v[184:187], v[72:75]
  ds_read_b64_tr_b16 v[144:145], v11 offset:49216
  v_mfma_f32_16x16x32_bf16 v[120:123], v[168:171], v[188:191], v[120:123]
  ds_read_b64_tr_b16 v[146:147], v11 offset:52288
  buffer_load_dwordx4 v[236:239], v15, s[36:39], s67 offen offset:2048 sc1
  v_mfma_f32_16x16x32_bf16 v[76:79], v[172:175], v[184:187], v[76:79]
  ds_read_b64_tr_b16 v[148:149], v11 offset:55360
  v_mfma_f32_16x16x32_bf16 v[124:127], v[172:175], v[188:191], v[124:127]
  ds_read_b64_tr_b16 v[150:151], v11 offset:58432
  s_waitcnt lgkmcnt(8)
  s_waitcnt vmcnt(10)
  v_mfma_f32_16x16x32_bf16 v[32:35], v[128:131], v[192:195], v[32:35]
  ds_read_b64_tr_b16 v[152:153], v8 offset:49216
  v_mfma_f32_16x16x32_bf16 v[80:83], v[128:131], v[196:199], v[80:83]
  ds_read_b64_tr_b16 v[154:155], v8 offset:52288
  v_mfma_f32_16x16x32_bf16 v[36:39], v[132:135], v[192:195], v[36:39]
  ds_read_b64_tr_b16 v[156:157], v8 offset:55360
  v_mfma_f32_16x16x32_bf16 v[84:87], v[132:135], v[196:199], v[84:87]
  ds_read_b64_tr_b16 v[158:159], v8 offset:58432
  s_add_u32 s66, s66, 4096
  s_add_u32 s67, s67, 4096
  buffer_load_dwordx4 v[176:179], v15, s[36:39], s66 offen offset:0 sc1
  s_waitcnt lgkmcnt(8)
  v_mfma_f32_16x16x32_bf16 v[40:43], v[136:139], v[192:195], v[40:43]
  ds_read_b64_tr_b16 v[160:161], v11 offset:49280
  v_mfma_f32_16x16x32_bf16 v[88:91], v[136:139], v[196:199], v[88:91]
  ds_read_b64_tr_b16 v[162:163], v11 offset:52352
  v_mfma_f32_16x16x32_bf16 v[44:47], v[140:143], v[192:195], v[44:47]
  ds_read_b64_tr_b16 v[164:165], v11 offset:55424
  v_mfma_f32_16x16x32_bf16 v[92:95], v[140:143], v[196:199], v[92:95]
  ds_read_b64_tr_b16 v[166:167], v11 offset:58496
  s_waitcnt lgkmcnt(8)
  v_mfma_f32_16x16x32_bf16 v[48:51], v[144:147], v[192:195], v[48:51]
  ds_read_b64_tr_b16 v[168:169], v8 offset:49280
  v_mfma_f32_16x16x32_bf16 v[96:99], v[144:147], v[196:199], v[96:99]
  ds_read_b64_tr_b16 v[170:171], v8 offset:52352
  buffer_load_dwordx4 v[180:183], v15, s[36:39], s67 offen offset:0 sc1
  v_mfma_f32_16x16x32_bf16 v[52:55], v[148:151], v[192:195], v[52:55]
  ds_read_b64_tr_b16 v[172:173], v8 offset:55424
  v_mfma_f32_16x16x32_bf16 v[100:103], v[148:151], v[196:199], v[100:103]
  ds_read_b64_tr_b16 v[174:175], v8 offset:58496
  s_waitcnt lgkmcnt(8)
  v_mfma_f32_16x16x32_bf16 v[56:59], v[152:155], v[192:195], v[56:59]
  ds_read_b64_tr_b16 v[128:129], v11 offset:61440
  v_mfma_f32_16x16x32_bf16 v[104:107], v[152:155], v[196:199], v[104:107]
  ds_read_b64_tr_b16 v[130:131], v11 offset:64512
  v_mfma_f32_16x16x32_bf16 v[60:63], v[156:159], v[192:195], v[60:63]
  ds_read_b64_tr_b16 v[132:133], v12 offset:2048
  v_mfma_f32_16x16x32_bf16 v[108:111], v[156:159], v[196:199], v[108:111]
  ds_read_b64_tr_b16 v[134:135], v12 offset:5120
  buffer_load_dwordx4 v[184:187], v15, s[36:39], s66 offen offset:2048 sc1
  s_waitcnt lgkmcnt(8)
  v_mfma_f32_16x16x32_bf16 v[64:67], v[160:163], v[192:195], v[64:67]
  ds_read_b64_tr_b16 v[136:137], v8 offset:61440
  v_mfma_f32_16x16x32_bf16 v[112:115], v[160:163], v[196:199], v[112:115]
  ds_read_b64_tr_b16 v[138:139], v8 offset:64512
  v_mfma_f32_16x16x32_bf16 v[68:71], v[164:167], v[192:195], v[68:71]
  ds_read_b64_tr_b16 v[140:141], v9 offset:2048
  v_mfma_f32_16x16x32_bf16 v[116:119], v[164:167], v[196:199], v[116:119]
  ds_read_b64_tr_b16 v[142:143], v9 offset:5120
  s_waitcnt lgkmcnt(8)
  v_mfma_f32_16x16x32_bf16 v[72:75], v[168:171], v[192:195], v[72:75]
  ds_read_b64_tr_b16 v[144:145], v11 offset:61504
  v_mfma_f32_16x16x32_bf16 v[120:123], v[168:171], v[196:199], v[120:123]
  ds_read_b64_tr_b16 v[146:147], v11 offset:64576
  v_mfma_f32_16x16x32_bf16 v[76:79], v[172:175], v[192:195], v[76:79]
  ds_read_b64_tr_b16 v[148:149], v12 offset:2112
  v_mfma_f32_16x16x32_bf16 v[124:127], v[172:175], v[196:199], v[124:127]
  ds_read_b64_tr_b16 v[150:151], v12 offset:5184
  ds_read_b32 v31, v29 offset:40
  s_waitcnt lgkmcnt(9)
  s_waitcnt vmcnt(11)
  v_mfma_f32_16x16x32_bf16 v[32:35], v[128:131], v[200:203], v[32:35]
  ds_read_b64_tr_b16 v[152:153], v8 offset:61504
  v_mfma_f32_16x16x32_bf16 v[80:83], v[128:131], v[204:207], v[80:83]
  ds_read_b64_tr_b16 v[154:155], v8 offset:64576
  v_mfma_f32_16x16x32_bf16 v[36:39], v[132:135], v[200:203], v[36:39]
  ds_read_b64_tr_b16 v[156:157], v9 offset:2112
  v_mfma_f32_16x16x32_bf16 v[84:87], v[132:135], v[204:207], v[84:87]
  ds_read_b64_tr_b16 v[158:159], v9 offset:5184
  buffer_load_dwordx4 v[188:191], v15, s[36:39], s67 offen offset:2048 sc1
  s_waitcnt lgkmcnt(9)
  v_mfma_f32_16x16x32_bf16 v[40:43], v[136:139], v[200:203], v[40:43]
  ds_read_b64_tr_b16 v[160:161], v11 offset:61568
  v_mfma_f32_16x16x32_bf16 v[88:91], v[136:139], v[204:207], v[88:91]
  ds_read_b64_tr_b16 v[162:163], v11 offset:64640
  v_mfma_f32_16x16x32_bf16 v[44:47], v[140:143], v[200:203], v[44:47]
  ds_read_b64_tr_b16 v[164:165], v12 offset:2176
  v_mfma_f32_16x16x32_bf16 v[92:95], v[140:143], v[204:207], v[92:95]
  ds_read_b64_tr_b16 v[166:167], v12 offset:5248
  s_waitcnt lgkmcnt(9)
  v_mfma_f32_16x16x32_bf16 v[48:51], v[144:147], v[200:203], v[48:51]
  ds_read_b64_tr_b16 v[168:169], v8 offset:61568
  v_mfma_f32_16x16x32_bf16 v[96:99], v[144:147], v[204:207], v[96:99]
  ds_read_b64_tr_b16 v[170:171], v8 offset:64640
  v_mfma_f32_16x16x32_bf16 v[52:55], v[148:151], v[200:203], v[52:55]
  ds_read_b64_tr_b16 v[172:173], v9 offset:2176
  v_mfma_f32_16x16x32_bf16 v[100:103], v[148:151], v[204:207], v[100:103]
  ds_read_b64_tr_b16 v[174:175], v9 offset:5248
  s_mov_b64 exec, 1
  ds_add_u32 v29, v30 offset:188
  s_mov_b64 exec, -1
  s_waitcnt lgkmcnt(13)
  v_readfirstlane_b32 s56, v31
  s_cmp_ge_u32 s56, 4
  s_cbranch_scc1 L_fl16_ok
  s_mov_b32 s57, 0
L_fl16:
  ds_read_b32 v31, v29 offset:40
  s_waitcnt lgkmcnt(0)
  v_readfirstlane_b32 s56, v31
  s_add_u32 s57, s57, 1
  s_cmp_ge_u32 s56, 4
  s_cbranch_scc1 L_fl16_ok
  s_cmp_lt_u32 s57, 1048576
  s_cbranch_scc1 L_fl16
L_fl16_ok:
  s_waitcnt lgkmcnt(9)
  v_mfma_f32_16x16x32_bf16 v[56:59], v[152:155], v[200:203], v[56:59]
  ds_read_b64_tr_b16 v[128:129], v12 offset:8192
  v_mfma_f32_16x16x32_bf16 v[104:107], v[152:155], v[204:207], v[104:107]
  ds_read_b64_tr_b16 v[130:131], v12 offset:11264
  v_mfma_f32_16x16x32_bf16 v[60:63], v[156:159], v[200:203], v[60:63]
  ds_read_b64_tr_b16 v[132:133], v12 offset:14336
  v_mfma_f32_16x16x32_bf16 v[108:111], v[156:159], v[204:207], v[108:111]
  ds_read_b64_tr_b16 v[134:135], v12 offset:17408
  s_add_u32 s66, s66, 4096
  s_add_u32 s67, s67, 4096
  buffer_load_dwordx4 v[192:195], v15, s[36:39], s66 offen offset:0 sc1
  s_waitcnt lgkmcnt(9)
  v_mfma_f32_16x16x32_bf16 v[64:67], v[160:163], v[200:203], v[64:67]
  ds_read_b64_tr_b16 v[136:137], v9 offset:8192
  v_mfma_f32_16x16x32_bf16 v[112:115], v[160:163], v[204:207], v[112:115]
  ds_read_b64_tr_b16 v[138:139], v9 offset:11264
  v_mfma_f32_16x16x32_bf16 v[68:71], v[164:167], v[200:203], v[68:71]
  ds_read_b64_tr_b16 v[140:141], v9 offset:14336
  v_mfma_f32_16x16x32_bf16 v[116:119], v[164:167], v[204:207], v[116:119]
  ds_read_b64_tr_b16 v[142:143], v9 offset:17408
  s_waitcnt lgkmcnt(9)
  v_mfma_f32_16x16x32_bf16 v[72:75], v[168:171], v[200:203], v[72:75]
  ds_read_b64_tr_b16 v[144:145], v12 offset:8256
  v_mfma_f32_16x16x32_bf16 v[120:123], v[168:171], v[204:207], v[120:123]
  ds_read_b64_tr_b16 v[146:147], v12 offset:11328
  v_mfma_f32_16x16x32_bf16 v[76:79], v[172:175], v[200:203], v[76:79]
  ds_read_b64_tr_b16 v[148:149], v12 offset:14400
  v_mfma_f32_16x16x32_bf16 v[124:127], v[172:175], v[204:207], v[124:127]
  ds_read_b64_tr_b16 v[150:151], v12 offset:17472
  s_waitcnt lgkmcnt(8)
  s_waitcnt vmcnt(11)
  v_mfma_f32_16x16x32_bf16 v[32:35], v[128:131], v[208:211], v[32:35]
  ds_read_b64_tr_b16 v[152:153], v9 offset:8256
  v_mfma_f32_16x16x32_bf16 v[80:83], v[128:131], v[212:215], v[80:83]
  ds_read_b64_tr_b16 v[154:155], v9 offset:11328
  v_mfma_f32_16x16x32_bf16 v[36:39], v[132:135], v[208:211], v[36:39]
  ds_read_b64_tr_b16 v[156:157], v9 offset:14400
  v_mfma_f32_16x16x32_bf16 v[84:87], v[132:135], v[212:215], v[84:87]
  ds_read_b64_tr_b16 v[158:159], v9 offset:17472
  buffer_load_dwordx4 v[196:199], v15, s[36:39], s67 offen offset:0 sc1
  s_waitcnt lgkmcnt(8)
  v_mfma_f32_16x16x32_bf16 v[40:43], v[136:139], v[208:211], v[40:43]
  ds_read_b64_tr_b16 v[160:161], v12 offset:8320
  v_mfma_f32_16x16x32_bf16 v[88:91], v[136:139], v[212:215], v[88:91]
  ds_read_b64_tr_b16 v[162:163], v12 offset:11392
  v_mfma_f32_16x16x32_bf16 v[44:47], v[140:143], v[208:211], v[44:47]
  ds_read_b64_tr_b16 v[164:165], v12 offset:14464
  v_mfma_f32_16x16x32_bf16 v[92:95], v[140:143], v[212:215], v[92:95]
  ds_read_b64_tr_b16 v[166:167], v12 offset:17536
  s_waitcnt lgkmcnt(8)
  v_mfma_f32_16x16x32_bf16 v[48:51], v[144:147], v[208:211], v[48:51]
  ds_read_b64_tr_b16 v[168:169], v9 offset:8320
  v_mfma_f32_16x16x32_bf16 v[96:99], v[144:147], v[212:215], v[96:99]
  ds_read_b64_tr_b16 v[170:171], v9 offset:11392
  v_mfma_f32_16x16x32_bf16 v[52:55], v[148:151], v[208:211], v[52:55]
  ds_read_b64_tr_b16 v[172:173], v9 offset:14464
  v_mfma_f32_16x16x32_bf16 v[100:103], v[148:151], v[212:215], v[100:103]
  ds_read_b64_tr_b16 v[174:175], v9 offset:17536
  s_waitcnt lgkmcnt(8)
  v_mfma_f32_16x16x32_bf16 v[56:59], v[152:155], v[208:211], v[56:59]
  ds_read_b64_tr_b16 v[128:129], v10 offset:12288
  v_mfma_f32_16x16x32_bf16 v[104:107], v[152:155], v[212:215], v[104:107]
  ds_read_b64_tr_b16 v[130:131], v10 offset:15360
  v_mfma_f32_16x16x32_bf16 v[60:63], v[156:159], v[208:211], v[60:63]
  ds_read_b64_tr_b16 v[132:133], v10 offset:18432
  v_mfma_f32_16x16x32_bf16 v[108:111], v[156:159], v[212:215], v[108:111]
  ds_read_b64_tr_b16 v[134:135], v10 offset:21504
  buffer_load_dwordx4 v[200:203], v15, s[36:39], s66 offen offset:2048 sc1
  s_waitcnt lgkmcnt(8)
  v_mfma_f32_16x16x32_bf16 v[64:67], v[160:163], v[208:211], v[64:67]
  ds_read_b64_tr_b16 v[136:137], v7 offset:12288
  v_mfma_f32_16x16x32_bf16 v[112:115], v[160:163], v[212:215], v[112:115]
  ds_read_b64_tr_b16 v[138:139], v7 offset:15360
  v_mfma_f32_16x16x32_bf16 v[68:71], v[164:167], v[208:211], v[68:71]
  ds_read_b64_tr_b16 v[140:141], v7 offset:18432
  v_mfma_f32_16x16x32_bf16 v[116:119], v[164:167], v[212:215], v[116:119]
  ds_read_b64_tr_b16 v[142:143], v7 offset:21504
  s_waitcnt lgkmcnt(8)
  v_mfma_f32_16x16x32_bf16 v[72:75], v[168:171], v[208:211], v[72:75]
  ds_read_b64_tr_b16 v[144:145], v10 offset:12352
  v_mfma_f32_16x16x32_bf16 v[120:123], v[168:171], v[212:215], v[120:123]
  ds_read_b64_tr_b16 v[146:147], v10 offset:15424
  v_mfma_f32_16x16x32_bf16 v[76:79], v[172:175], v[208:211], v[76:79]
  ds_read_b64_tr_b16 v[148:149], v10 offset:18496
  v_mfma_f32_16x16x32_bf16 v[124:127], v[172:175], v[212:215], v[124:127]
  ds_read_b64_tr_b16 v[150:151], v10 offset:21568
  ds_read_b32 v31, v29 offset:48
  s_waitcnt lgkmcnt(9)
  s_waitcnt vmcnt(11)
  v_mfma_f32_16x16x32_bf16 v[32:35], v[128:131], v[216:219], v[32:35]
  ds_read_b64_tr_b16 v[152:153], v7 offset:12352
  v_mfma_f32_16x16x32_bf16 v[80:83], v[128:131], v[220:223], v[80:83]
  ds_read_b64_tr_b16 v[154:155], v7 offset:15424
  v_mfma_f32_16x16x32_bf16 v[36:39], v[132:135], v[216:219], v[36:39]
  ds_read_b64_tr_b16 v[156:157], v7 offset:18496
  v_mfma_f32_16x16x32_bf16 v[84:87], v[132:135], v[220:223], v[84:87]
  ds_read_b64_tr_b16 v[158:159], v7 offset:21568
  buffer_load_dwordx4 v[204:207], v15, s[36:39], s67 offen offset:2048 sc1
  s_waitcnt lgkmcnt(9)
  v_mfma_f32_16x16x32_bf16 v[40:43], v[136:139], v[216:219], v[40:43]
  ds_read_b64_tr_b16 v[160:161], v10 offset:12416
  v_mfma_f32_16x16x32_bf16 v[88:91], v[136:139], v[220:223], v[88:91]
  ds_read_b64_tr_b16 v[162:163], v10 offset:15488
  v_mfma_f32_16x16x32_bf16 v[44:47], v[140:143], v[216:219], v[44:47]
  ds_read_b64_tr_b16 v[164:165], v10 offset:18560
  v_mfma_f32_16x16x32_bf16 v[92:95], v[140:143], v[220:223], v[92:95]
  ds_read_b64_tr_b16 v[166:167], v10 offset:21632
  s_waitcnt lgkmcnt(9)
  v_mfma_f32_16x16x32_bf16 v[48:51], v[144:147], v[216:219], v[48:51]
  ds_read_b64_tr_b16 v[168:169], v7 offset:12416
  v_mfma_f32_16x16x32_bf16 v[96:99], v[144:147], v[220:223], v[96:99]
  ds_read_b64_tr_b16 v[170:171], v7 offset:15488
  v_mfma_f32_16x16x32_bf16 v[52:55], v[148:151], v[216:219], v[52:55]
  ds_read_b64_tr_b16 v[172:173], v7 offset:18560
  v_mfma_f32_16x16x32_bf16 v[100:103], v[148:151], v[220:223], v[100:103]
  ds_read_b64_tr_b16 v[174:175], v7 offset:21632
  s_mov_b64 exec, 1
  ds_add_u32 v29, v30 offset:192
  s_mov_b64 exec, -1
  s_waitcnt lgkmcnt(13)
  v_readfirstlane_b32 s56, v31
  s_cmp_ge_u32 s56, 4
  s_cbranch_scc1 L_fl17_ok
  s_mov_b32 s57, 0
L_fl17:
  ds_read_b32 v31, v29 offset:48
  s_waitcnt lgkmcnt(0)
  v_readfirstlane_b32 s56, v31
  s_add_u32 s57, s57, 1
  s_cmp_ge_u32 s56, 4
  s_cbranch_scc1 L_fl17_ok
  s_cmp_lt_u32 s57, 1048576
  s_cbranch_scc1 L_fl17
L_fl17_ok:
  s_waitcnt lgkmcnt(9)
  v_mfma_f32_16x16x32_bf16 v[56:59], v[152:155], v[216:219], v[56:59]
  ds_read_b64_tr_b16 v[128:129], v10 offset:24576
  v_mfma_f32_16x16x32_bf16 v[104:107], v[152:155], v[220:223], v[104:107]
  ds_read_b64_tr_b16 v[130:131], v10 offset:27648
  v_mfma_f32_16x16x32_bf16 v[60:63], v[156:159], v[216:219], v[60:63]
  ds_read_b64_tr_b16 v[132:133], v10 offset:30720
  v_mfma_f32_16x16x32_bf16 v[108:111], v[156:159], v[220:223], v[108:111]
  ds_read_b64_tr_b16 v[134:135], v10 offset:33792
  s_add_u32 s66, s66, 4096
  s_add_u32 s67, s67, 4096
  buffer_load_dwordx4 v[208:211], v15, s[36:39], s66 offen offset:0 sc1
  s_waitcnt lgkmcnt(9)
  v_mfma_f32_16x16x32_bf16 v[64:67], v[160:163], v[216:219], v[64:67]
  ds_read_b64_tr_b16 v[136:137], v7 offset:24576
  v_mfma_f32_16x16x32_bf16 v[112:115], v[160:163], v[220:223], v[112:115]
  ds_read_b64_tr_b16 v[138:139], v7 offset:27648
  v_mfma_f32_16x16x32_bf16 v[68:71], v[164:167], v[216:219], v[68:71]
  ds_read_b64_tr_b16 v[140:141], v7 offset:30720
  v_mfma_f32_16x16x32_bf16 v[116:119], v[164:167], v[220:223], v[116:119]
  ds_read_b64_tr_b16 v[142:143], v7 offset:33792
  s_waitcnt lgkmcnt(9)
  v_mfma_f32_16x16x32_bf16 v[72:75], v[168:171], v[216:219], v[72:75]
  ds_read_b64_tr_b16 v[144:145], v10 offset:24640
  v_mfma_f32_16x16x32_bf16 v[120:123], v[168:171], v[220:223], v[120:123]
  ds_read_b64_tr_b16 v[146:147], v10 offset:27712
  v_mfma_f32_16x16x32_bf16 v[76:79], v[172:175], v[216:219], v[76:79]
  ds_read_b64_tr_b16 v[148:149], v10 offset:30784
  v_mfma_f32_16x16x32_bf16 v[124:127], v[172:175], v[220:223], v[124:127]
  ds_read_b64_tr_b16 v[150:151], v10 offset:33856
  s_waitcnt lgkmcnt(8)
  s_waitcnt vmcnt(11)
  v_mfma_f32_16x16x32_bf16 v[32:35], v[128:131], v[224:227], v[32:35]
  ds_read_b64_tr_b16 v[152:153], v7 offset:24640
  v_mfma_f32_16x16x32_bf16 v[80:83], v[128:131], v[228:231], v[80:83]
  ds_read_b64_tr_b16 v[154:155], v7 offset:27712
  v_mfma_f32_16x16x32_bf16 v[36:39], v[132:135], v[224:227], v[36:39]
  ds_read_b64_tr_b16 v[156:157], v7 offset:30784
  v_mfma_f32_16x16x32_bf16 v[84:87], v[132:135], v[228:231], v[84:87]
  ds_read_b64_tr_b16 v[158:159], v7 offset:33856
  buffer_load_dwordx4 v[212:215], v15, s[36:39], s67 offen offset:0 sc1
  s_waitcnt lgkmcnt(8)
  v_mfma_f32_16x16x32_bf16 v[40:43], v[136:139], v[224:227], v[40:43]
  ds_read_b64_tr_b16 v[160:161], v10 offset:24704
  v_mfma_f32_16x16x32_bf16 v[88:91], v[136:139], v[228:231], v[88:91]
  ds_read_b64_tr_b16 v[162:163], v10 offset:27776
  v_mfma_f32_16x16x32_bf16 v[44:47], v[140:143], v[224:227], v[44:47]
  ds_read_b64_tr_b16 v[164:165], v10 offset:30848
  v_mfma_f32_16x16x32_bf16 v[92:95], v[140:143], v[228:231], v[92:95]
  ds_read_b64_tr_b16 v[166:167], v10 offset:33920
  s_waitcnt lgkmcnt(8)
  v_mfma_f32_16x16x32_bf16 v[48:51], v[144:147], v[224:227], v[48:51]
  ds_read_b64_tr_b16 v[168:169], v7 offset:24704
  v_mfma_f32_16x16x32_bf16 v[96:99], v[144:147], v[228:231], v[96:99]
  ds_read_b64_tr_b16 v[170:171], v7 offset:27776
  v_mfma_f32_16x16x32_bf16 v[52:55], v[148:151], v[224:227], v[52:55]
  ds_read_b64_tr_b16 v[172:173], v7 offset:30848
  v_mfma_f32_16x16x32_bf16 v[100:103], v[148:151], v[228:231], v[100:103]
  ds_read_b64_tr_b16 v[174:175], v7 offset:33920
  s_waitcnt lgkmcnt(8)
  v_mfma_f32_16x16x32_bf16 v[56:59], v[152:155], v[224:227], v[56:59]
  ds_read_b64_tr_b16 v[128:129], v10 offset:36864
  v_mfma_f32_16x16x32_bf16 v[104:107], v[152:155], v[228:231], v[104:107]
  ds_read_b64_tr_b16 v[130:131], v10 offset:39936
  v_mfma_f32_16x16x32_bf16 v[60:63], v[156:159], v[224:227], v[60:63]
  ds_read_b64_tr_b16 v[132:133], v10 offset:43008
  v_mfma_f32_16x16x32_bf16 v[108:111], v[156:159], v[228:231], v[108:111]
  ds_read_b64_tr_b16 v[134:135], v10 offset:46080
  buffer_load_dwordx4 v[216:219], v15, s[36:39], s66 offen offset:2048 sc1
  s_waitcnt lgkmcnt(8)
  v_mfma_f32_16x16x32_bf16 v[64:67], v[160:163], v[224:227], v[64:67]
  ds_read_b64_tr_b16 v[136:137], v7 offset:36864
  v_mfma_f32_16x16x32_bf16 v[112:115], v[160:163], v[228:231], v[112:115]
  ds_read_b64_tr_b16 v[138:139], v7 offset:39936
  v_mfma_f32_16x16x32_bf16 v[68:71], v[164:167], v[224:227], v[68:71]
  ds_read_b64_tr_b16 v[140:141], v7 offset:43008
  v_mfma_f32_16x16x32_bf16 v[116:119], v[164:167], v[228:231], v[116:119]
  ds_read_b64_tr_b16 v[142:143], v7 offset:46080
  s_waitcnt lgkmcnt(8)
  v_mfma_f32_16x16x32_bf16 v[72:75], v[168:171], v[224:227], v[72:75]
  ds_read_b64_tr_b16 v[144:145], v10 offset:36928
  v_mfma_f32_16x16x32_bf16 v[120:123], v[168:171], v[228:231], v[120:123]
  ds_read_b64_tr_b16 v[146:147], v10 offset:40000
  v_mfma_f32_16x16x32_bf16 v[76:79], v[172:175], v[224:227], v[76:79]
  ds_read_b64_tr_b16 v[148:149], v10 offset:43072
  v_mfma_f32_16x16x32_bf16 v[124:127], v[172:175], v[228:231], v[124:127]
  ds_read_b64_tr_b16 v[150:151], v10 offset:46144
  ds_read_b32 v31, v29 offset:56
  s_waitcnt lgkmcnt(9)
  s_waitcnt vmcnt(11)
  v_mfma_f32_16x16x32_bf16 v[32:35], v[128:131], v[232:235], v[32:35]
  ds_read_b64_tr_b16 v[152:153], v7 offset:36928
  v_mfma_f32_16x16x32_bf16 v[80:83], v[128:131], v[236:239], v[80:83]
  ds_read_b64_tr_b16 v[154:155], v7 offset:40000
  v_mfma_f32_16x16x32_bf16 v[36:39], v[132:135], v[232:235], v[36:39]
  ds_read_b64_tr_b16 v[156:157], v7 offset:43072
  v_mfma_f32_16x16x32_bf16 v[84:87], v[132:135], v[236:239], v[84:87]
  ds_read_b64_tr_b16 v[158:159], v7 offset:46144
  buffer_load_dwordx4 v[220:223], v15, s[36:39], s67 offen offset:2048 sc1
  s_waitcnt lgkmcnt(9)
  v_mfma_f32_16x16x32_bf16 v[40:43], v[136:139], v[232:235], v[40:43]
  ds_read_b64_tr_b16 v[160:161], v10 offset:36992
  v_mfma_f32_16x16x32_bf16 v[88:91], v[136:139], v[236:239], v[88:91]
  ds_read_b64_tr_b16 v[162:163], v10 offset:40064
  v_mfma_f32_16x16x32_bf16 v[44:47], v[140:143], v[232:235], v[44:47]
  ds_read_b64_tr_b16 v[164:165], v10 offset:43136
  v_mfma_f32_16x16x32_bf16 v[92:95], v[140:143], v[236:239], v[92:95]
  ds_read_b64_tr_b16 v[166:167], v10 offset:46208
  s_waitcnt lgkmcnt(9)
  v_mfma_f32_16x16x32_bf16 v[48:51], v[144:147], v[232:235], v[48:51]
  ds_read_b64_tr_b16 v[168:169], v7 offset:36992
  v_mfma_f32_16x16x32_bf16 v[96:99], v[144:147], v[236:239], v[96:99]
  ds_read_b64_tr_b16 v[170:171], v7 offset:40064
  v_mfma_f32_16x16x32_bf16 v[52:55], v[148:151], v[232:235], v[52:55]
  ds_read_b64_tr_b16 v[172:173], v7 offset:43136
  v_mfma_f32_16x16x32_bf16 v[100:103], v[148:151], v[236:239], v[100:103]
  ds_read_b64_tr_b16 v[174:175], v7 offset:46208
  s_mov_b64 exec, 1
  ds_add_u32 v29, v30 offset:196
  s_mov_b64 exec, -1
  s_waitcnt lgkmcnt(13)
  v_readfirstlane_b32 s56, v31
  s_cmp_ge_u32 s56, 4
  s_cbranch_scc1 L_fl18_ok
  s_mov_b32 s57, 0
L_fl18:
  ds_read_b32 v31, v29 offset:56
  s_waitcnt lgkmcnt(0)
  v_readfirstlane_b32 s56, v31
  s_add_u32 s57, s57, 1
  s_cmp_ge_u32 s56, 4
  s_cbranch_scc1 L_fl18_ok
  s_cmp_lt_u32 s57, 1048576
  s_cbranch_scc1 L_fl18
L_fl18_ok:
  s_waitcnt lgkmcnt(9)
  v_mfma_f32_16x16x32_bf16 v[56:59], v[152:155], v[232:235], v[56:59]
  ds_read_b64_tr_b16 v[128:129], v10 offset:49152
  v_mfma_f32_16x16x32_bf16 v[104:107], v[152:155], v[236:239], v[104:107]
  ds_read_b64_tr_b16 v[130:131], v10 offset:52224
  v_mfma_f32_16x16x32_bf16 v[60:63], v[156:159], v[232:235], v[60:63]
  ds_read_b64_tr_b16 v[132:133], v10 offset:55296
  v_mfma_f32_16x16x32_bf16 v[108:111], v[156:159], v[236:239], v[108:111]
  ds_read_b64_tr_b16 v[134:135], v10 offset:58368
  s_add_u32 s66, s66, 4096
  s_add_u32 s67, s67, 4096
  buffer_load_dwordx4 v[224:227], v15, s[36:39], s66 offen offset:0 sc1
  s_waitcnt lgkmcnt(9)
  v_mfma_f32_16x16x32_bf16 v[64:67], v[160:163], v[232:235], v[64:67]
  ds_read_b64_tr_b16 v[136:137], v7 offset:49152
  v_mfma_f32_16x16x32_bf16 v[112:115], v[160:163], v[236:239], v[112:115]
  ds_read_b64_tr_b16 v[138:139], v7 offset:52224
  v_mfma_f32_16x16x32_bf16 v[68:71], v[164:167], v[232:235], v[68:71]
  ds_read_b64_tr_b16 v[140:141], v7 offset:55296
  v_mfma_f32_16x16x32_bf16 v[116:119], v[164:167], v[236:239], v[116:119]
  ds_read_b64_tr_b16 v[142:143], v7 offset:58368
  s_waitcnt lgkmcnt(9)
  v_mfma_f32_16x16x32_bf16 v[72:75], v[168:171], v[232:235], v[72:75]
  ds_read_b64_tr_b16 v[144:145], v10 offset:49216
  v_mfma_f32_16x16x32_bf16 v[120:123], v[168:171], v[236:239], v[120:123]
  ds_read_b64_tr_b16 v[146:147], v10 offset:52288
  v_mfma_f32_16x16x32_bf16 v[76:79], v[172:175], v[232:235], v[76:79]
  ds_read_b64_tr_b16 v[148:149], v10 offset:55360
  v_mfma_f32_16x16x32_bf16 v[124:127], v[172:175], v[236:239], v[124:127]
  ds_read_b64_tr_b16 v[150:151], v10 offset:58432
  s_waitcnt lgkmcnt(8)
  s_waitcnt vmcnt(11)
  v_mfma_f32_16x16x32_bf16 v[32:35], v[128:131], v[176:179], v[32:35]
  ds_read_b64_tr_b16 v[152:153], v7 offset:49216
  v_mfma_f32_16x16x32_bf16 v[80:83], v[128:131], v[180:183], v[80:83]
  ds_read_b64_tr_b16 v[154:155], v7 offset:52288
  v_mfma_f32_16x16x32_bf16 v[36:39], v[132:135], v[176:179], v[36:39]
  ds_read_b64_tr_b16 v[156:157], v7 offset:55360
  v_mfma_f32_16x16x32_bf16 v[84:87], v[132:135], v[180:183], v[84:87]
  ds_read_b64_tr_b16 v[158:159], v7 offset:58432
  buffer_load_dwordx4 v[228:231], v15, s[36:39], s67 offen offset:0 sc1
  s_waitcnt lgkmcnt(8)
  v_mfma_f32_16x16x32_bf16 v[40:43], v[136:139], v[176:179], v[40:43]
  ds_read_b64_tr_b16 v[160:161], v10 offset:49280
  v_mfma_f32_16x16x32_bf16 v[88:91], v[136:139], v[180:183], v[88:91]
  ds_read_b64_tr_b16 v[162:163], v10 offset:52352
  v_mfma_f32_16x16x32_bf16 v[44:47], v[140:143], v[176:179], v[44:47]
  ds_read_b64_tr_b16 v[164:165], v10 offset:55424
  v_mfma_f32_16x16x32_bf16 v[92:95], v[140:143], v[180:183], v[92:95]
  ds_read_b64_tr_b16 v[166:167], v10 offset:58496
  s_waitcnt lgkmcnt(8)
  v_mfma_f32_16x16x32_bf16 v[48:51], v[144:147], v[176:179], v[48:51]
  ds_read_b64_tr_b16 v[168:169], v7 offset:49280
  v_mfma_f32_16x16x32_bf16 v[96:99], v[144:147], v[180:183], v[96:99]
  ds_read_b64_tr_b16 v[170:171], v7 offset:52352
  v_mfma_f32_16x16x32_bf16 v[52:55], v[148:151], v[176:179], v[52:55]
  ds_read_b64_tr_b16 v[172:173], v7 offset:55424
  v_mfma_f32_16x16x32_bf16 v[100:103], v[148:151], v[180:183], v[100:103]
  ds_read_b64_tr_b16 v[174:175], v7 offset:58496
  s_waitcnt lgkmcnt(8)
  v_mfma_f32_16x16x32_bf16 v[56:59], v[152:155], v[176:179], v[56:59]
  ds_read_b64_tr_b16 v[128:129], v10 offset:61440
  v_mfma_f32_16x16x32_bf16 v[104:107], v[152:155], v[180:183], v[104:107]
  ds_read_b64_tr_b16 v[130:131], v10 offset:64512
  v_mfma_f32_16x16x32_bf16 v[60:63], v[156:159], v[176:179], v[60:63]
  ds_read_b64_tr_b16 v[132:133], v11 offset:2048
  v_mfma_f32_16x16x32_bf16 v[108:111], v[156:159], v[180:183], v[108:111]
  ds_read_b64_tr_b16 v[134:135], v11 offset:5120
  buffer_load_dwordx4 v[232:235], v15, s[36:39], s66 offen offset:2048 sc1
  s_waitcnt lgkmcnt(8)
  v_mfma_f32_16x16x32_bf16 v[64:67], v[160:163], v[176:179], v[64:67]
  ds_read_b64_tr_b16 v[136:137], v7 offset:61440
  v_mfma_f32_16x16x32_bf16 v[112:115], v[160:163], v[180:183], v[112:115]
  ds_read_b64_tr_b16 v[138:139], v7 offset:64512
  v_mfma_f32_16x16x32_bf16 v[68:71], v[164:167], v[176:179], v[68:71]
  ds_read_b64_tr_b16 v[140:141], v8 offset:2048
  v_mfma_f32_16x16x32_bf16 v[116:119], v[164:167], v[180:183], v[116:119]
  ds_read_b64_tr_b16 v[142:143], v8 offset:5120
  s_waitcnt lgkmcnt(8)
  v_mfma_f32_16x16x32_bf16 v[72:75], v[168:171], v[176:179], v[72:75]
  ds_read_b64_tr_b16 v[144:145], v10 offset:61504
  v_mfma_f32_16x16x32_bf16 v[120:123], v[168:171], v[180:183], v[120:123]
  ds_read_b64_tr_b16 v[146:147], v10 offset:64576
  v_mfma_f32_16x16x32_bf16 v[76:79], v[172:175], v[176:179], v[76:79]
  ds_read_b64_tr_b16 v[148:149], v11 offset:2112
  v_mfma_f32_16x16x32_bf16 v[124:127], v[172:175], v[180:183], v[124:127]
  ds_read_b64_tr_b16 v[150:151], v11 offset:5184
  ds_read_b32 v31, v29 offset:64
  s_waitcnt lgkmcnt(9)
  s_waitcnt vmcnt(11)
  v_mfma_f32_16x16x32_bf16 v[32:35], v[128:131], v[184:187], v[32:35]
  ds_read_b64_tr_b16 v[152:153], v7 offset:61504
  v_mfma_f32_16x16x32_bf16 v[80:83], v[128:131], v[188:191], v[80:83]
  ds_read_b64_tr_b16 v[154:155], v7 offset:64576
  v_mfma_f32_16x16x32_bf16 v[36:39], v[132:135], v[184:187], v[36:39]
  ds_read_b64_tr_b16 v[156:157], v8 offset:2112
  v_mfma_f32_16x16x32_bf16 v[84:87], v[132:135], v[188:191], v[84:87]
  ds_read_b64_tr_b16 v[158:159], v8 offset:5184
  buffer_load_dwordx4 v[236:239], v15, s[36:39], s67 offen offset:2048 sc1
  s_waitcnt lgkmcnt(9)
  v_mfma_f32_16x16x32_bf16 v[40:43], v[136:139], v[184:187], v[40:43]
  ds_read_b64_tr_b16 v[160:161], v10 offset:61568
  v_mfma_f32_16x16x32_bf16 v[88:91], v[136:139], v[188:191], v[88:91]
  ds_read_b64_tr_b16 v[162:163], v10 offset:64640
  v_mfma_f32_16x16x32_bf16 v[44:47], v[140:143], v[184:187], v[44:47]
  ds_read_b64_tr_b16 v[164:165], v11 offset:2176
  v_mfma_f32_16x16x32_bf16 v[92:95], v[140:143], v[188:191], v[92:95]
  ds_read_b64_tr_b16 v[166:167], v11 offset:5248
  s_waitcnt lgkmcnt(9)
  v_mfma_f32_16x16x32_bf16 v[48:51], v[144:147], v[184:187], v[48:51]
  ds_read_b64_tr_b16 v[168:169], v7 offset:61568
  v_mfma_f32_16x16x32_bf16 v[96:99], v[144:147], v[188:191], v[96:99]
  ds_read_b64_tr_b16 v[170:171], v7 offset:64640
  v_mfma_f32_16x16x32_bf16 v[52:55], v[148:151], v[184:187], v[52:55]
  ds_read_b64_tr_b16 v[172:173], v8 offset:2176
  v_mfma_f32_16x16x32_bf16 v[100:103], v[148:151], v[188:191], v[100:103]
  ds_read_b64_tr_b16 v[174:175], v8 offset:5248
  s_mov_b64 exec, 1
  ds_add_u32 v29, v30 offset:200
  s_mov_b64 exec, -1
  s_waitcnt lgkmcnt(13)
  v_readfirstlane_b32 s56, v31
  s_cmp_ge_u32 s56, 4
  s_cbranch_scc1 L_fl19_ok
  s_mov_b32 s57, 0
L_fl19:
  ds_read_b32 v31, v29 offset:64
  s_waitcnt lgkmcnt(0)
  v_readfirstlane_b32 s56, v31
  s_add_u32 s57, s57, 1
  s_cmp_ge_u32 s56, 4
  s_cbranch_scc1 L_fl19_ok
  s_cmp_lt_u32 s57, 1048576
  s_cbranch_scc1 L_fl19
L_fl19_ok:
  s_waitcnt lgkmcnt(9)
  v_mfma_f32_16x16x32_bf16 v[56:59], v[152:155], v[184:187], v[56:59]
  ds_read_b64_tr_b16 v[128:129], v11 offset:8192
  v_mfma_f32_16x16x32_bf16 v[104:107], v[152:155], v[188:191], v[104:107]
  ds_read_b64_tr_b16 v[130:131], v11 offset:11264
  v_mfma_f32_16x16x32_bf16 v[60:63], v[156:159], v[184:187], v[60:63]
  ds_read_b64_tr_b16 v[132:133], v11 offset:14336
  v_mfma_f32_16x16x32_bf16 v[108:111], v[156:159], v[188:191], v[108:111]
  ds_read_b64_tr_b16 v[134:135], v11 offset:17408
  s_add_u32 s66, s66, 4096
  s_add_u32 s67, s67, 4096
  buffer_load_dwordx4 v[176:179], v15, s[36:39], s66 offen offset:0 sc1
  s_waitcnt lgkmcnt(9)
  v_mfma_f32_16x16x32_bf16 v[64:67], v[160:163], v[184:187], v[64:67]
  ds_read_b64_tr_b16 v[136:137], v8 offset:8192
  v_mfma_f32_16x16x32_bf16 v[112:115], v[160:163], v[188:191], v[112:115]
  ds_read_b64_tr_b16 v[138:139], v8 offset:11264
  v_mfma_f32_16x16x32_bf16 v[68:71], v[164:167], v[184:187], v[68:71]
  ds_read_b64_tr_b16 v[140:141], v8 offset:14336
  v_mfma_f32_16x16x32_bf16 v[116:119], v[164:167], v[188:191], v[116:119]
  ds_read_b64_tr_b16 v[142:143], v8 offset:17408
  s_waitcnt lgkmcnt(9)
  v_mfma_f32_16x16x32_bf16 v[72:75], v[168:171], v[184:187], v[72:75]
  ds_read_b64_tr_b16 v[144:145], v11 offset:8256
  v_mfma_f32_16x16x32_bf16 v[120:123], v[168:171], v[188:191], v[120:123]
  ds_read_b64_tr_b16 v[146:147], v11 offset:11328
  v_mfma_f32_16x16x32_bf16 v[76:79], v[172:175], v[184:187], v[76:79]
  ds_read_b64_tr_b16 v[148:149], v11 offset:14400
  v_mfma_f32_16x16x32_bf16 v[124:127], v[172:175], v[188:191], v[124:127]
  ds_read_b64_tr_b16 v[150:151], v11 offset:17472
  s_waitcnt lgkmcnt(8)
  s_waitcnt vmcnt(11)
  v_mfma_f32_16x16x32_bf16 v[32:35], v[128:131], v[192:195], v[32:35]
  ds_read_b64_tr_b16 v[152:153], v8 offset:8256
  v_mfma_f32_16x16x32_bf16 v[80:83], v[128:131], v[196:199], v[80:83]
  ds_read_b64_tr_b16 v[154:155], v8 offset:11328
  v_mfma_f32_16x16x32_bf16 v[36:39], v[132:135], v[192:195], v[36:39]
  ds_read_b64_tr_b16 v[156:157], v8 offset:14400
  v_mfma_f32_16x16x32_bf16 v[84:87], v[132:135], v[196:199], v[84:87]
  ds_read_b64_tr_b16 v[158:159], v8 offset:17472
  buffer_load_dwordx4 v[180:183], v15, s[36:39], s67 offen offset:0 sc1
  s_waitcnt lgkmcnt(8)
  v_mfma_f32_16x16x32_bf16 v[40:43], v[136:139], v[192:195], v[40:43]
  ds_read_b64_tr_b16 v[160:161], v11 offset:8320
  v_mfma_f32_16x16x32_bf16 v[88:91], v[136:139], v[196:199], v[88:91]
  ds_read_b64_tr_b16 v[162:163], v11 offset:11392
  v_mfma_f32_16x16x32_bf16 v[44:47], v[140:143], v[192:195], v[44:47]
  ds_read_b64_tr_b16 v[164:165], v11 offset:14464
  v_mfma_f32_16x16x32_bf16 v[92:95], v[140:143], v[196:199], v[92:95]
  ds_read_b64_tr_b16 v[166:167], v11 offset:17536
  s_waitcnt lgkmcnt(8)
  v_mfma_f32_16x16x32_bf16 v[48:51], v[144:147], v[192:195], v[48:51]
  ds_read_b64_tr_b16 v[168:169], v8 offset:8320
  v_mfma_f32_16x16x32_bf16 v[96:99], v[144:147], v[196:199], v[96:99]
  ds_read_b64_tr_b16 v[170:171], v8 offset:11392
  v_mfma_f32_16x16x32_bf16 v[52:55], v[148:151], v[192:195], v[52:55]
  ds_read_b64_tr_b16 v[172:173], v8 offset:14464
  v_mfma_f32_16x16x32_bf16 v[100:103], v[148:151], v[196:199], v[100:103]
  ds_read_b64_tr_b16 v[174:175], v8 offset:17536
  s_waitcnt lgkmcnt(8)
  v_mfma_f32_16x16x32_bf16 v[56:59], v[152:155], v[192:195], v[56:59]
  ds_read_b64_tr_b16 v[128:129], v11 offset:20480
  v_mfma_f32_16x16x32_bf16 v[104:107], v[152:155], v[196:199], v[104:107]
  ds_read_b64_tr_b16 v[130:131], v11 offset:23552
  v_mfma_f32_16x16x32_bf16 v[60:63], v[156:159], v[192:195], v[60:63]
  ds_read_b64_tr_b16 v[132:133], v11 offset:26624
  v_mfma_f32_16x16x32_bf16 v[108:111], v[156:159], v[196:199], v[108:111]
  ds_read_b64_tr_b16 v[134:135], v11 offset:29696
  buffer_load_dwordx4 v[184:187], v15, s[36:39], s66 offen offset:2048 sc1
  s_waitcnt lgkmcnt(8)
  v_mfma_f32_16x16x32_bf16 v[64:67], v[160:163], v[192:195], v[64:67]
  ds_read_b64_tr_b16 v[136:137], v8 offset:20480
  v_mfma_f32_16x16x32_bf16 v[112:115], v[160:163], v[196:199], v[112:115]
  ds_read_b64_tr_b16 v[138:139], v8 offset:23552
  v_mfma_f32_16x16x32_bf16 v[68:71], v[164:167], v[192:195], v[68:71]
  ds_read_b64_tr_b16 v[140:141], v8 offset:26624
  v_mfma_f32_16x16x32_bf16 v[116:119], v[164:167], v[196:199], v[116:119]
  ds_read_b64_tr_b16 v[142:143], v8 offset:29696
  s_waitcnt lgkmcnt(8)
  v_mfma_f32_16x16x32_bf16 v[72:75], v[168:171], v[192:195], v[72:75]
  ds_read_b64_tr_b16 v[144:145], v11 offset:20544
  v_mfma_f32_16x16x32_bf16 v[120:123], v[168:171], v[196:199], v[120:123]
  ds_read_b64_tr_b16 v[146:147], v11 offset:23616
  v_mfma_f32_16x16x32_bf16 v[76:79], v[172:175], v[192:195], v[76:79]
  ds_read_b64_tr_b16 v[148:149], v11 offset:26688
  v_mfma_f32_16x16x32_bf16 v[124:127], v[172:175], v[196:199], v[124:127]
  ds_read_b64_tr_b16 v[150:151], v11 offset:29760
  ds_read_b32 v31, v29 offset:72
  s_waitcnt lgkmcnt(9)
  s_waitcnt vmcnt(11)
  v_mfma_f32_16x16x32_bf16 v[32:35], v[128:131], v[200:203], v[32:35]
  ds_read_b64_tr_b16 v[152:153], v8 offset:20544
  v_mfma_f32_16x16x32_bf16 v[80:83], v[128:131], v[204:207], v[80:83]
  ds_read_b64_tr_b16 v[154:155], v8 offset:23616
  v_mfma_f32_16x16x32_bf16 v[36:39], v[132:135], v[200:203], v[36:39]
  ds_read_b64_tr_b16 v[156:157], v8 offset:26688
  v_mfma_f32_16x16x32_bf16 v[84:87], v[132:135], v[204:207], v[84:87]
  ds_read_b64_tr_b16 v[158:159], v8 offset:29760
  buffer_load_dwordx4 v[188:191], v15, s[36:39], s67 offen offset:2048 sc1
  s_waitcnt lgkmcnt(9)
  v_mfma_f32_16x16x32_bf16 v[40:43], v[136:139], v[200:203], v[40:43]
  ds_read_b64_tr_b16 v[160:161], v11 offset:20608
  v_mfma_f32_16x16x32_bf16 v[88:91], v[136:139], v[204:207], v[88:91]
  ds_read_b64_tr_b16 v[162:163], v11 offset:23680
  v_mfma_f32_16x16x32_bf16 v[44:47], v[140:143], v[200:203], v[44:47]
  ds_read_b64_tr_b16 v[164:165], v11 offset:26752
  v_mfma_f32_16x16x32_bf16 v[92:95], v[140:143], v[204:207], v[92:95]
  ds_read_b64_tr_b16 v[166:167], v11 offset:29824
  s_waitcnt lgkmcnt(9)
  v_mfma_f32_16x16x32_bf16 v[48:51], v[144:147], v[200:203], v[48:51]
  ds_read_b64_tr_b16 v[168:169], v8 offset:20608
  v_mfma_f32_16x16x32_bf16 v[96:99], v[144:147], v[204:207], v[96:99]
  ds_read_b64_tr_b16 v[170:171], v8 offset:23680
  v_mfma_f32_16x16x32_bf16 v[52:55], v[148:151], v[200:203], v[52:55]
  ds_read_b64_tr_b16 v[172:173], v8 offset:26752
  v_mfma_f32_16x16x32_bf16 v[100:103], v[148:151], v[204:207], v[100:103]
  ds_read_b64_tr_b16 v[174:175], v8 offset:29824
  s_mov_b64 exec, 1
  ds_add_u32 v29, v30 offset:204
  s_mov_b64 exec, -1
  s_waitcnt lgkmcnt(13)
  v_readfirstlane_b32 s56, v31
  s_cmp_ge_u32 s56, 4
  s_cbranch_scc1 L_fl20_ok
  s_mov_b32 s57, 0
L_fl20:
  ds_read_b32 v31, v29 offset:72
  s_waitcnt lgkmcnt(0)
  v_readfirstlane_b32 s56, v31
  s_add_u32 s57, s57, 1
  s_cmp_ge_u32 s56, 4
  s_cbranch_scc1 L_fl20_ok
  s_cmp_lt_u32 s57, 1048576
  s_cbranch_scc1 L_fl20
L_fl20_ok:
  s_waitcnt lgkmcnt(9)
  v_mfma_f32_16x16x32_bf16 v[56:59], v[152:155], v[200:203], v[56:59]
  ds_read_b64_tr_b16 v[128:129], v10 offset:0
  v_mfma_f32_16x16x32_bf16 v[104:107], v[152:155], v[204:207], v[104:107]
  ds_read_b64_tr_b16 v[130:131], v10 offset:3072
  v_mfma_f32_16x16x32_bf16 v[60:63], v[156:159], v[200:203], v[60:63]
  ds_read_b64_tr_b16 v[132:133], v10 offset:6144
  v_mfma_f32_16x16x32_bf16 v[108:111], v[156:159], v[204:207], v[108:111]
  ds_read_b64_tr_b16 v[134:135], v10 offset:9216
  s_add_u32 s66, s66, 4096
  s_add_u32 s67, s67, 4096
  buffer_load_dwordx4 v[192:195], v15, s[36:39], s66 offen offset:0 sc1
  s_waitcnt lgkmcnt(9)
  v_mfma_f32_16x16x32_bf16 v[64:67], v[160:163], v[200:203], v[64:67]
  ds_read_b64_tr_b16 v[136:137], v7 offset:0
  v_mfma_f32_16x16x32_bf16 v[112:115], v[160:163], v[204:207], v[112:115]
  ds_read_b64_tr_b16 v[138:139], v7 offset:3072
  v_mfma_f32_16x16x32_bf16 v[68:71], v[164:167], v[200:203], v[68:71]
  ds_read_b64_tr_b16 v[140:141], v7 offset:6144
  v_mfma_f32_16x16x32_bf16 v[116:119], v[164:167], v[204:207], v[116:119]
  ds_read_b64_tr_b16 v[142:143], v7 offset:9216
  s_waitcnt lgkmcnt(9)
  v_mfma_f32_16x16x32_bf16 v[72:75], v[168:171], v[200:203], v[72:75]
  ds_read_b64_tr_b16 v[144:145], v10 offset:64
  v_mfma_f32_16x16x32_bf16 v[120:123], v[168:171], v[204:207], v[120:123]
  ds_read_b64_tr_b16 v[146:147], v10 offset:3136
  v_mfma_f32_16x16x32_bf16 v[76:79], v[172:175], v[200:203], v[76:79]
  ds_read_b64_tr_b16 v[148:149], v10 offset:6208
  v_mfma_f32_16x16x32_bf16 v[124:127], v[172:175], v[204:207], v[124:127]
  ds_read_b64_tr_b16 v[150:151], v10 offset:9280
  s_waitcnt lgkmcnt(8)
  s_waitcnt vmcnt(11)
  v_mfma_f32_16x16x32_bf16 v[32:35], v[128:131], v[208:211], v[32:35]
  ds_read_b64_tr_b16 v[152:153], v7 offset:64
  v_mfma_f32_16x16x32_bf16 v[80:83], v[128:131], v[212:215], v[80:83]
  ds_read_b64_tr_b16 v[154:155], v7 offset:3136
  v_mfma_f32_16x16x32_bf16 v[36:39], v[132:135], v[208:211], v[36:39]
  ds_read_b64_tr_b16 v[156:157], v7 offset:6208
  v_mfma_f32_16x16x32_bf16 v[84:87], v[132:135], v[212:215], v[84:87]
  ds_read_b64_tr_b16 v[158:159], v7 offset:9280
  buffer_load_dwordx4 v[196:199], v15, s[36:39], s67 offen offset:0 sc1
  s_waitcnt lgkmcnt(8)
  v_mfma_f32_16x16x32_bf16 v[40:43], v[136:139], v[208:211], v[40:43]
  ds_read_b64_tr_b16 v[160:161], v10 offset:128
  v_mfma_f32_16x16x32_bf16 v[88:91], v[136:139], v[212:215], v[88:91]
  ds_read_b64_tr_b16 v[162:163], v10 offset:3200
  v_mfma_f32_16x16x32_bf16 v[44:47], v[140:143], v[208:211], v[44:47]
  ds_read_b64_tr_b16 v[164:165], v10 offset:6272
  v_mfma_f32_16x16x32_bf16 v[92:95], v[140:143], v[212:215], v[92:95]
  ds_read_b64_tr_b16 v[166:167], v10 offset:9344
  s_waitcnt lgkmcnt(8)
  v_mfma_f32_16x16x32_bf16 v[48:51], v[144:147], v[208:211], v[48:51]
  ds_read_b64_tr_b16 v[168:169], v7 offset:128
  v_mfma_f32_16x16x32_bf16 v[96:99], v[144:147], v[212:215], v[96:99]
  ds_read_b64_tr_b16 v[170:171], v7 offset:3200
  v_mfma_f32_16x16x32_bf16 v[52:55], v[148:151], v[208:211], v[52:55]
  ds_read_b64_tr_b16 v[172:173], v7 offset:6272
  v_mfma_f32_16x16x32_bf16 v[100:103], v[148:151], v[212:215], v[100:103]
  ds_read_b64_tr_b16 v[174:175], v7 offset:9344
  s_waitcnt lgkmcnt(8)
  v_mfma_f32_16x16x32_bf16 v[56:59], v[152:155], v[208:211], v[56:59]
  ds_read_b64_tr_b16 v[128:129], v11 offset:32768
  v_mfma_f32_16x16x32_bf16 v[104:107], v[152:155], v[212:215], v[104:107]
  ds_read_b64_tr_b16 v[130:131], v11 offset:35840
  v_mfma_f32_16x16x32_bf16 v[60:63], v[156:159], v[208:211], v[60:63]
  ds_read_b64_tr_b16 v[132:133], v11 offset:38912
  v_mfma_f32_16x16x32_bf16 v[108:111], v[156:159], v[212:215], v[108:111]
  ds_read_b64_tr_b16 v[134:135], v11 offset:41984
  buffer_load_dwordx4 v[200:203], v15, s[36:39], s66 offen offset:2048 sc1
  s_waitcnt lgkmcnt(8)
  v_mfma_f32_16x16x32_bf16 v[64:67], v[160:163], v[208:211], v[64:67]
  ds_read_b64_tr_b16 v[136:137], v8 offset:32768
  v_mfma_f32_16x16x32_bf16 v[112:115], v[160:163], v[212:215], v[112:115]
  ds_read_b64_tr_b16 v[138:139], v8 offset:35840
  v_mfma_f32_16x16x32_bf16 v[68:71], v[164:167], v[208:211], v[68:71]
  ds_read_b64_tr_b16 v[140:141], v8 offset:38912
  v_mfma_f32_16x16x32_bf16 v[116:119], v[164:167], v[212:215], v[116:119]
  ds_read_b64_tr_b16 v[142:143], v8 offset:41984
  s_waitcnt lgkmcnt(8)
  v_mfma_f32_16x16x32_bf16 v[72:75], v[168:171], v[208:211], v[72:75]
  ds_read_b64_tr_b16 v[144:145], v11 offset:32832
  v_mfma_f32_16x16x32_bf16 v[120:123], v[168:171], v[212:215], v[120:123]
  ds_read_b64_tr_b16 v[146:147], v11 offset:35904
  v_mfma_f32_16x16x32_bf16 v[76:79], v[172:175], v[208:211], v[76:79]
  ds_read_b64_tr_b16 v[148:149], v11 offset:38976
  v_mfma_f32_16x16x32_bf16 v[124:127], v[172:175], v[212:215], v[124:127]
  ds_read_b64_tr_b16 v[150:151], v11 offset:42048
  v_add_f32 v20, v20, v22
  v_add_f32 v21, v21, v23
  v_add_f32 v24, v24, v26
  v_add_f32 v25, v25, v27
  v_mov_b32 v22, v20
  v_mov_b32 v23, v21
  v_mov_b32 v26, v24
  v_mov_b32 v27, v25
  v_permlane16_swap_b32 v20, v22
  v_permlane16_swap_b32 v21, v23
  v_permlane16_swap_b32 v24, v26
  v_permlane16_swap_b32 v25, v27
  v_add_f32 v20, v20, v22
  v_add_f32 v21, v21, v23
  v_add_f32 v24, v24, v26
  v_add_f32 v25, v25, v27
  v_mov_b32 v22, v20
  v_mov_b32 v23, v21
  v_mov_b32 v26, v24
  v_mov_b32 v27, v25
  v_permlane32_swap_b32 v20, v22
  v_permlane32_swap_b32 v21, v23
  v_permlane32_swap_b32 v24, v26
  v_permlane32_swap_b32 v25, v27
  v_add_f32 v20, v20, v22
  v_add_f32 v21, v21, v23
  v_add_f32 v24, v24, v26
  v_add_f32 v25, v25, v27
  v_mul_f32 v20, 0xbacccccd, v20
  v_mul_f32 v21, 0x3acccccd, v21
  v_fma_f32 v21, -v20, v20, v21
  v_max_f32 v21, 0, v21
  v_add_f32 v21, 0x3727c5ac, v21
  v_rsq_f32 v21, v21
  s_nop 0
  v_mul_f32 v22, 0xc0135761, v21
  v_mul_f32 v23, 0xbdd2d3e8, v21
  v_mul_f32 v21, v21, v21
  v_mul_f32 v23, v23, v21
  v_mul_f32 v24, 0xbacccccd, v24
  v_mul_f32 v25, 0x3acccccd, v25
  v_fma_f32 v25, -v24, v24, v25
  v_max_f32 v25, 0, v25
  v_add_f32 v25, 0x3727c5ac, v25
  v_rsq_f32 v25, v25
  s_nop 0
  v_mul_f32 v26, 0xc0135761, v25
  v_mul_f32 v27, 0xbdd2d3e8, v25
  v_mul_f32 v25, v25, v25
  v_mul_f32 v27, v27, v25
  ds_read_b32 v31, v29 offset:80
  s_waitcnt lgkmcnt(9)
  s_waitcnt vmcnt(11)
  v_mfma_f32_16x16x32_bf16 v[32:35], v[128:131], v[216:219], v[32:35]
  ds_read_b64_tr_b16 v[152:153], v8 offset:32832
  v_mfma_f32_16x16x32_bf16 v[80:83], v[128:131], v[220:223], v[80:83]
  ds_read_b64_tr_b16 v[154:155], v8 offset:35904
  v_mfma_f32_16x16x32_bf16 v[36:39], v[132:135], v[216:219], v[36:39]
  ds_read_b64_tr_b16 v[156:157], v8 offset:38976
  v_mfma_f32_16x16x32_bf16 v[84:87], v[132:135], v[220:223], v[84:87]
  ds_read_b64_tr_b16 v[158:159], v8 offset:42048
  buffer_load_dwordx4 v[204:207], v15, s[36:39], s67 offen offset:2048 sc1
  s_waitcnt lgkmcnt(9)
  v_mfma_f32_16x16x32_bf16 v[40:43], v[136:139], v[216:219], v[40:43]
  ds_read_b64_tr_b16 v[160:161], v11 offset:32896
  v_mfma_f32_16x16x32_bf16 v[88:91], v[136:139], v[220:223], v[88:91]
  ds_read_b64_tr_b16 v[162:163], v11 offset:35968
  v_mfma_f32_16x16x32_bf16 v[44:47], v[140:143], v[216:219], v[44:47]
  ds_read_b64_tr_b16 v[164:165], v11 offset:39040
  v_mfma_f32_16x16x32_bf16 v[92:95], v[140:143], v[220:223], v[92:95]
  ds_read_b64_tr_b16 v[166:167], v11 offset:42112
  s_waitcnt lgkmcnt(9)
  v_mfma_f32_16x16x32_bf16 v[48:51], v[144:147], v[216:219], v[48:51]
  ds_read_b64_tr_b16 v[168:169], v8 offset:32896
  v_mfma_f32_16x16x32_bf16 v[96:99], v[144:147], v[220:223], v[96:99]
  ds_read_b64_tr_b16 v[170:171], v8 offset:35968
  v_mfma_f32_16x16x32_bf16 v[52:55], v[148:151], v[216:219], v[52:55]
  ds_read_b64_tr_b16 v[172:173], v8 offset:39040
  v_mfma_f32_16x16x32_bf16 v[100:103], v[148:151], v[220:223], v[100:103]
  ds_read_b64_tr_b16 v[174:175], v8 offset:42112
  s_mov_b64 exec, 1
  ds_add_u32 v29, v30 offset:208
  s_mov_b64 exec, -1
  s_waitcnt lgkmcnt(13)
  v_readfirstlane_b32 s56, v31
  s_cmp_ge_u32 s56, 4
  s_cbranch_scc1 L_fl21_ok
  s_mov_b32 s57, 0
L_fl21:
  ds_read_b32 v31, v29 offset:80
  s_waitcnt lgkmcnt(0)
  v_readfirstlane_b32 s56, v31
  s_add_u32 s57, s57, 1
  s_cmp_ge_u32 s56, 4
  s_cbranch_scc1 L_fl21_ok
  s_cmp_lt_u32 s57, 1048576
  s_cbranch_scc1 L_fl21
L_fl21_ok:
  s_waitcnt lgkmcnt(9)
  v_mfma_f32_16x16x32_bf16 v[56:59], v[152:155], v[216:219], v[56:59]
  ds_read_b64_tr_b16 v[128:129], v11 offset:45056
  v_mfma_f32_16x16x32_bf16 v[104:107], v[152:155], v[220:223], v[104:107]
  ds_read_b64_tr_b16 v[130:131], v11 offset:48128
  v_mfma_f32_16x16x32_bf16 v[60:63], v[156:159], v[216:219], v[60:63]
  ds_read_b64_tr_b16 v[132:133], v11 offset:51200
  v_mfma_f32_16x16x32_bf16 v[108:111], v[156:159], v[220:223], v[108:111]
  ds_read_b64_tr_b16 v[134:135], v11 offset:54272
  s_waitcnt lgkmcnt(9)
  v_mfma_f32_16x16x32_bf16 v[64:67], v[160:163], v[216:219], v[64:67]
  ds_read_b64_tr_b16 v[136:137], v8 offset:45056
  v_mfma_f32_16x16x32_bf16 v[112:115], v[160:163], v[220:223], v[112:115]
  ds_read_b64_tr_b16 v[138:139], v8 offset:48128
  v_mfma_f32_16x16x32_bf16 v[68:71], v[164:167], v[216:219], v[68:71]
  ds_read_b64_tr_b16 v[140:141], v8 offset:51200
  v_mfma_f32_16x16x32_bf16 v[116:119], v[164:167], v[220:223], v[116:119]
  ds_read_b64_tr_b16 v[142:143], v8 offset:54272
  s_waitcnt lgkmcnt(9)
  v_mfma_f32_16x16x32_bf16 v[72:75], v[168:171], v[216:219], v[72:75]
  ds_read_b64_tr_b16 v[144:145], v11 offset:45120
  v_mfma_f32_16x16x32_bf16 v[120:123], v[168:171], v[220:223], v[120:123]
  ds_read_b64_tr_b16 v[146:147], v11 offset:48192
  v_mfma_f32_16x16x32_bf16 v[76:79], v[172:175], v[216:219], v[76:79]
  ds_read_b64_tr_b16 v[148:149], v11 offset:51264
  v_mfma_f32_16x16x32_bf16 v[124:127], v[172:175], v[220:223], v[124:127]
  ds_read_b64_tr_b16 v[150:151], v11 offset:54336
  s_waitcnt lgkmcnt(8)
  s_waitcnt vmcnt(10)
  v_mfma_f32_16x16x32_bf16 v[32:35], v[128:131], v[224:227], v[32:35]
  ds_read_b64_tr_b16 v[152:153], v8 offset:45120
  v_mfma_f32_16x16x32_bf16 v[80:83], v[128:131], v[228:231], v[80:83]
  ds_read_b64_tr_b16 v[154:155], v8 offset:48192
  v_mfma_f32_16x16x32_bf16 v[36:39], v[132:135], v[224:227], v[36:39]
  ds_read_b64_tr_b16 v[156:157], v8 offset:51264
  v_mfma_f32_16x16x32_bf16 v[84:87], v[132:135], v[228:231], v[84:87]
  ds_read_b64_tr_b16 v[158:159], v8 offset:54336
  s_waitcnt lgkmcnt(8)
  v_mfma_f32_16x16x32_bf16 v[40:43], v[136:139], v[224:227], v[40:43]
  ds_read_b64_tr_b16 v[160:161], v11 offset:45184
  v_mfma_f32_16x16x32_bf16 v[88:91], v[136:139], v[228:231], v[88:91]
  ds_read_b64_tr_b16 v[162:163], v11 offset:48256
  v_mfma_f32_16x16x32_bf16 v[44:47], v[140:143], v[224:227], v[44:47]
  ds_read_b64_tr_b16 v[164:165], v11 offset:51328
  v_mfma_f32_16x16x32_bf16 v[92:95], v[140:143], v[228:231], v[92:95]
  ds_read_b64_tr_b16 v[166:167], v11 offset:54400
  s_waitcnt lgkmcnt(8)
  v_mfma_f32_16x16x32_bf16 v[48:51], v[144:147], v[224:227], v[48:51]
  ds_read_b64_tr_b16 v[168:169], v8 offset:45184
  v_mfma_f32_16x16x32_bf16 v[96:99], v[144:147], v[228:231], v[96:99]
  ds_read_b64_tr_b16 v[170:171], v8 offset:48256
  v_mfma_f32_16x16x32_bf16 v[52:55], v[148:151], v[224:227], v[52:55]
  ds_read_b64_tr_b16 v[172:173], v8 offset:51328
  v_mfma_f32_16x16x32_bf16 v[100:103], v[148:151], v[228:231], v[100:103]
  ds_read_b64_tr_b16 v[174:175], v8 offset:54400
  s_waitcnt lgkmcnt(8)
  v_mfma_f32_16x16x32_bf16 v[56:59], v[152:155], v[224:227], v[56:59]
  ds_read_b64_tr_b16 v[128:129], v11 offset:57344
  v_mfma_f32_16x16x32_bf16 v[104:107], v[152:155], v[228:231], v[104:107]
  ds_read_b64_tr_b16 v[130:131], v11 offset:60416
  v_mfma_f32_16x16x32_bf16 v[60:63], v[156:159], v[224:227], v[60:63]
  ds_read_b64_tr_b16 v[132:133], v11 offset:63488
  v_mfma_f32_16x16x32_bf16 v[108:111], v[156:159], v[228:231], v[108:111]
  ds_read_b64_tr_b16 v[134:135], v12 offset:1024
  s_waitcnt lgkmcnt(8)
  v_mfma_f32_16x16x32_bf16 v[64:67], v[160:163], v[224:227], v[64:67]
  ds_read_b64_tr_b16 v[136:137], v8 offset:57344
  v_mfma_f32_16x16x32_bf16 v[112:115], v[160:163], v[228:231], v[112:115]
  ds_read_b64_tr_b16 v[138:139], v8 offset:60416
  v_mfma_f32_16x16x32_bf16 v[68:71], v[164:167], v[224:227], v[68:71]
  ds_read_b64_tr_b16 v[140:141], v8 offset:63488
  v_mfma_f32_16x16x32_bf16 v[116:119], v[164:167], v[228:231], v[116:119]
  ds_read_b64_tr_b16 v[142:143], v9 offset:1024
  s_waitcnt lgkmcnt(8)
  v_mfma_f32_16x16x32_bf16 v[72:75], v[168:171], v[224:227], v[72:75]
  ds_read_b64_tr_b16 v[144:145], v11 offset:57408
  v_mfma_f32_16x16x32_bf16 v[120:123], v[168:171], v[228:231], v[120:123]
  ds_read_b64_tr_b16 v[146:147], v11 offset:60480
  v_mfma_f32_16x16x32_bf16 v[76:79], v[172:175], v[224:227], v[76:79]
  ds_read_b64_tr_b16 v[148:149], v11 offset:63552
  v_mfma_f32_16x16x32_bf16 v[124:127], v[172:175], v[228:231], v[124:127]
  ds_read_b64_tr_b16 v[150:151], v12 offset:1088
  ds_read_b32 v31, v29 offset:88
  s_waitcnt lgkmcnt(9)
  s_waitcnt vmcnt(8)
  v_mfma_f32_16x16x32_bf16 v[32:35], v[128:131], v[232:235], v[32:35]
  ds_read_b64_tr_b16 v[152:153], v8 offset:57408
  v_mfma_f32_16x16x32_bf16 v[80:83], v[128:131], v[236:239], v[80:83]
  ds_read_b64_tr_b16 v[154:155], v8 offset:60480
  v_mfma_f32_16x16x32_bf16 v[36:39], v[132:135], v[232:235], v[36:39]
  ds_read_b64_tr_b16 v[156:157], v8 offset:63552
  v_mfma_f32_16x16x32_bf16 v[84:87], v[132:135], v[236:239], v[84:87]
  ds_read_b64_tr_b16 v[158:159], v9 offset:1088
  s_waitcnt lgkmcnt(9)
  v_mfma_f32_16x16x32_bf16 v[40:43], v[136:139], v[232:235], v[40:43]
  ds_read_b64_tr_b16 v[160:161], v11 offset:57472
  v_mfma_f32_16x16x32_bf16 v[88:91], v[136:139], v[236:239], v[88:91]
  ds_read_b64_tr_b16 v[162:163], v11 offset:60544
  v_mfma_f32_16x16x32_bf16 v[44:47], v[140:143], v[232:235], v[44:47]
  ds_read_b64_tr_b16 v[164:165], v11 offset:63616
  v_mfma_f32_16x16x32_bf16 v[92:95], v[140:143], v[236:239], v[92:95]
  ds_read_b64_tr_b16 v[166:167], v12 offset:1152
  s_waitcnt lgkmcnt(9)
  v_mfma_f32_16x16x32_bf16 v[48:51], v[144:147], v[232:235], v[48:51]
  ds_read_b64_tr_b16 v[168:169], v8 offset:57472
  v_mfma_f32_16x16x32_bf16 v[96:99], v[144:147], v[236:239], v[96:99]
  ds_read_b64_tr_b16 v[170:171], v8 offset:60544
  v_mfma_f32_16x16x32_bf16 v[52:55], v[148:151], v[232:235], v[52:55]
  ds_read_b64_tr_b16 v[172:173], v8 offset:63616
  v_mfma_f32_16x16x32_bf16 v[100:103], v[148:151], v[236:239], v[100:103]
  ds_read_b64_tr_b16 v[174:175], v9 offset:1152
  s_mov_b64 exec, 1
  ds_add_u32 v29, v30 offset:212
  s_mov_b64 exec, -1
  s_waitcnt lgkmcnt(13)
  v_readfirstlane_b32 s56, v31
  s_cmp_ge_u32 s56, 4
  s_cbranch_scc1 L_fl22_ok
  s_mov_b32 s57, 0
L_fl22:
  ds_read_b32 v31, v29 offset:88
  s_waitcnt lgkmcnt(0)
  v_readfirstlane_b32 s56, v31
  s_add_u32 s57, s57, 1
  s_cmp_ge_u32 s56, 4
  s_cbranch_scc1 L_fl22_ok
  s_cmp_lt_u32 s57, 1048576
  s_cbranch_scc1 L_fl22
L_fl22_ok:
  s_waitcnt lgkmcnt(9)
  v_mfma_f32_16x16x32_bf16 v[56:59], v[152:155], v[232:235], v[56:59]
  ds_read_b64_tr_b16 v[128:129], v10 offset:12288
  v_mfma_f32_16x16x32_bf16 v[104:107], v[152:155], v[236:239], v[104:107]
  ds_read_b64_tr_b16 v[130:131], v10 offset:15360
  v_mfma_f32_16x16x32_bf16 v[60:63], v[156:159], v[232:235], v[60:63]
  ds_read_b64_tr_b16 v[132:133], v10 offset:18432
  v_mfma_f32_16x16x32_bf16 v[108:111], v[156:159], v[236:239], v[108:111]
  ds_read_b64_tr_b16 v[134:135], v10 offset:21504
  s_waitcnt lgkmcnt(9)
  v_mfma_f32_16x16x32_bf16 v[64:67], v[160:163], v[232:235], v[64:67]
  ds_read_b64_tr_b16 v[136:137], v7 offset:12288
  v_mfma_f32_16x16x32_bf16 v[112:115], v[160:163], v[236:239], v[112:115]
  ds_read_b64_tr_b16 v[138:139], v7 offset:15360
  v_mfma_f32_16x16x32_bf16 v[68:71], v[164:167], v[232:235], v[68:71]
  ds_read_b64_tr_b16 v[140:141], v7 offset:18432
  v_mfma_f32_16x16x32_bf16 v[116:119], v[164:167], v[236:239], v[116:119]
  ds_read_b64_tr_b16 v[142:143], v7 offset:21504
  s_waitcnt lgkmcnt(9)
  v_mfma_f32_16x16x32_bf16 v[72:75], v[168:171], v[232:235], v[72:75]
  ds_read_b64_tr_b16 v[144:145], v10 offset:12352
  v_mfma_f32_16x16x32_bf16 v[120:123], v[168:171], v[236:239], v[120:123]
  ds_read_b64_tr_b16 v[146:147], v10 offset:15424
  v_mfma_f32_16x16x32_bf16 v[76:79], v[172:175], v[232:235], v[76:79]
  ds_read_b64_tr_b16 v[148:149], v10 offset:18496
  v_mfma_f32_16x16x32_bf16 v[124:127], v[172:175], v[236:239], v[124:127]
  ds_read_b64_tr_b16 v[150:151], v10 offset:21568
  s_waitcnt lgkmcnt(8)
  s_waitcnt vmcnt(6)
  v_mfma_f32_16x16x32_bf16 v[32:35], v[128:131], v[176:179], v[32:35]
  ds_read_b64_tr_b16 v[152:153], v7 offset:12352
  v_mfma_f32_16x16x32_bf16 v[80:83], v[128:131], v[180:183], v[80:83]
  ds_read_b64_tr_b16 v[154:155], v7 offset:15424
  v_mfma_f32_16x16x32_bf16 v[36:39], v[132:135], v[176:179], v[36:39]
  ds_read_b64_tr_b16 v[156:157], v7 offset:18496
  v_mfma_f32_16x16x32_bf16 v[84:87], v[132:135], v[180:183], v[84:87]
  ds_read_b64_tr_b16 v[158:159], v7 offset:21568
  s_waitcnt lgkmcnt(8)
  v_mfma_f32_16x16x32_bf16 v[40:43], v[136:139], v[176:179], v[40:43]
  ds_read_b64_tr_b16 v[160:161], v10 offset:12416
  v_mfma_f32_16x16x32_bf16 v[88:91], v[136:139], v[180:183], v[88:91]
  ds_read_b64_tr_b16 v[162:163], v10 offset:15488
  v_mfma_f32_16x16x32_bf16 v[44:47], v[140:143], v[176:179], v[44:47]
  ds_read_b64_tr_b16 v[164:165], v10 offset:18560
  v_mfma_f32_16x16x32_bf16 v[92:95], v[140:143], v[180:183], v[92:95]
  ds_read_b64_tr_b16 v[166:167], v10 offset:21632
  s_waitcnt lgkmcnt(8)
  v_mfma_f32_16x16x32_bf16 v[48:51], v[144:147], v[176:179], v[48:51]
  ds_read_b64_tr_b16 v[168:169], v7 offset:12416
  v_mfma_f32_16x16x32_bf16 v[96:99], v[144:147], v[180:183], v[96:99]
  ds_read_b64_tr_b16 v[170:171], v7 offset:15488
  v_mfma_f32_16x16x32_bf16 v[52:55], v[148:151], v[176:179], v[52:55]
  ds_read_b64_tr_b16 v[172:173], v7 offset:18560
  v_mfma_f32_16x16x32_bf16 v[100:103], v[148:151], v[180:183], v[100:103]
  ds_read_b64_tr_b16 v[174:175], v7 offset:21632
  s_waitcnt lgkmcnt(8)
  v_mfma_f32_16x16x32_bf16 v[56:59], v[152:155], v[176:179], v[56:59]
  ds_read_b64_tr_b16 v[128:129], v12 offset:4096
  v_mfma_f32_16x16x32_bf16 v[104:107], v[152:155], v[180:183], v[104:107]
  ds_read_b64_tr_b16 v[130:131], v12 offset:7168
  v_mfma_f32_16x16x32_bf16 v[60:63], v[156:159], v[176:179], v[60:63]
  ds_read_b64_tr_b16 v[132:133], v12 offset:10240
  v_mfma_f32_16x16x32_bf16 v[108:111], v[156:159], v[180:183], v[108:111]
  ds_read_b64_tr_b16 v[134:135], v12 offset:13312
  s_waitcnt lgkmcnt(8)
  v_mfma_f32_16x16x32_bf16 v[64:67], v[160:163], v[176:179], v[64:67]
  ds_read_b64_tr_b16 v[136:137], v9 offset:4096
  v_mfma_f32_16x16x32_bf16 v[112:115], v[160:163], v[180:183], v[112:115]
  ds_read_b64_tr_b16 v[138:139], v9 offset:7168
  v_mfma_f32_16x16x32_bf16 v[68:71], v[164:167], v[176:179], v[68:71]
  ds_read_b64_tr_b16 v[140:141], v9 offset:10240
  v_mfma_f32_16x16x32_bf16 v[116:119], v[164:167], v[180:183], v[116:119]
  ds_read_b64_tr_b16 v[142:143], v9 offset:13312
  s_waitcnt lgkmcnt(8)
  v_mfma_f32_16x16x32_bf16 v[72:75], v[168:171], v[176:179], v[72:75]
  ds_read_b64_tr_b16 v[144:145], v12 offset:4160
  v_mfma_f32_16x16x32_bf16 v[120:123], v[168:171], v[180:183], v[120:123]
  ds_read_b64_tr_b16 v[146:147], v12 offset:7232
  v_mfma_f32_16x16x32_bf16 v[76:79], v[172:175], v[176:179], v[76:79]
  ds_read_b64_tr_b16 v[148:149], v12 offset:10304
  v_mfma_f32_16x16x32_bf16 v[124:127], v[172:175], v[180:183], v[124:127]
  ds_read_b64_tr_b16 v[150:151], v12 offset:13376
  ds_read_b32 v31, v29 offset:96
  s_waitcnt lgkmcnt(9)
  s_waitcnt vmcnt(4)
  v_mfma_f32_16x16x32_bf16 v[32:35], v[128:131], v[184:187], v[32:35]
  ds_read_b64_tr_b16 v[152:153], v9 offset:4160
  v_mfma_f32_16x16x32_bf16 v[80:83], v[128:131], v[188:191], v[80:83]
  ds_read_b64_tr_b16 v[154:155], v9 offset:7232
  v_mfma_f32_16x16x32_bf16 v[36:39], v[132:135], v[184:187], v[36:39]
  ds_read_b64_tr_b16 v[156:157], v9 offset:10304
  v_mfma_f32_16x16x32_bf16 v[84:87], v[132:135], v[188:191], v[84:87]
  ds_read_b64_tr_b16 v[158:159], v9 offset:13376
  s_waitcnt lgkmcnt(9)
  v_mfma_f32_16x16x32_bf16 v[40:43], v[136:139], v[184:187], v[40:43]
  ds_read_b64_tr_b16 v[160:161], v12 offset:4224
  v_mfma_f32_16x16x32_bf16 v[88:91], v[136:139], v[188:191], v[88:91]
  ds_read_b64_tr_b16 v[162:163], v12 offset:7296
  v_mfma_f32_16x16x32_bf16 v[44:47], v[140:143], v[184:187], v[44:47]
  ds_read_b64_tr_b16 v[164:165], v12 offset:10368
  v_mfma_f32_16x16x32_bf16 v[92:95], v[140:143], v[188:191], v[92:95]
  ds_read_b64_tr_b16 v[166:167], v12 offset:13440
  s_waitcnt lgkmcnt(9)
  v_mfma_f32_16x16x32_bf16 v[48:51], v[144:147], v[184:187], v[48:51]
  ds_read_b64_tr_b16 v[168:169], v9 offset:4224
  v_mfma_f32_16x16x32_bf16 v[96:99], v[144:147], v[188:191], v[96:99]
  ds_read_b64_tr_b16 v[170:171], v9 offset:7296
  v_mfma_f32_16x16x32_bf16 v[52:55], v[148:151], v[184:187], v[52:55]
  ds_read_b64_tr_b16 v[172:173], v9 offset:10368
  v_mfma_f32_16x16x32_bf16 v[100:103], v[148:151], v[188:191], v[100:103]
  ds_read_b64_tr_b16 v[174:175], v9 offset:13440
  s_mov_b64 exec, 1
  ds_add_u32 v29, v30 offset:216
  s_mov_b64 exec, -1
  s_waitcnt lgkmcnt(13)
  v_readfirstlane_b32 s56, v31
  s_cmp_ge_u32 s56, 4
  s_cbranch_scc1 L_fl23_ok
  s_mov_b32 s57, 0
L_fl23:
  ds_read_b32 v31, v29 offset:96
  s_waitcnt lgkmcnt(0)
  v_readfirstlane_b32 s56, v31
  s_add_u32 s57, s57, 1
  s_cmp_ge_u32 s56, 4
  s_cbranch_scc1 L_fl23_ok
  s_cmp_lt_u32 s57, 1048576
  s_cbranch_scc1 L_fl23
L_fl23_ok:
  s_waitcnt lgkmcnt(9)
  v_mfma_f32_16x16x32_bf16 v[56:59], v[152:155], v[184:187], v[56:59]
  ds_read_b64_tr_b16 v[128:129], v10 offset:24576
  v_mfma_f32_16x16x32_bf16 v[104:107], v[152:155], v[188:191], v[104:107]
  ds_read_b64_tr_b16 v[130:131], v10 offset:27648
  v_mfma_f32_16x16x32_bf16 v[60:63], v[156:159], v[184:187], v[60:63]
  ds_read_b64_tr_b16 v[132:133], v10 offset:30720
  v_mfma_f32_16x16x32_bf16 v[108:111], v[156:159], v[188:191], v[108:111]
  ds_read_b64_tr_b16 v[134:135], v10 offset:33792
  s_waitcnt lgkmcnt(9)
  v_mfma_f32_16x16x32_bf16 v[64:67], v[160:163], v[184:187], v[64:67]
  ds_read_b64_tr_b16 v[136:137], v7 offset:24576
  v_mfma_f32_16x16x32_bf16 v[112:115], v[160:163], v[188:191], v[112:115]
  ds_read_b64_tr_b16 v[138:139], v7 offset:27648
  v_mfma_f32_16x16x32_bf16 v[68:71], v[164:167], v[184:187], v[68:71]
  ds_read_b64_tr_b16 v[140:141], v7 offset:30720
  v_mfma_f32_16x16x32_bf16 v[116:119], v[164:167], v[188:191], v[116:119]
  ds_read_b64_tr_b16 v[142:143], v7 offset:33792
  s_waitcnt lgkmcnt(9)
  v_mfma_f32_16x16x32_bf16 v[72:75], v[168:171], v[184:187], v[72:75]
  ds_read_b64_tr_b16 v[144:145], v10 offset:24640
  v_mfma_f32_16x16x32_bf16 v[120:123], v[168:171], v[188:191], v[120:123]
  ds_read_b64_tr_b16 v[146:147], v10 offset:27712
  v_mfma_f32_16x16x32_bf16 v[76:79], v[172:175], v[184:187], v[76:79]
  ds_read_b64_tr_b16 v[148:149], v10 offset:30784
  v_mfma_f32_16x16x32_bf16 v[124:127], v[172:175], v[188:191], v[124:127]
  ds_read_b64_tr_b16 v[150:151], v10 offset:33856
  s_waitcnt lgkmcnt(8)
  s_waitcnt vmcnt(2)
  v_mfma_f32_16x16x32_bf16 v[32:35], v[128:131], v[192:195], v[32:35]
  ds_read_b64_tr_b16 v[152:153], v7 offset:24640
  v_mfma_f32_16x16x32_bf16 v[80:83], v[128:131], v[196:199], v[80:83]
  ds_read_b64_tr_b16 v[154:155], v7 offset:27712
  v_mfma_f32_16x16x32_bf16 v[36:39], v[132:135], v[192:195], v[36:39]
  ds_read_b64_tr_b16 v[156:157], v7 offset:30784
  v_mfma_f32_16x16x32_bf16 v[84:87], v[132:135], v[196:199], v[84:87]
  ds_read_b64_tr_b16 v[158:159], v7 offset:33856
  s_waitcnt lgkmcnt(8)
  v_mfma_f32_16x16x32_bf16 v[40:43], v[136:139], v[192:195], v[40:43]
  ds_read_b64_tr_b16 v[160:161], v10 offset:24704
  v_mfma_f32_16x16x32_bf16 v[88:91], v[136:139], v[196:199], v[88:91]
  ds_read_b64_tr_b16 v[162:163], v10 offset:27776
  v_mfma_f32_16x16x32_bf16 v[44:47], v[140:143], v[192:195], v[44:47]
  ds_read_b64_tr_b16 v[164:165], v10 offset:30848
  v_mfma_f32_16x16x32_bf16 v[92:95], v[140:143], v[196:199], v[92:95]
  ds_read_b64_tr_b16 v[166:167], v10 offset:33920
  s_waitcnt lgkmcnt(8)
  v_mfma_f32_16x16x32_bf16 v[48:51], v[144:147], v[192:195], v[48:51]
  ds_read_b64_tr_b16 v[168:169], v7 offset:24704
  v_mfma_f32_16x16x32_bf16 v[96:99], v[144:147], v[196:199], v[96:99]
  ds_read_b64_tr_b16 v[170:171], v7 offset:27776
  v_mfma_f32_16x16x32_bf16 v[52:55], v[148:151], v[192:195], v[52:55]
  ds_read_b64_tr_b16 v[172:173], v7 offset:30848
  v_mfma_f32_16x16x32_bf16 v[100:103], v[148:151], v[196:199], v[100:103]
  ds_read_b64_tr_b16 v[174:175], v7 offset:33920
  s_waitcnt lgkmcnt(8)
  v_mfma_f32_16x16x32_bf16 v[56:59], v[152:155], v[192:195], v[56:59]
  ds_read_b64_tr_b16 v[128:129], v10 offset:36864
  v_mfma_f32_16x16x32_bf16 v[104:107], v[152:155], v[196:199], v[104:107]
  ds_read_b64_tr_b16 v[130:131], v10 offset:39936
  v_mfma_f32_16x16x32_bf16 v[60:63], v[156:159], v[192:195], v[60:63]
  ds_read_b64_tr_b16 v[132:133], v10 offset:43008
  v_mfma_f32_16x16x32_bf16 v[108:111], v[156:159], v[196:199], v[108:111]
  ds_read_b64_tr_b16 v[134:135], v10 offset:46080
  s_waitcnt lgkmcnt(8)
  v_mfma_f32_16x16x32_bf16 v[64:67], v[160:163], v[192:195], v[64:67]
  ds_read_b64_tr_b16 v[136:137], v7 offset:36864
  v_mfma_f32_16x16x32_bf16 v[112:115], v[160:163], v[196:199], v[112:115]
  ds_read_b64_tr_b16 v[138:139], v7 offset:39936
  v_mfma_f32_16x16x32_bf16 v[68:71], v[164:167], v[192:195], v[68:71]
  ds_read_b64_tr_b16 v[140:141], v7 offset:43008
  v_mfma_f32_16x16x32_bf16 v[116:119], v[164:167], v[196:199], v[116:119]
  ds_read_b64_tr_b16 v[142:143], v7 offset:46080
  s_waitcnt lgkmcnt(8)
  v_mfma_f32_16x16x32_bf16 v[72:75], v[168:171], v[192:195], v[72:75]
  ds_read_b64_tr_b16 v[144:145], v10 offset:36928
  v_mfma_f32_16x16x32_bf16 v[120:123], v[168:171], v[196:199], v[120:123]
  ds_read_b64_tr_b16 v[146:147], v10 offset:40000
  v_mfma_f32_16x16x32_bf16 v[76:79], v[172:175], v[192:195], v[76:79]
  ds_read_b64_tr_b16 v[148:149], v10 offset:43072
  v_mfma_f32_16x16x32_bf16 v[124:127], v[172:175], v[196:199], v[124:127]
  ds_read_b64_tr_b16 v[150:151], v10 offset:46144
  s_waitcnt lgkmcnt(8)
  s_waitcnt vmcnt(0)
  v_mfma_f32_16x16x32_bf16 v[32:35], v[128:131], v[200:203], v[32:35]
  ds_read_b64_tr_b16 v[152:153], v7 offset:36928
  v_mfma_f32_16x16x32_bf16 v[80:83], v[128:131], v[204:207], v[80:83]
  ds_read_b64_tr_b16 v[154:155], v7 offset:40000
  v_mfma_f32_16x16x32_bf16 v[36:39], v[132:135], v[200:203], v[36:39]
  ds_read_b64_tr_b16 v[156:157], v7 offset:43072
  v_mfma_f32_16x16x32_bf16 v[84:87], v[132:135], v[204:207], v[84:87]
  ds_read_b64_tr_b16 v[158:159], v7 offset:46144
  s_waitcnt lgkmcnt(8)
  v_mfma_f32_16x16x32_bf16 v[40:43], v[136:139], v[200:203], v[40:43]
  ds_read_b64_tr_b16 v[160:161], v10 offset:36992
  v_mfma_f32_16x16x32_bf16 v[88:91], v[136:139], v[204:207], v[88:91]
  ds_read_b64_tr_b16 v[162:163], v10 offset:40064
  v_mfma_f32_16x16x32_bf16 v[44:47], v[140:143], v[200:203], v[44:47]
  ds_read_b64_tr_b16 v[164:165], v10 offset:43136
  v_mfma_f32_16x16x32_bf16 v[92:95], v[140:143], v[204:207], v[92:95]
  ds_read_b64_tr_b16 v[166:167], v10 offset:46208
  s_waitcnt lgkmcnt(8)
  v_mfma_f32_16x16x32_bf16 v[48:51], v[144:147], v[200:203], v[48:51]
  ds_read_b64_tr_b16 v[168:169], v7 offset:36992
  v_mfma_f32_16x16x32_bf16 v[96:99], v[144:147], v[204:207], v[96:99]
  ds_read_b64_tr_b16 v[170:171], v7 offset:40064
  v_mfma_f32_16x16x32_bf16 v[52:55], v[148:151], v[200:203], v[52:55]
  ds_read_b64_tr_b16 v[172:173], v7 offset:43136
  v_mfma_f32_16x16x32_bf16 v[100:103], v[148:151], v[204:207], v[100:103]
  ds_read_b64_tr_b16 v[174:175], v7 offset:46208
  s_mov_b64 exec, 1
  ds_add_u32 v29, v30 offset:220
  s_mov_b64 exec, -1
  ds_read_b32 v31, v29 offset:272
  s_waitcnt lgkmcnt(10)
  v_mfma_f32_16x16x32_bf16 v[56:59], v[152:155], v[200:203], v[56:59]
  v_mfma_f32_16x16x32_bf16 v[104:107], v[152:155], v[204:207], v[104:107]
  v_mfma_f32_16x16x32_bf16 v[60:63], v[156:159], v[200:203], v[60:63]
  v_mfma_f32_16x16x32_bf16 v[108:111], v[156:159], v[204:207], v[108:111]
  s_waitcnt lgkmcnt(6)
  v_mfma_f32_16x16x32_bf16 v[64:67], v[160:163], v[200:203], v[64:67]
  v_mfma_f32_16x16x32_bf16 v[112:115], v[160:163], v[204:207], v[112:115]
  v_mfma_f32_16x16x32_bf16 v[68:71], v[164:167], v[200:203], v[68:71]
  v_mfma_f32_16x16x32_bf16 v[116:119], v[164:167], v[204:207], v[116:119]
  s_waitcnt lgkmcnt(2)
  v_mfma_f32_16x16x32_bf16 v[72:75], v[168:171], v[200:203], v[72:75]
  v_mfma_f32_16x16x32_bf16 v[120:123], v[168:171], v[204:207], v[120:123]
  v_mfma_f32_16x16x32_bf16 v[76:79], v[172:175], v[200:203], v[76:79]
  v_mfma_f32_16x16x32_bf16 v[124:127], v[172:175], v[204:207], v[124:127]
  s_waitcnt lgkmcnt(0)
  v_readfirstlane_b32 s56, v31
  s_cmp_ge_u32 s56, 4
  s_cbranch_scc1 L_fl24_ok
  s_mov_b32 s57, 0
L_fl24:
  ds_read_b32 v31, v29 offset:272
  s_waitcnt lgkmcnt(0)
  v_readfirstlane_b32 s56, v31
  s_add_u32 s57, s57, 1
  s_cmp_ge_u32 s56, 4
  s_cbranch_scc1 L_fl24_ok
  s_cmp_lt_u32 s57, 1048576
  s_cbranch_scc1 L_fl24
L_fl24_ok:
  v_lshlrev_b32 v18, 4, v2
  v_add_u32 v18, 162688, v18
  ds_read_b128 v[128:131], v18 offset:0
  ds_read_b128 v[132:135], v18 offset:384
  ds_read_b128 v[136:139], v18 offset:64
  ds_read_b128 v[140:143], v18 offset:448
  ds_read_b128 v[144:147], v18 offset:128
  ds_read_b128 v[148:151], v18 offset:512
  ds_read_b128 v[152:155], v18 offset:192
  ds_read_b128 v[156:159], v18 offset:576
  ds_read_b128 v[160:163], v18 offset:256
  ds_read_b128 v[164:167], v18 offset:640
  ds_read_b128 v[168:171], v18 offset:320
  ds_read_b128 v[172:175], v18 offset:704
  s_waitcnt lgkmcnt(10)
  v_pk_fma_f32 v[32:33], v[128:129], v[20:21], v[32:33] op_sel_hi:[1,0,1]
  v_pk_fma_f32 v[34:35], v[130:131], v[20:21], v[34:35] op_sel_hi:[1,0,1]
  v_pk_fma_f32 v[36:37], v[132:133], v[20:21], v[36:37] op_sel_hi:[1,0,1]
  v_pk_fma_f32 v[38:39], v[134:135], v[20:21], v[38:39] op_sel_hi:[1,0,1]
  v_pk_mul_f32 v[176:177], v[32:33], v[32:33]
  v_pk_mul_f32 v[178:179], v[34:35], v[34:35]
  v_pk_fma_f32 v[176:177], v[176:177], v[22:23], v[22:23] op_sel:[0,1,0] op_sel_hi:[1,1,0]
  v_pk_fma_f32 v[178:179], v[178:179], v[22:23], v[22:23] op_sel:[0,1,0] op_sel_hi:[1,1,0]
  v_pk_mul_f32 v[176:177], v[176:177], v[32:33]
  v_pk_mul_f32 v[178:179], v[178:179], v[34:35]
  v_exp_f32 v176, v176
  v_exp_f32 v177, v177
  v_exp_f32 v178, v178
  v_exp_f32 v179, v179
  v_pk_mul_f32 v[36:37], v[36:37], v[32:33]
  v_pk_mul_f32 v[38:39], v[38:39], v[34:35]
  v_pk_add_f32 v[176:177], v[176:177], 1.0 op_sel_hi:[1,0]
  v_pk_add_f32 v[178:179], v[178:179], 1.0 op_sel_hi:[1,0]
  v_rcp_f32 v176, v176
  v_rcp_f32 v177, v177
  v_rcp_f32 v178, v178
  v_rcp_f32 v179, v179
  v_pk_mul_f32 v[36:37], v[36:37], v[20:21] op_sel:[0,1] op_sel_hi:[1,1]
  v_pk_mul_f32 v[38:39], v[38:39], v[20:21] op_sel:[0,1] op_sel_hi:[1,1]
  v_pk_mul_f32 v[36:37], v[36:37], v[176:177]
  v_pk_mul_f32 v[38:39], v[38:39], v[178:179]
  v_cvt_pk_bf16_f32 v200, v36, v37
  v_cvt_pk_bf16_f32 v201, v38, v39
  s_waitcnt lgkmcnt(8)
  v_pk_fma_f32 v[40:41], v[136:137], v[20:21], v[40:41] op_sel_hi:[1,0,1]
  v_pk_fma_f32 v[42:43], v[138:139], v[20:21], v[42:43] op_sel_hi:[1,0,1]
  v_pk_fma_f32 v[44:45], v[140:141], v[20:21], v[44:45] op_sel_hi:[1,0,1]
  v_pk_fma_f32 v[46:47], v[142:143], v[20:21], v[46:47] op_sel_hi:[1,0,1]
  v_pk_mul_f32 v[176:177], v[40:41], v[40:41]
  v_pk_mul_f32 v[178:179], v[42:43], v[42:43]
  v_pk_fma_f32 v[176:177], v[176:177], v[22:23], v[22:23] op_sel:[0,1,0] op_sel_hi:[1,1,0]
  v_pk_fma_f32 v[178:179], v[178:179], v[22:23], v[22:23] op_sel:[0,1,0] op_sel_hi:[1,1,0]
  v_pk_mul_f32 v[176:177], v[176:177], v[40:41]
  v_pk_mul_f32 v[178:179], v[178:179], v[42:43]
  v_exp_f32 v176, v176
  v_exp_f32 v177, v177
  v_exp_f32 v178, v178
  v_exp_f32 v179, v179
  v_pk_mul_f32 v[44:45], v[44:45], v[40:41]
  v_pk_mul_f32 v[46:47], v[46:47], v[42:43]
  v_pk_add_f32 v[176:177], v[176:177], 1.0 op_sel_hi:[1,0]
  v_pk_add_f32 v[178:179], v[178:179], 1.0 op_sel_hi:[1,0]
  v_rcp_f32 v176, v176
  v_rcp_f32 v177, v177
  v_rcp_f32 v178, v178
  v_rcp_f32 v179, v179
  v_pk_mul_f32 v[44:45], v[44:45], v[20:21] op_sel:[0,1] op_sel_hi:[1,1]
  v_pk_mul_f32 v[46:47], v[46:47], v[20:21] op_sel:[0,1] op_sel_hi:[1,1]
  v_pk_mul_f32 v[44:45], v[44:45], v[176:177]
  v_pk_mul_f32 v[46:47], v[46:47], v[178:179]
  v_cvt_pk_bf16_f32 v202, v44, v45
  v_cvt_pk_bf16_f32 v203, v46, v47
  buffer_store_dwordx4 v[200:203], v1, s[32:35], s68 offen offset:0 sc1
  s_waitcnt lgkmcnt(6)
  v_pk_fma_f32 v[48:49], v[144:145], v[20:21], v[48:49] op_sel_hi:[1,0,1]
  v_pk_fma_f32 v[50:51], v[146:147], v[20:21], v[50:51] op_sel_hi:[1,0,1]
  v_pk_fma_f32 v[52:53], v[148:149], v[20:21], v[52:53] op_sel_hi:[1,0,1]
  v_pk_fma_f32 v[54:55], v[150:151], v[20:21], v[54:55] op_sel_hi:[1,0,1]
  v_pk_mul_f32 v[176:177], v[48:49], v[48:49]
  v_pk_mul_f32 v[178:179], v[50:51], v[50:51]
  v_pk_fma_f32 v[176:177], v[176:177], v[22:23], v[22:23] op_sel:[0,1,0] op_sel_hi:[1,1,0]
  v_pk_fma_f32 v[178:179], v[178:179], v[22:23], v[22:23] op_sel:[0,1,0] op_sel_hi:[1,1,0]
  v_pk_mul_f32 v[176:177], v[176:177], v[48:49]
  v_pk_mul_f32 v[178:179], v[178:179], v[50:51]
  v_exp_f32 v176, v176
  v_exp_f32 v177, v177
  v_exp_f32 v178, v178
  v_exp_f32 v179, v179
  v_pk_mul_f32 v[52:53], v[52:53], v[48:49]
  v_pk_mul_f32 v[54:55], v[54:55], v[50:51]
  v_pk_add_f32 v[176:177], v[176:177], 1.0 op_sel_hi:[1,0]
  v_pk_add_f32 v[178:179], v[178:179], 1.0 op_sel_hi:[1,0]
  v_rcp_f32 v176, v176
  v_rcp_f32 v177, v177
  v_rcp_f32 v178, v178
  v_rcp_f32 v179, v179
  v_pk_mul_f32 v[52:53], v[52:53], v[20:21] op_sel:[0,1] op_sel_hi:[1,1]
  v_pk_mul_f32 v[54:55], v[54:55], v[20:21] op_sel:[0,1] op_sel_hi:[1,1]
  v_pk_mul_f32 v[52:53], v[52:53], v[176:177]
  v_pk_mul_f32 v[54:55], v[54:55], v[178:179]
  v_cvt_pk_bf16_f32 v204, v52, v53
  v_cvt_pk_bf16_f32 v205, v54, v55
  s_waitcnt lgkmcnt(4)
  v_pk_fma_f32 v[56:57], v[152:153], v[20:21], v[56:57] op_sel_hi:[1,0,1]
  v_pk_fma_f32 v[58:59], v[154:155], v[20:21], v[58:59] op_sel_hi:[1,0,1]
  v_pk_fma_f32 v[60:61], v[156:157], v[20:21], v[60:61] op_sel_hi:[1,0,1]
  v_pk_fma_f32 v[62:63], v[158:159], v[20:21], v[62:63] op_sel_hi:[1,0,1]
  v_pk_mul_f32 v[176:177], v[56:57], v[56:57]
  v_pk_mul_f32 v[178:179], v[58:59], v[58:59]
  v_pk_fma_f32 v[176:177], v[176:177], v[22:23], v[22:23] op_sel:[0,1,0] op_sel_hi:[1,1,0]
  v_pk_fma_f32 v[178:179], v[178:179], v[22:23], v[22:23] op_sel:[0,1,0] op_sel_hi:[1,1,0]
  v_pk_mul_f32 v[176:177], v[176:177], v[56:57]
  v_pk_mul_f32 v[178:179], v[178:179], v[58:59]
  v_exp_f32 v176, v176
  v_exp_f32 v177, v177
  v_exp_f32 v178, v178
  v_exp_f32 v179, v179
  v_pk_mul_f32 v[60:61], v[60:61], v[56:57]
  v_pk_mul_f32 v[62:63], v[62:63], v[58:59]
  v_pk_add_f32 v[176:177], v[176:177], 1.0 op_sel_hi:[1,0]
  v_pk_add_f32 v[178:179], v[178:179], 1.0 op_sel_hi:[1,0]
  v_rcp_f32 v176, v176
  v_rcp_f32 v177, v177
  v_rcp_f32 v178, v178
  v_rcp_f32 v179, v179
  v_pk_mul_f32 v[60:61], v[60:61], v[20:21] op_sel:[0,1] op_sel_hi:[1,1]
  v_pk_mul_f32 v[62:63], v[62:63], v[20:21] op_sel:[0,1] op_sel_hi:[1,1]
  v_pk_mul_f32 v[60:61], v[60:61], v[176:177]
  v_pk_mul_f32 v[62:63], v[62:63], v[178:179]
  v_cvt_pk_bf16_f32 v206, v60, v61
  v_cvt_pk_bf16_f32 v207, v62, v63
  buffer_store_dwordx4 v[204:207], v1, s[32:35], s68 offen offset:1024 sc1
  s_waitcnt lgkmcnt(2)
  v_pk_fma_f32 v[64:65], v[160:161], v[20:21], v[64:65] op_sel_hi:[1,0,1]
  v_pk_fma_f32 v[66:67], v[162:163], v[20:21], v[66:67] op_sel_hi:[1,0,1]
  v_pk_fma_f32 v[68:69], v[164:165], v[20:21], v[68:69] op_sel_hi:[1,0,1]
  v_pk_fma_f32 v[70:71], v[166:167], v[20:21], v[70:71] op_sel_hi:[1,0,1]
  v_pk_mul_f32 v[176:177], v[64:65], v[64:65]
  v_pk_mul_f32 v[178:179], v[66:67], v[66:67]
  v_pk_fma_f32 v[176:177], v[176:177], v[22:23], v[22:23] op_sel:[0,1,0] op_sel_hi:[1,1,0]
  v_pk_fma_f32 v[178:179], v[178:179], v[22:23], v[22:23] op_sel:[0,1,0] op_sel_hi:[1,1,0]
  v_pk_mul_f32 v[176:177], v[176:177], v[64:65]
  v_pk_mul_f32 v[178:179], v[178:179], v[66:67]
  v_exp_f32 v176, v176
  v_exp_f32 v177, v177
  v_exp_f32 v178, v178
  v_exp_f32 v179, v179
  v_pk_mul_f32 v[68:69], v[68:69], v[64:65]
  v_pk_mul_f32 v[70:71], v[70:71], v[66:67]
  v_pk_add_f32 v[176:177], v[176:177], 1.0 op_sel_hi:[1,0]
  v_pk_add_f32 v[178:179], v[178:179], 1.0 op_sel_hi:[1,0]
  v_rcp_f32 v176, v176
  v_rcp_f32 v177, v177
  v_rcp_f32 v178, v178
  v_rcp_f32 v179, v179
  v_pk_mul_f32 v[68:69], v[68:69], v[20:21] op_sel:[0,1] op_sel_hi:[1,1]
  v_pk_mul_f32 v[70:71], v[70:71], v[20:21] op_sel:[0,1] op_sel_hi:[1,1]
  v_pk_mul_f32 v[68:69], v[68:69], v[176:177]
  v_pk_mul_f32 v[70:71], v[70:71], v[178:179]
  v_cvt_pk_bf16_f32 v200, v68, v69
  v_cvt_pk_bf16_f32 v201, v70, v71
  s_waitcnt lgkmcnt(0)
  v_pk_fma_f32 v[72:73], v[168:169], v[20:21], v[72:73] op_sel_hi:[1,0,1]
  v_pk_fma_f32 v[74:75], v[170:171], v[20:21], v[74:75] op_sel_hi:[1,0,1]
  v_pk_fma_f32 v[76:77], v[172:173], v[20:21], v[76:77] op_sel_hi:[1,0,1]
  v_pk_fma_f32 v[78:79], v[174:175], v[20:21], v[78:79] op_sel_hi:[1,0,1]
  v_pk_mul_f32 v[176:177], v[72:73], v[72:73]
  v_pk_mul_f32 v[178:179], v[74:75], v[74:75]
  v_pk_fma_f32 v[176:177], v[176:177], v[22:23], v[22:23] op_sel:[0,1,0] op_sel_hi:[1,1,0]
  v_pk_fma_f32 v[178:179], v[178:179], v[22:23], v[22:23] op_sel:[0,1,0] op_sel_hi:[1,1,0]
  v_pk_mul_f32 v[176:177], v[176:177], v[72:73]
  v_pk_mul_f32 v[178:179], v[178:179], v[74:75]
  v_exp_f32 v176, v176
  v_exp_f32 v177, v177
  v_exp_f32 v178, v178
  v_exp_f32 v179, v179
  v_pk_mul_f32 v[76:77], v[76:77], v[72:73]
  v_pk_mul_f32 v[78:79], v[78:79], v[74:75]
  v_pk_add_f32 v[176:177], v[176:177], 1.0 op_sel_hi:[1,0]
  v_pk_add_f32 v[178:179], v[178:179], 1.0 op_sel_hi:[1,0]
  v_rcp_f32 v176, v176
  v_rcp_f32 v177, v177
  v_rcp_f32 v178, v178
  v_rcp_f32 v179, v179
  v_pk_mul_f32 v[76:77], v[76:77], v[20:21] op_sel:[0,1] op_sel_hi:[1,1]
  v_pk_mul_f32 v[78:79], v[78:79], v[20:21] op_sel:[0,1] op_sel_hi:[1,1]
  v_pk_mul_f32 v[76:77], v[76:77], v[176:177]
  v_pk_mul_f32 v[78:79], v[78:79], v[178:179]
  v_cvt_pk_bf16_f32 v202, v76, v77
  v_cvt_pk_bf16_f32 v203, v78, v79
  buffer_store_dwordx4 v[200:203], v1, s[32:35], s68 offen offset:2048 sc1
  v_pk_fma_f32 v[80:81], v[128:129], v[24:25], v[80:81] op_sel_hi:[1,0,1]
  v_pk_fma_f32 v[82:83], v[130:131], v[24:25], v[82:83] op_sel_hi:[1,0,1]
  v_pk_fma_f32 v[84:85], v[132:133], v[24:25], v[84:85] op_sel_hi:[1,0,1]
  v_pk_fma_f32 v[86:87], v[134:135], v[24:25], v[86:87] op_sel_hi:[1,0,1]
  v_pk_mul_f32 v[176:177], v[80:81], v[80:81]
  v_pk_mul_f32 v[178:179], v[82:83], v[82:83]
  v_pk_fma_f32 v[176:177], v[176:177], v[26:27], v[26:27] op_sel:[0,1,0] op_sel_hi:[1,1,0]
  v_pk_fma_f32 v[178:179], v[178:179], v[26:27], v[26:27] op_sel:[0,1,0] op_sel_hi:[1,1,0]
  v_pk_mul_f32 v[176:177], v[176:177], v[80:81]
  v_pk_mul_f32 v[178:179], v[178:179], v[82:83]
  v_exp_f32 v176, v176
  v_exp_f32 v177, v177
  v_exp_f32 v178, v178
  v_exp_f32 v179, v179
  v_pk_mul_f32 v[84:85], v[84:85], v[80:81]
  v_pk_mul_f32 v[86:87], v[86:87], v[82:83]
  v_pk_add_f32 v[176:177], v[176:177], 1.0 op_sel_hi:[1,0]
  v_pk_add_f32 v[178:179], v[178:179], 1.0 op_sel_hi:[1,0]
  v_rcp_f32 v176, v176
  v_rcp_f32 v177, v177
  v_rcp_f32 v178, v178
  v_rcp_f32 v179, v179
  v_pk_mul_f32 v[84:85], v[84:85], v[24:25] op_sel:[0,1] op_sel_hi:[1,1]
  v_pk_mul_f32 v[86:87], v[86:87], v[24:25] op_sel:[0,1] op_sel_hi:[1,1]
  v_pk_mul_f32 v[84:85], v[84:85], v[176:177]
  v_pk_mul_f32 v[86:87], v[86:87], v[178:179]
  v_cvt_pk_bf16_f32 v204, v84, v85
  v_cvt_pk_bf16_f32 v205, v86, v87
  v_pk_fma_f32 v[88:89], v[136:137], v[24:25], v[88:89] op_sel_hi:[1,0,1]
  v_pk_fma_f32 v[90:91], v[138:139], v[24:25], v[90:91] op_sel_hi:[1,0,1]
  v_pk_fma_f32 v[92:93], v[140:141], v[24:25], v[92:93] op_sel_hi:[1,0,1]
  v_pk_fma_f32 v[94:95], v[142:143], v[24:25], v[94:95] op_sel_hi:[1,0,1]
  v_pk_mul_f32 v[176:177], v[88:89], v[88:89]
  v_pk_mul_f32 v[178:179], v[90:91], v[90:91]
  v_pk_fma_f32 v[176:177], v[176:177], v[26:27], v[26:27] op_sel:[0,1,0] op_sel_hi:[1,1,0]
  v_pk_fma_f32 v[178:179], v[178:179], v[26:27], v[26:27] op_sel:[0,1,0] op_sel_hi:[1,1,0]
  v_pk_mul_f32 v[176:177], v[176:177], v[88:89]
  v_pk_mul_f32 v[178:179], v[178:179], v[90:91]
  v_exp_f32 v176, v176
  v_exp_f32 v177, v177
  v_exp_f32 v178, v178
  v_exp_f32 v179, v179
  v_pk_mul_f32 v[92:93], v[92:93], v[88:89]
  v_pk_mul_f32 v[94:95], v[94:95], v[90:91]
  v_pk_add_f32 v[176:177], v[176:177], 1.0 op_sel_hi:[1,0]
  v_pk_add_f32 v[178:179], v[178:179], 1.0 op_sel_hi:[1,0]
  v_rcp_f32 v176, v176
  v_rcp_f32 v177, v177
  v_rcp_f32 v178, v178
  v_rcp_f32 v179, v179
  v_pk_mul_f32 v[92:93], v[92:93], v[24:25] op_sel:[0,1] op_sel_hi:[1,1]
  v_pk_mul_f32 v[94:95], v[94:95], v[24:25] op_sel:[0,1] op_sel_hi:[1,1]
  v_pk_mul_f32 v[92:93], v[92:93], v[176:177]
  v_pk_mul_f32 v[94:95], v[94:95], v[178:179]
  v_cvt_pk_bf16_f32 v206, v92, v93
  v_cvt_pk_bf16_f32 v207, v94, v95
  s_add_u32 s68, s68, 49152
  buffer_store_dwordx4 v[204:207], v1, s[32:35], s68 offen offset:0 sc1
  v_pk_fma_f32 v[96:97], v[144:145], v[24:25], v[96:97] op_sel_hi:[1,0,1]
  v_pk_fma_f32 v[98:99], v[146:147], v[24:25], v[98:99] op_sel_hi:[1,0,1]
  v_pk_fma_f32 v[100:101], v[148:149], v[24:25], v[100:101] op_sel_hi:[1,0,1]
  v_pk_fma_f32 v[102:103], v[150:151], v[24:25], v[102:103] op_sel_hi:[1,0,1]
  v_pk_mul_f32 v[176:177], v[96:97], v[96:97]
  v_pk_mul_f32 v[178:179], v[98:99], v[98:99]
  v_pk_fma_f32 v[176:177], v[176:177], v[26:27], v[26:27] op_sel:[0,1,0] op_sel_hi:[1,1,0]
  v_pk_fma_f32 v[178:179], v[178:179], v[26:27], v[26:27] op_sel:[0,1,0] op_sel_hi:[1,1,0]
  v_pk_mul_f32 v[176:177], v[176:177], v[96:97]
  v_pk_mul_f32 v[178:179], v[178:179], v[98:99]
  v_exp_f32 v176, v176
  v_exp_f32 v177, v177
  v_exp_f32 v178, v178
  v_exp_f32 v179, v179
  v_pk_mul_f32 v[100:101], v[100:101], v[96:97]
  v_pk_mul_f32 v[102:103], v[102:103], v[98:99]
  v_pk_add_f32 v[176:177], v[176:177], 1.0 op_sel_hi:[1,0]
  v_pk_add_f32 v[178:179], v[178:179], 1.0 op_sel_hi:[1,0]
  v_rcp_f32 v176, v176
  v_rcp_f32 v177, v177
  v_rcp_f32 v178, v178
  v_rcp_f32 v179, v179
  v_pk_mul_f32 v[100:101], v[100:101], v[24:25] op_sel:[0,1] op_sel_hi:[1,1]
  v_pk_mul_f32 v[102:103], v[102:103], v[24:25] op_sel:[0,1] op_sel_hi:[1,1]
  v_pk_mul_f32 v[100:101], v[100:101], v[176:177]
  v_pk_mul_f32 v[102:103], v[102:103], v[178:179]
  v_cvt_pk_bf16_f32 v200, v100, v101
  v_cvt_pk_bf16_f32 v201, v102, v103
  v_pk_fma_f32 v[104:105], v[152:153], v[24:25], v[104:105] op_sel_hi:[1,0,1]
  v_pk_fma_f32 v[106:107], v[154:155], v[24:25], v[106:107] op_sel_hi:[1,0,1]
  v_pk_fma_f32 v[108:109], v[156:157], v[24:25], v[108:109] op_sel_hi:[1,0,1]
  v_pk_fma_f32 v[110:111], v[158:159], v[24:25], v[110:111] op_sel_hi:[1,0,1]
  v_pk_mul_f32 v[176:177], v[104:105], v[104:105]
  v_pk_mul_f32 v[178:179], v[106:107], v[106:107]
  v_pk_fma_f32 v[176:177], v[176:177], v[26:27], v[26:27] op_sel:[0,1,0] op_sel_hi:[1,1,0]
  v_pk_fma_f32 v[178:179], v[178:179], v[26:27], v[26:27] op_sel:[0,1,0] op_sel_hi:[1,1,0]
  v_pk_mul_f32 v[176:177], v[176:177], v[104:105]
  v_pk_mul_f32 v[178:179], v[178:179], v[106:107]
  v_exp_f32 v176, v176
  v_exp_f32 v177, v177
  v_exp_f32 v178, v178
  v_exp_f32 v179, v179
  v_pk_mul_f32 v[108:109], v[108:109], v[104:105]
  v_pk_mul_f32 v[110:111], v[110:111], v[106:107]
  v_pk_add_f32 v[176:177], v[176:177], 1.0 op_sel_hi:[1,0]
  v_pk_add_f32 v[178:179], v[178:179], 1.0 op_sel_hi:[1,0]
  v_rcp_f32 v176, v176
  v_rcp_f32 v177, v177
  v_rcp_f32 v178, v178
  v_rcp_f32 v179, v179
  v_pk_mul_f32 v[108:109], v[108:109], v[24:25] op_sel:[0,1] op_sel_hi:[1,1]
  v_pk_mul_f32 v[110:111], v[110:111], v[24:25] op_sel:[0,1] op_sel_hi:[1,1]
  v_pk_mul_f32 v[108:109], v[108:109], v[176:177]
  v_pk_mul_f32 v[110:111], v[110:111], v[178:179]
  v_cvt_pk_bf16_f32 v202, v108, v109
  v_cvt_pk_bf16_f32 v203, v110, v111
  buffer_store_dwordx4 v[200:203], v1, s[32:35], s68 offen offset:1024 sc1
  v_pk_fma_f32 v[112:113], v[160:161], v[24:25], v[112:113] op_sel_hi:[1,0,1]
  v_pk_fma_f32 v[114:115], v[162:163], v[24:25], v[114:115] op_sel_hi:[1,0,1]
  v_pk_fma_f32 v[116:117], v[164:165], v[24:25], v[116:117] op_sel_hi:[1,0,1]
  v_pk_fma_f32 v[118:119], v[166:167], v[24:25], v[118:119] op_sel_hi:[1,0,1]
  v_pk_mul_f32 v[176:177], v[112:113], v[112:113]
  v_pk_mul_f32 v[178:179], v[114:115], v[114:115]
  v_pk_fma_f32 v[176:177], v[176:177], v[26:27], v[26:27] op_sel:[0,1,0] op_sel_hi:[1,1,0]
  v_pk_fma_f32 v[178:179], v[178:179], v[26:27], v[26:27] op_sel:[0,1,0] op_sel_hi:[1,1,0]
  v_pk_mul_f32 v[176:177], v[176:177], v[112:113]
  v_pk_mul_f32 v[178:179], v[178:179], v[114:115]
  v_exp_f32 v176, v176
  v_exp_f32 v177, v177
  v_exp_f32 v178, v178
  v_exp_f32 v179, v179
  v_pk_mul_f32 v[116:117], v[116:117], v[112:113]
  v_pk_mul_f32 v[118:119], v[118:119], v[114:115]
  v_pk_add_f32 v[176:177], v[176:177], 1.0 op_sel_hi:[1,0]
  v_pk_add_f32 v[178:179], v[178:179], 1.0 op_sel_hi:[1,0]
  v_rcp_f32 v176, v176
  v_rcp_f32 v177, v177
  v_rcp_f32 v178, v178
  v_rcp_f32 v179, v179
  v_pk_mul_f32 v[116:117], v[116:117], v[24:25] op_sel:[0,1] op_sel_hi:[1,1]
  v_pk_mul_f32 v[118:119], v[118:119], v[24:25] op_sel:[0,1] op_sel_hi:[1,1]
  v_pk_mul_f32 v[116:117], v[116:117], v[176:177]
  v_pk_mul_f32 v[118:119], v[118:119], v[178:179]
  v_cvt_pk_bf16_f32 v204, v116, v117
  v_cvt_pk_bf16_f32 v205, v118, v119
  v_pk_fma_f32 v[120:121], v[168:169], v[24:25], v[120:121] op_sel_hi:[1,0,1]
  v_pk_fma_f32 v[122:123], v[170:171], v[24:25], v[122:123] op_sel_hi:[1,0,1]
  v_pk_fma_f32 v[124:125], v[172:173], v[24:25], v[124:125] op_sel_hi:[1,0,1]
  v_pk_fma_f32 v[126:127], v[174:175], v[24:25], v[126:127] op_sel_hi:[1,0,1]
  v_pk_mul_f32 v[176:177], v[120:121], v[120:121]
  v_pk_mul_f32 v[178:179], v[122:123], v[122:123]
  v_pk_fma_f32 v[176:177], v[176:177], v[26:27], v[26:27] op_sel:[0,1,0] op_sel_hi:[1,1,0]
  v_pk_fma_f32 v[178:179], v[178:179], v[26:27], v[26:27] op_sel:[0,1,0] op_sel_hi:[1,1,0]
  v_pk_mul_f32 v[176:177], v[176:177], v[120:121]
  v_pk_mul_f32 v[178:179], v[178:179], v[122:123]
  v_exp_f32 v176, v176
  v_exp_f32 v177, v177
  v_exp_f32 v178, v178
  v_exp_f32 v179, v179
  v_pk_mul_f32 v[124:125], v[124:125], v[120:121]
  v_pk_mul_f32 v[126:127], v[126:127], v[122:123]
  v_pk_add_f32 v[176:177], v[176:177], 1.0 op_sel_hi:[1,0]
  v_pk_add_f32 v[178:179], v[178:179], 1.0 op_sel_hi:[1,0]
  v_rcp_f32 v176, v176
  v_rcp_f32 v177, v177
  v_rcp_f32 v178, v178
  v_rcp_f32 v179, v179
  v_pk_mul_f32 v[124:125], v[124:125], v[24:25] op_sel:[0,1] op_sel_hi:[1,1]
  v_pk_mul_f32 v[126:127], v[126:127], v[24:25] op_sel:[0,1] op_sel_hi:[1,1]
  v_pk_mul_f32 v[124:125], v[124:125], v[176:177]
  v_pk_mul_f32 v[126:127], v[126:127], v[178:179]
  v_cvt_pk_bf16_f32 v206, v124, v125
  v_cvt_pk_bf16_f32 v207, v126, v127
  buffer_store_dwordx4 v[204:207], v1, s[32:35], s68 offen offset:2048 sc1
  s_lshl_b32 s53, s45, 6
  s_lshl_b32 s52, s49, 2
  s_add_u32 s53, s53, s52
  s_add_u32 s53, s53, 512
  s_lshl_b32 s52, s47, 7
  s_and_b32 s52, s52, 128
  s_lshr_b32 s55, s45, 1
  s_lshl_b32 s55, s55, 6
  s_add_u32 s52, s52, s55
  s_add_u32 s52, s52, 512
  s_lshl_b32 s54, s46, 10
  s_add_u32 s54, s54, 0x8000
  s_add_u32 s52, s52, s54
  s_add_u32 s53, s53, s54
  v_lshl_add_u32 v26, v0, 2, s52
  v_mov_b32 v25, s53
  s_lshl_b32 s54, s47, 2
  s_add_u32 s54, s54, s45
  s_mul_i32 s66, s54, 49152
  s_add_u32 s66, s66, 14680064
  s_waitcnt vmcnt(0)
  s_mov_b64 exec, 1
  s_cmp_eq_u32 s51, 0
  s_cbranch_scc1 L_ms26_g
  global_store_dword v25, v30, s[22:23]
  s_branch L_ms26_d
L_ms26_g:
  global_store_dword v25, v30, s[22:23] sc1
L_ms26_d:
  s_mov_b32 exec_lo, 0xffff
  s_mov_b32 s57, 0
L_sy25_p:
  global_load_dword v28, v26, s[22:23] sc1
  s_add_u32 s57, s57, 1
  s_waitcnt vmcnt(0)
  v_cmp_eq_u32 vcc, 0, v28
  s_cbranch_vccz L_sy25_q
  s_cmp_lt_u32 s57, 65536
  s_cbranch_scc1 L_sy25_p
L_sy25_q:
  s_mov_b64 exec, -1
  ds_read_b32 v31, v29 offset:100
  buffer_load_dwordx4 v[112:115], v1, s[32:35], s66 offen offset:0 sc1
  buffer_load_dwordx4 v[116:119], v1, s[32:35], s66 offen offset:1024 sc1
  buffer_load_dwordx4 v[120:123], v1, s[32:35], s66 offen offset:2048 sc1
  buffer_load_dwordx4 v[124:127], v1, s[32:35], s66 offen offset:3072 sc1
  s_add_u32 s66, s66, 4096
  buffer_load_dwordx4 v[128:131], v1, s[32:35], s66 offen offset:0 sc1
  buffer_load_dwordx4 v[132:135], v1, s[32:35], s66 offen offset:1024 sc1
  buffer_load_dwordx4 v[136:139], v1, s[32:35], s66 offen offset:2048 sc1
  buffer_load_dwordx4 v[140:143], v1, s[32:35], s66 offen offset:3072 sc1
  s_mov_b64 exec, 1
  ds_add_u32 v29, v30 offset:224
  s_mov_b64 exec, -1
  v_lshlrev_b32 v212, 16, v246
  v_and_b32 v213, 0xffff0000, v246
  v_lshlrev_b32 v214, 16, v247
  v_and_b32 v215, 0xffff0000, v247
  v_lshlrev_b32 v216, 16, v248
  v_and_b32 v217, 0xffff0000, v248
  v_lshlrev_b32 v218, 16, v249
  v_and_b32 v219, 0xffff0000, v249
  v_lshlrev_b32 v220, 16, v250
  v_and_b32 v221, 0xffff0000, v250
  v_lshlrev_b32 v222, 16, v251
  v_and_b32 v223, 0xffff0000, v251
  v_lshlrev_b32 v224, 16, v252
  v_and_b32 v225, 0xffff0000, v252
  v_lshlrev_b32 v226, 16, v253
  v_and_b32 v227, 0xffff0000, v253
  v_lshlrev_b32 v228, 16, v254
  v_and_b32 v229, 0xffff0000, v254
  v_lshlrev_b32 v230, 16, v255
  v_and_b32 v231, 0xffff0000, v255
  s_waitcnt lgkmcnt(1)
  v_readfirstlane_b32 s56, v31
  s_cmp_ge_u32 s56, 4
  s_cbranch_scc1 L_fl27_ok
  s_mov_b32 s57, 0
L_fl27:
  ds_read_b32 v31, v29 offset:100
  s_waitcnt lgkmcnt(0)
  v_readfirstlane_b32 s56, v31
  s_add_u32 s57, s57, 1
  s_cmp_ge_u32 s56, 4
  s_cbranch_scc1 L_fl27_ok
  s_cmp_lt_u32 s57, 1048576
  s_cbranch_scc1 L_fl27
L_fl27_ok:
  ds_read_b128 v[52:55], v1 offset:49152
  ds_read_b128 v[56:59], v1 offset:50176
  ds_read_b128 v[60:63], v1 offset:51200
  ds_read_b128 v[64:67], v1 offset:52224
  ds_read_b128 v[68:71], v1 offset:53248
  ds_read_b128 v[72:75], v1 offset:54272
  ds_read_b128 v[76:79], v1 offset:55296
  ds_read_b128 v[80:83], v1 offset:56320
  ds_read_b128 v[84:87], v1 offset:57344
  ds_read_b128 v[88:91], v1 offset:58368
  ds_read_b32 v31, v29 offset:104
  s_waitcnt vmcnt(7)
  s_waitcnt lgkmcnt(6)
  v_mfma_f32_16x16x32_bf16 v[32:35], v[52:55], v[112:115], 0
  ds_read_b128 v[92:95], v1 offset:59392
  v_mfma_f32_16x16x32_bf16 v[36:39], v[56:59], v[112:115], 0
  ds_read_b128 v[96:99], v1 offset:60416
  s_add_u32 s66, s66, 4096
  buffer_load_dwordx4 v[144:147], v1, s[32:35], s66 offen offset:0 sc1
  v_mfma_f32_16x16x32_bf16 v[40:43], v[60:63], v[112:115], 0
  ds_read_b128 v[100:103], v1 offset:61440
  v_mfma_f32_16x16x32_bf16 v[44:47], v[64:67], v[112:115], 0
  ds_read_b128 v[104:107], v1 offset:62464
  buffer_load_dwordx4 v[148:151], v1, s[32:35], s66 offen offset:1024 sc1
  v_mfma_f32_16x16x32_bf16 v[48:51], v[68:71], v[112:115], 0
  ds_read_b128 v[108:111], v1 offset:63488
  s_waitcnt vmcnt(8)
  s_waitcnt lgkmcnt(6)
  v_mfma_f32_16x16x32_bf16 v[32:35], v[72:75], v[116:119], v[32:35]
  ds_read_b128 v[52:55], v1 offset:64512
  v_mfma_f32_16x16x32_bf16 v[36:39], v[76:79], v[116:119], v[36:39]
  ds_read_b128 v[56:59], v13 offset:0
  buffer_load_dwordx4 v[152:155], v1, s[32:35], s66 offen offset:2048 sc1
  v_mfma_f32_16x16x32_bf16 v[40:43], v[80:83], v[116:119], v[40:43]
  ds_read_b128 v[60:63], v13 offset:1024
  v_mfma_f32_16x16x32_bf16 v[44:47], v[84:87], v[116:119], v[44:47]
  ds_read_b128 v[64:67], v13 offset:2048
  buffer_load_dwordx4 v[156:159], v1, s[32:35], s66 offen offset:3072 sc1
  v_mfma_f32_16x16x32_bf16 v[48:51], v[88:91], v[116:119], v[48:51]
  ds_read_b128 v[68:71], v13 offset:3072
  s_mov_b64 exec, 1
  ds_add_u32 v29, v30 offset:228
  s_mov_b64 exec, -1
  s_waitcnt lgkmcnt(11)
  v_readfirstlane_b32 s56, v31
  s_cmp_ge_u32 s56, 4
  s_cbranch_scc1 L_fl28_ok
  s_mov_b32 s57, 0
L_fl28:
  ds_read_b32 v31, v29 offset:104
  s_waitcnt lgkmcnt(0)
  v_readfirstlane_b32 s56, v31
  s_add_u32 s57, s57, 1
  s_cmp_ge_u32 s56, 4
  s_cbranch_scc1 L_fl28_ok
  s_cmp_lt_u32 s57, 1048576
  s_cbranch_scc1 L_fl28
L_fl28_ok:
  s_waitcnt vmcnt(9)
  s_waitcnt lgkmcnt(6)
  v_mfma_f32_16x16x32_bf16 v[32:35], v[92:95], v[120:123], v[32:35]
  ds_read_b128 v[72:75], v13 offset:4096
  v_mfma_f32_16x16x32_bf16 v[36:39], v[96:99], v[120:123], v[36:39]
  ds_read_b128 v[76:79], v13 offset:5120
  s_add_u32 s66, s66, 4096
  buffer_load_dwordx4 v[160:163], v1, s[32:35], s66 offen offset:0 sc1
  v_mfma_f32_16x16x32_bf16 v[40:43], v[100:103], v[120:123], v[40:43]
  ds_read_b128 v[80:83], v13 offset:6144
  v_mfma_f32_16x16x32_bf16 v[44:47], v[104:107], v[120:123], v[44:47]
  ds_read_b128 v[84:87], v13 offset:7168
  buffer_load_dwordx4 v[164:167], v1, s[32:35], s66 offen offset:1024 sc1
  v_mfma_f32_16x16x32_bf16 v[48:51], v[108:111], v[120:123], v[48:51]
  ds_read_b128 v[88:91], v13 offset:8192
  s_waitcnt vmcnt(10)
  s_waitcnt lgkmcnt(6)
  v_mfma_f32_16x16x32_bf16 v[32:35], v[52:55], v[124:127], v[32:35]
  ds_read_b128 v[92:95], v13 offset:9216
  v_mfma_f32_16x16x32_bf16 v[36:39], v[56:59], v[124:127], v[36:39]
  ds_read_b128 v[96:99], v13 offset:10240
  buffer_load_dwordx4 v[168:171], v1, s[32:35], s66 offen offset:2048 sc1
  v_mfma_f32_16x16x32_bf16 v[40:43], v[60:63], v[124:127], v[40:43]
  ds_read_b128 v[100:103], v13 offset:11264
  v_mfma_f32_16x16x32_bf16 v[44:47], v[64:67], v[124:127], v[44:47]
  ds_read_b128 v[104:107], v13 offset:12288
  buffer_load_dwordx4 v[172:175], v1, s[32:35], s66 offen offset:3072 sc1
  v_mfma_f32_16x16x32_bf16 v[48:51], v[68:71], v[124:127], v[48:51]
  ds_read_b128 v[108:111], v13 offset:13312
  ds_read_b32 v31, v29 offset:108
  s_waitcnt vmcnt(11)
  s_waitcnt lgkmcnt(6)
  v_mfma_f32_16x16x32_bf16 v[32:35], v[72:75], v[128:131], v[32:35]
  ds_read_b128 v[52:55], v13 offset:14336
  v_mfma_f32_16x16x32_bf16 v[36:39], v[76:79], v[128:131], v[36:39]
  ds_read_b128 v[56:59], v13 offset:15360
  s_add_u32 s66, s66, 4096
  buffer_load_dwordx4 v[112:115], v1, s[32:35], s66 offen offset:0 sc1
  v_mfma_f32_16x16x32_bf16 v[40:43], v[80:83], v[128:131], v[40:43]
  ds_read_b128 v[60:63], v13 offset:16384
  v_mfma_f32_16x16x32_bf16 v[44:47], v[84:87], v[128:131], v[44:47]
  ds_read_b128 v[64:67], v13 offset:17408
  buffer_load_dwordx4 v[116:119], v1, s[32:35], s66 offen offset:1024 sc1
  v_mfma_f32_16x16x32_bf16 v[48:51], v[88:91], v[128:131], v[48:51]
  ds_read_b128 v[68:71], v13 offset:18432
  s_waitcnt vmcnt(12)
  s_waitcnt lgkmcnt(6)
  v_mfma_f32_16x16x32_bf16 v[32:35], v[92:95], v[132:135], v[32:35]
  ds_read_b128 v[72:75], v13 offset:19456
  v_mfma_f32_16x16x32_bf16 v[36:39], v[96:99], v[132:135], v[36:39]
  ds_read_b128 v[76:79], v13 offset:20480
  buffer_load_dwordx4 v[120:123], v1, s[32:35], s66 offen offset:2048 sc1
  v_mfma_f32_16x16x32_bf16 v[40:43], v[100:103], v[132:135], v[40:43]
  ds_read_b128 v[80:83], v13 offset:21504
  v_mfma_f32_16x16x32_bf16 v[44:47], v[104:107], v[132:135], v[44:47]
  ds_read_b128 v[84:87], v13 offset:22528
  buffer_load_dwordx4 v[124:127], v1, s[32:35], s66 offen offset:3072 sc1
  v_mfma_f32_16x16x32_bf16 v[48:51], v[108:111], v[132:135], v[48:51]
  ds_read_b128 v[88:91], v13 offset:23552
  s_mov_b64 exec, 1
  ds_add_u32 v29, v30 offset:232
  s_mov_b64 exec, -1
  s_waitcnt lgkmcnt(11)
  v_readfirstlane_b32 s56, v31
  s_cmp_ge_u32 s56, 4
  s_cbranch_scc1 L_fl29_ok
  s_mov_b32 s57, 0
L_fl29:
  ds_read_b32 v31, v29 offset:108
  s_waitcnt lgkmcnt(0)
  v_readfirstlane_b32 s56, v31
  s_add_u32 s57, s57, 1
  s_cmp_ge_u32 s56, 4
  s_cbranch_scc1 L_fl29_ok
  s_cmp_lt_u32 s57, 1048576
  s_cbranch_scc1 L_fl29
L_fl29_ok:
  s_waitcnt vmcnt(13)
  s_waitcnt lgkmcnt(6)
  v_mfma_f32_16x16x32_bf16 v[32:35], v[52:55], v[136:139], v[32:35]
  ds_read_b128 v[92:95], v13 offset:24576
  v_mfma_f32_16x16x32_bf16 v[36:39], v[56:59], v[136:139], v[36:39]
  ds_read_b128 v[96:99], v13 offset:25600
  s_add_u32 s66, s66, 4096
  buffer_load_dwordx4 v[128:131], v1, s[32:35], s66 offen offset:0 sc1
  v_mfma_f32_16x16x32_bf16 v[40:43], v[60:63], v[136:139], v[40:43]
  ds_read_b128 v[100:103], v13 offset:26624
  v_mfma_f32_16x16x32_bf16 v[44:47], v[64:67], v[136:139], v[44:47]
  ds_read_b128 v[104:107], v13 offset:27648
  buffer_load_dwordx4 v[132:135], v1, s[32:35], s66 offen offset:1024 sc1
  v_mfma_f32_16x16x32_bf16 v[48:51], v[68:71], v[136:139], v[48:51]
  ds_read_b128 v[108:111], v13 offset:28672
  s_waitcnt vmcnt(14)
  s_waitcnt lgkmcnt(6)
  v_mfma_f32_16x16x32_bf16 v[32:35], v[72:75], v[140:143], v[32:35]
  ds_read_b128 v[52:55], v13 offset:29696
  v_mfma_f32_16x16x32_bf16 v[36:39], v[76:79], v[140:143], v[36:39]
  ds_read_b128 v[56:59], v13 offset:30720
  buffer_load_dwordx4 v[136:139], v1, s[32:35], s66 offen offset:2048 sc1
  v_mfma_f32_16x16x32_bf16 v[40:43], v[80:83], v[140:143], v[40:43]
  ds_read_b128 v[60:63], v13 offset:31744
  v_mfma_f32_16x16x32_bf16 v[44:47], v[84:87], v[140:143], v[44:47]
  ds_read_b128 v[64:67], v13 offset:32768
  v_mfma_f32_16x16x32_bf16 v[48:51], v[88:91], v[140:143], v[48:51]
  ds_read_b128 v[68:71], v13 offset:33792
  ds_read_b32 v31, v29 offset:112
  s_waitcnt vmcnt(14)
  s_waitcnt lgkmcnt(6)
  v_mfma_f32_16x16x32_bf16 v[32:35], v[92:95], v[144:147], v[32:35]
  ds_read_b128 v[72:75], v13 offset:34816
  v_mfma_f32_16x16x32_bf16 v[36:39], v[96:99], v[144:147], v[36:39]
  ds_read_b128 v[76:79], v13 offset:35840
  buffer_load_dwordx4 v[140:143], v1, s[32:35], s66 offen offset:3072 sc1
  v_mfma_f32_16x16x32_bf16 v[40:43], v[100:103], v[144:147], v[40:43]
  ds_read_b128 v[80:83], v13 offset:36864
  v_mfma_f32_16x16x32_bf16 v[44:47], v[104:107], v[144:147], v[44:47]
  ds_read_b128 v[84:87], v13 offset:37888
  v_mfma_f32_16x16x32_bf16 v[48:51], v[108:111], v[144:147], v[48:51]
  ds_read_b128 v[88:91], v13 offset:38912
  s_waitcnt vmcnt(14)
  s_waitcnt lgkmcnt(6)
  v_mfma_f32_16x16x32_bf16 v[32:35], v[52:55], v[148:151], v[32:35]
  ds_read_b128 v[92:95], v13 offset:39936
  v_mfma_f32_16x16x32_bf16 v[36:39], v[56:59], v[148:151], v[36:39]
  ds_read_b128 v[96:99], v13 offset:40960
  s_add_u32 s66, s66, 4096
  buffer_load_dwordx4 v[144:147], v1, s[32:35], s66 offen offset:0 sc1
  v_mfma_f32_16x16x32_bf16 v[40:43], v[60:63], v[148:151], v[40:43]
  ds_read_b128 v[100:103], v13 offset:41984
  v_mfma_f32_16x16x32_bf16 v[44:47], v[64:67], v[148:151], v[44:47]
  ds_read_b128 v[104:107], v13 offset:43008
  v_mfma_f32_16x16x32_bf16 v[48:51], v[68:71], v[148:151], v[48:51]
  ds_read_b128 v[108:111], v13 offset:44032
  s_mov_b64 exec, 1
  ds_add_u32 v29, v30 offset:236
  s_mov_b64 exec, -1
  s_waitcnt lgkmcnt(11)
  v_readfirstlane_b32 s56, v31
  s_cmp_ge_u32 s56, 4
  s_cbranch_scc1 L_fl30_ok
  s_mov_b32 s57, 0
L_fl30:
  ds_read_b32 v31, v29 offset:112
  s_waitcnt lgkmcnt(0)
  v_readfirstlane_b32 s56, v31
  s_add_u32 s57, s57, 1
  s_cmp_ge_u32 s56, 4
  s_cbranch_scc1 L_fl30_ok
  s_cmp_lt_u32 s57, 1048576
  s_cbranch_scc1 L_fl30
L_fl30_ok:
  s_waitcnt vmcnt(14)
  s_waitcnt lgkmcnt(6)
  v_mfma_f32_16x16x32_bf16 v[32:35], v[72:75], v[152:155], v[32:35]
  ds_read_b128 v[52:55], v13 offset:45056
  v_mfma_f32_16x16x32_bf16 v[36:39], v[76:79], v[152:155], v[36:39]
  ds_read_b128 v[56:59], v13 offset:46080
  buffer_load_dwordx4 v[148:151], v1, s[32:35], s66 offen offset:1024 sc1
  v_mfma_f32_16x16x32_bf16 v[40:43], v[80:83], v[152:155], v[40:43]
  ds_read_b128 v[60:63], v13 offset:47104
  v_mfma_f32_16x16x32_bf16 v[44:47], v[84:87], v[152:155], v[44:47]
  ds_read_b128 v[64:67], v13 offset:48128
  v_mfma_f32_16x16x32_bf16 v[48:51], v[88:91], v[152:155], v[48:51]
  ds_read_b128 v[68:71], v13 offset:49152
  s_waitcnt vmcnt(14)
  s_waitcnt lgkmcnt(6)
  v_mfma_f32_16x16x32_bf16 v[32:35], v[92:95], v[156:159], v[32:35]
  ds_read_b128 v[72:75], v13 offset:50176
  v_mfma_f32_16x16x32_bf16 v[36:39], v[96:99], v[156:159], v[36:39]
  ds_read_b128 v[76:79], v13 offset:51200
  buffer_load_dwordx4 v[152:155], v1, s[32:35], s66 offen offset:2048 sc1
  v_mfma_f32_16x16x32_bf16 v[40:43], v[100:103], v[156:159], v[40:43]
  ds_read_b128 v[80:83], v13 offset:52224
  v_mfma_f32_16x16x32_bf16 v[44:47], v[104:107], v[156:159], v[44:47]
  ds_read_b128 v[84:87], v13 offset:53248
  v_mfma_f32_16x16x32_bf16 v[48:51], v[108:111], v[156:159], v[48:51]
  ds_read_b128 v[88:91], v13 offset:54272
  ds_read_b32 v31, v29 offset:116
  s_waitcnt vmcnt(14)
  s_waitcnt lgkmcnt(6)
  v_mfma_f32_16x16x32_bf16 v[32:35], v[52:55], v[160:163], v[32:35]
  ds_read_b128 v[92:95], v13 offset:55296
  v_mfma_f32_16x16x32_bf16 v[36:39], v[56:59], v[160:163], v[36:39]
  ds_read_b128 v[96:99], v13 offset:56320
  buffer_load_dwordx4 v[156:159], v1, s[32:35], s66 offen offset:3072 sc1
  v_mfma_f32_16x16x32_bf16 v[40:43], v[60:63], v[160:163], v[40:43]
  ds_read_b128 v[100:103], v13 offset:57344
  v_mfma_f32_16x16x32_bf16 v[44:47], v[64:67], v[160:163], v[44:47]
  ds_read_b128 v[104:107], v13 offset:58368
  v_mfma_f32_16x16x32_bf16 v[48:51], v[68:71], v[160:163], v[48:51]
  ds_read_b128 v[108:111], v13 offset:59392
  s_waitcnt vmcnt(14)
  s_waitcnt lgkmcnt(6)
  v_mfma_f32_16x16x32_bf16 v[32:35], v[72:75], v[164:167], v[32:35]
  ds_read_b128 v[52:55], v13 offset:60416
  v_mfma_f32_16x16x32_bf16 v[36:39], v[76:79], v[164:167], v[36:39]
  ds_read_b128 v[56:59], v13 offset:61440
  s_add_u32 s66, s66, 4096
  buffer_load_dwordx4 v[160:163], v1, s[32:35], s66 offen offset:0 sc1
  v_mfma_f32_16x16x32_bf16 v[40:43], v[80:83], v[164:167], v[40:43]
  ds_read_b128 v[60:63], v13 offset:62464
  v_mfma_f32_16x16x32_bf16 v[44:47], v[84:87], v[164:167], v[44:47]
  ds_read_b128 v[64:67], v13 offset:63488
  v_mfma_f32_16x16x32_bf16 v[48:51], v[88:91], v[164:167], v[48:51]
  ds_read_b128 v[68:71], v13 offset:64512
  s_mov_b64 exec, 1
  ds_add_u32 v29, v30 offset:240
  s_mov_b64 exec, -1
  s_waitcnt lgkmcnt(11)
  v_readfirstlane_b32 s56, v31
  s_cmp_ge_u32 s56, 4
  s_cbranch_scc1 L_fl31_ok
  s_mov_b32 s57, 0
L_fl31:
  ds_read_b32 v31, v29 offset:116
  s_waitcnt lgkmcnt(0)
  v_readfirstlane_b32 s56, v31
  s_add_u32 s57, s57, 1
  s_cmp_ge_u32 s56, 4
  s_cbranch_scc1 L_fl31_ok
  s_cmp_lt_u32 s57, 1048576
  s_cbranch_scc1 L_fl31
L_fl31_ok:
  s_waitcnt vmcnt(14)
  s_waitcnt lgkmcnt(6)
  v_mfma_f32_16x16x32_bf16 v[32:35], v[92:95], v[168:171], v[32:35]
  ds_read_b128 v[72:75], v1 offset:0
  v_mfma_f32_16x16x32_bf16 v[36:39], v[96:99], v[168:171], v[36:39]
  ds_read_b128 v[76:79], v1 offset:1024
  buffer_load_dwordx4 v[164:167], v1, s[32:35], s66 offen offset:1024 sc1
  v_mfma_f32_16x16x32_bf16 v[40:43], v[100:103], v[168:171], v[40:43]
  ds_read_b128 v[80:83], v1 offset:2048
  v_mfma_f32_16x16x32_bf16 v[44:47], v[104:107], v[168:171], v[44:47]
  ds_read_b128 v[84:87], v1 offset:3072
  v_mfma_f32_16x16x32_bf16 v[48:51], v[108:111], v[168:171], v[48:51]
  ds_read_b128 v[88:91], v1 offset:4096
  s_waitcnt vmcnt(14)
  s_waitcnt lgkmcnt(6)
  v_mfma_f32_16x16x32_bf16 v[32:35], v[52:55], v[172:175], v[32:35]
  ds_read_b128 v[92:95], v1 offset:5120
  v_mfma_f32_16x16x32_bf16 v[36:39], v[56:59], v[172:175], v[36:39]
  ds_read_b128 v[96:99], v1 offset:6144
  buffer_load_dwordx4 v[168:171], v1, s[32:35], s66 offen offset:2048 sc1
  v_mfma_f32_16x16x32_bf16 v[40:43], v[60:63], v[172:175], v[40:43]
  ds_read_b128 v[100:103], v1 offset:7168
  v_mfma_f32_16x16x32_bf16 v[44:47], v[64:67], v[172:175], v[44:47]
  ds_read_b128 v[104:107], v1 offset:8192
  v_mfma_f32_16x16x32_bf16 v[48:51], v[68:71], v[172:175], v[48:51]
  ds_read_b128 v[108:111], v1 offset:9216
  ds_read_b32 v31, v29 offset:120
  s_waitcnt vmcnt(14)
  s_waitcnt lgkmcnt(6)
  v_mfma_f32_16x16x32_bf16 v[32:35], v[72:75], v[112:115], v[32:35]
  ds_read_b128 v[52:55], v1 offset:10240
  v_mfma_f32_16x16x32_bf16 v[36:39], v[76:79], v[112:115], v[36:39]
  ds_read_b128 v[56:59], v1 offset:11264
  buffer_load_dwordx4 v[172:175], v1, s[32:35], s66 offen offset:3072 sc1
  v_mfma_f32_16x16x32_bf16 v[40:43], v[80:83], v[112:115], v[40:43]
  ds_read_b128 v[60:63], v1 offset:12288
  v_mfma_f32_16x16x32_bf16 v[44:47], v[84:87], v[112:115], v[44:47]
  ds_read_b128 v[64:67], v1 offset:13312
  v_mfma_f32_16x16x32_bf16 v[48:51], v[88:91], v[112:115], v[48:51]
  ds_read_b128 v[68:71], v1 offset:14336
  s_waitcnt vmcnt(14)
  s_waitcnt lgkmcnt(6)
  v_mfma_f32_16x16x32_bf16 v[32:35], v[92:95], v[116:119], v[32:35]
  ds_read_b128 v[72:75], v1 offset:15360
  v_mfma_f32_16x16x32_bf16 v[36:39], v[96:99], v[116:119], v[36:39]
  ds_read_b128 v[76:79], v1 offset:16384
  s_add_u32 s66, s66, 4096
  buffer_load_dwordx4 v[112:115], v1, s[32:35], s66 offen offset:0 sc1
  v_mfma_f32_16x16x32_bf16 v[40:43], v[100:103], v[116:119], v[40:43]
  ds_read_b128 v[80:83], v1 offset:17408
  v_mfma_f32_16x16x32_bf16 v[44:47], v[104:107], v[116:119], v[44:47]
  ds_read_b128 v[84:87], v1 offset:18432
  v_mfma_f32_16x16x32_bf16 v[48:51], v[108:111], v[116:119], v[48:51]
  ds_read_b128 v[88:91], v1 offset:19456
  s_mov_b64 exec, 1
  ds_add_u32 v29, v30 offset:244
  s_mov_b64 exec, -1
  s_waitcnt lgkmcnt(11)
  v_readfirstlane_b32 s56, v31
  s_cmp_ge_u32 s56, 4
  s_cbranch_scc1 L_fl32_ok
  s_mov_b32 s57, 0
L_fl32:
  ds_read_b32 v31, v29 offset:120
  s_waitcnt lgkmcnt(0)
  v_readfirstlane_b32 s56, v31
  s_add_u32 s57, s57, 1
  s_cmp_ge_u32 s56, 4
  s_cbranch_scc1 L_fl32_ok
  s_cmp_lt_u32 s57, 1048576
  s_cbranch_scc1 L_fl32
L_fl32_ok:
  s_waitcnt vmcnt(14)
  s_waitcnt lgkmcnt(6)
  v_mfma_f32_16x16x32_bf16 v[32:35], v[52:55], v[120:123], v[32:35]
  ds_read_b128 v[92:95], v14 offset:0
  v_mfma_f32_16x16x32_bf16 v[36:39], v[56:59], v[120:123], v[36:39]
  ds_read_b128 v[96:99], v14 offset:1024
  buffer_load_dwordx4 v[116:119], v1, s[32:35], s66 offen offset:1024 sc1
  v_mfma_f32_16x16x32_bf16 v[40:43], v[60:63], v[120:123], v[40:43]
  ds_read_b128 v[100:103], v14 offset:2048
  v_mfma_f32_16x16x32_bf16 v[44:47], v[64:67], v[120:123], v[44:47]
  ds_read_b128 v[104:107], v14 offset:3072
  v_mfma_f32_16x16x32_bf16 v[48:51], v[68:71], v[120:123], v[48:51]
  ds_read_b128 v[108:111], v14 offset:4096
  s_waitcnt vmcnt(14)
  s_waitcnt lgkmcnt(6)
  v_mfma_f32_16x16x32_bf16 v[32:35], v[72:75], v[124:127], v[32:35]
  ds_read_b128 v[52:55], v14 offset:5120
  v_mfma_f32_16x16x32_bf16 v[36:39], v[76:79], v[124:127], v[36:39]
  ds_read_b128 v[56:59], v14 offset:6144
  buffer_load_dwordx4 v[120:123], v1, s[32:35], s66 offen offset:2048 sc1
  v_mfma_f32_16x16x32_bf16 v[40:43], v[80:83], v[124:127], v[40:43]
  ds_read_b128 v[60:63], v14 offset:7168
  v_mfma_f32_16x16x32_bf16 v[44:47], v[84:87], v[124:127], v[44:47]
  ds_read_b128 v[64:67], v14 offset:8192
  v_mfma_f32_16x16x32_bf16 v[48:51], v[88:91], v[124:127], v[48:51]
  ds_read_b128 v[68:71], v14 offset:9216
  ds_read_b32 v31, v29 offset:124
  s_waitcnt vmcnt(14)
  s_waitcnt lgkmcnt(6)
  v_mfma_f32_16x16x32_bf16 v[32:35], v[92:95], v[128:131], v[32:35]
  ds_read_b128 v[72:75], v14 offset:10240
  v_mfma_f32_16x16x32_bf16 v[36:39], v[96:99], v[128:131], v[36:39]
  ds_read_b128 v[76:79], v14 offset:11264
  buffer_load_dwordx4 v[124:127], v1, s[32:35], s66 offen offset:3072 sc1
  v_mfma_f32_16x16x32_bf16 v[40:43], v[100:103], v[128:131], v[40:43]
  ds_read_b128 v[80:83], v14 offset:12288
  v_mfma_f32_16x16x32_bf16 v[44:47], v[104:107], v[128:131], v[44:47]
  ds_read_b128 v[84:87], v14 offset:13312
  v_mfma_f32_16x16x32_bf16 v[48:51], v[108:111], v[128:131], v[48:51]
  ds_read_b128 v[88:91], v14 offset:14336
  s_waitcnt vmcnt(14)
  s_waitcnt lgkmcnt(6)
  v_mfma_f32_16x16x32_bf16 v[32:35], v[52:55], v[132:135], v[32:35]
  ds_read_b128 v[92:95], v14 offset:15360
  v_mfma_f32_16x16x32_bf16 v[36:39], v[56:59], v[132:135], v[36:39]
  ds_read_b128 v[96:99], v14 offset:16384
  s_add_u32 s66, s66, 4096
  buffer_load_dwordx4 v[128:131], v1, s[32:35], s66 offen offset:0 sc1
  v_mfma_f32_16x16x32_bf16 v[40:43], v[60:63], v[132:135], v[40:43]
  ds_read_b128 v[100:103], v14 offset:17408
  v_mfma_f32_16x16x32_bf16 v[44:47], v[64:67], v[132:135], v[44:47]
  ds_read_b128 v[104:107], v14 offset:18432
  v_mfma_f32_16x16x32_bf16 v[48:51], v[68:71], v[132:135], v[48:51]
  ds_read_b128 v[108:111], v14 offset:19456
  s_mov_b64 exec, 1
  ds_add_u32 v29, v30 offset:248
  s_mov_b64 exec, -1
  s_waitcnt lgkmcnt(11)
  v_readfirstlane_b32 s56, v31
  s_cmp_ge_u32 s56, 4
  s_cbranch_scc1 L_fl33_ok
  s_mov_b32 s57, 0
L_fl33:
  ds_read_b32 v31, v29 offset:124
  s_waitcnt lgkmcnt(0)
  v_readfirstlane_b32 s56, v31
  s_add_u32 s57, s57, 1
  s_cmp_ge_u32 s56, 4
  s_cbranch_scc1 L_fl33_ok
  s_cmp_lt_u32 s57, 1048576
  s_cbranch_scc1 L_fl33
L_fl33_ok:
  s_waitcnt vmcnt(14)
  s_waitcnt lgkmcnt(6)
  v_mfma_f32_16x16x32_bf16 v[32:35], v[72:75], v[136:139], v[32:35]
  ds_read_b128 v[52:55], v1 offset:20480
  v_mfma_f32_16x16x32_bf16 v[36:39], v[76:79], v[136:139], v[36:39]
  ds_read_b128 v[56:59], v1 offset:21504
  buffer_load_dwordx4 v[132:135], v1, s[32:35], s66 offen offset:1024 sc1
  v_mfma_f32_16x16x32_bf16 v[40:43], v[80:83], v[136:139], v[40:43]
  ds_read_b128 v[60:63], v1 offset:22528
  v_mfma_f32_16x16x32_bf16 v[44:47], v[84:87], v[136:139], v[44:47]
  ds_read_b128 v[64:67], v1 offset:23552
  v_mfma_f32_16x16x32_bf16 v[48:51], v[88:91], v[136:139], v[48:51]
  ds_read_b128 v[68:71], v1 offset:24576
  s_waitcnt vmcnt(14)
  s_waitcnt lgkmcnt(6)
  v_mfma_f32_16x16x32_bf16 v[32:35], v[92:95], v[140:143], v[32:35]
  ds_read_b128 v[72:75], v1 offset:25600
  v_mfma_f32_16x16x32_bf16 v[36:39], v[96:99], v[140:143], v[36:39]
  ds_read_b128 v[76:79], v1 offset:26624
  buffer_load_dwordx4 v[136:139], v1, s[32:35], s66 offen offset:2048 sc1
  v_mfma_f32_16x16x32_bf16 v[40:43], v[100:103], v[140:143], v[40:43]
  ds_read_b128 v[80:83], v1 offset:27648
  v_mfma_f32_16x16x32_bf16 v[44:47], v[104:107], v[140:143], v[44:47]
  ds_read_b128 v[84:87], v1 offset:28672
  v_mfma_f32_16x16x32_bf16 v[48:51], v[108:111], v[140:143], v[48:51]
  ds_read_b128 v[88:91], v1 offset:29696
  ds_read_b32 v31, v29 offset:128
  s_waitcnt vmcnt(14)
  s_waitcnt lgkmcnt(6)
  v_mfma_f32_16x16x32_bf16 v[32:35], v[52:55], v[144:147], v[32:35]
  ds_read_b128 v[92:95], v1 offset:30720
  v_mfma_f32_16x16x32_bf16 v[36:39], v[56:59], v[144:147], v[36:39]
  ds_read_b128 v[96:99], v1 offset:31744
  buffer_load_dwordx4 v[140:143], v1, s[32:35], s66 offen offset:3072 sc1
  v_mfma_f32_16x16x32_bf16 v[40:43], v[60:63], v[144:147], v[40:43]
  ds_read_b128 v[100:103], v1 offset:32768
  v_mfma_f32_16x16x32_bf16 v[44:47], v[64:67], v[144:147], v[44:47]
  ds_read_b128 v[104:107], v1 offset:33792
  v_mfma_f32_16x16x32_bf16 v[48:51], v[68:71], v[144:147], v[48:51]
  ds_read_b128 v[108:111], v1 offset:34816
  s_waitcnt vmcnt(14)
  s_waitcnt lgkmcnt(6)
  v_mfma_f32_16x16x32_bf16 v[32:35], v[72:75], v[148:151], v[32:35]
  ds_read_b128 v[52:55], v1 offset:35840
  v_mfma_f32_16x16x32_bf16 v[36:39], v[76:79], v[148:151], v[36:39]
  ds_read_b128 v[56:59], v1 offset:36864
  s_add_u32 s66, s66, 4096
  buffer_load_dwordx4 v[144:147], v1, s[32:35], s66 offen offset:0 sc1
  v_mfma_f32_16x16x32_bf16 v[40:43], v[80:83], v[148:151], v[40:43]
  ds_read_b128 v[60:63], v1 offset:37888
  v_mfma_f32_16x16x32_bf16 v[44:47], v[84:87], v[148:151], v[44:47]
  ds_read_b128 v[64:67], v1 offset:38912
  v_mfma_f32_16x16x32_bf16 v[48:51], v[88:91], v[148:151], v[48:51]
  ds_read_b128 v[68:71], v1 offset:39936
  s_waitcnt lgkmcnt(10)
  v_readfirstlane_b32 s56, v31
  s_cmp_ge_u32 s56, 4
  s_cbranch_scc1 L_fl34_ok
  s_mov_b32 s57, 0
L_fl34:
  ds_read_b32 v31, v29 offset:128
  s_waitcnt lgkmcnt(0)
  v_readfirstlane_b32 s56, v31
  s_add_u32 s57, s57, 1
  s_cmp_ge_u32 s56, 4
  s_cbranch_scc1 L_fl34_ok
  s_cmp_lt_u32 s57, 1048576
  s_cbranch_scc1 L_fl34
L_fl34_ok:
  s_waitcnt vmcnt(14)
  s_waitcnt lgkmcnt(5)
  v_mfma_f32_16x16x32_bf16 v[32:35], v[92:95], v[152:155], v[32:35]
  ds_read_b128 v[72:75], v1 offset:40960
  v_mfma_f32_16x16x32_bf16 v[36:39], v[96:99], v[152:155], v[36:39]
  ds_read_b128 v[76:79], v1 offset:41984
  buffer_load_dwordx4 v[148:151], v1, s[32:35], s66 offen offset:1024 sc1
  v_mfma_f32_16x16x32_bf16 v[40:43], v[100:103], v[152:155], v[40:43]
  ds_read_b128 v[80:83], v1 offset:43008
  v_mfma_f32_16x16x32_bf16 v[44:47], v[104:107], v[152:155], v[44:47]
  ds_read_b128 v[84:87], v1 offset:44032
  v_mfma_f32_16x16x32_bf16 v[48:51], v[108:111], v[152:155], v[48:51]
  ds_read_b128 v[88:91], v1 offset:45056
  s_waitcnt vmcnt(14)
  s_waitcnt lgkmcnt(5)
  v_mfma_f32_16x16x32_bf16 v[32:35], v[52:55], v[156:159], v[32:35]
  ds_read_b128 v[92:95], v1 offset:46080
  v_mfma_f32_16x16x32_bf16 v[36:39], v[56:59], v[156:159], v[36:39]
  ds_read_b128 v[96:99], v1 offset:47104
  buffer_load_dwordx4 v[152:155], v1, s[32:35], s66 offen offset:2048 sc1
  v_mfma_f32_16x16x32_bf16 v[40:43], v[60:63], v[156:159], v[40:43]
  ds_read_b128 v[100:103], v1 offset:48128
  v_mfma_f32_16x16x32_bf16 v[44:47], v[64:67], v[156:159], v[44:47]
  ds_read_b128 v[104:107], v1 offset:49152
  v_mfma_f32_16x16x32_bf16 v[48:51], v[68:71], v[156:159], v[48:51]
  ds_read_b128 v[108:111], v1 offset:50176
  ds_read_b32 v31, v29 offset:132
  s_waitcnt vmcnt(14)
  s_waitcnt lgkmcnt(6)
  v_mfma_f32_16x16x32_bf16 v[32:35], v[72:75], v[160:163], v[32:35]
  ds_read_b128 v[52:55], v1 offset:51200
  v_mfma_f32_16x16x32_bf16 v[36:39], v[76:79], v[160:163], v[36:39]
  ds_read_b128 v[56:59], v1 offset:52224
  buffer_load_dwordx4 v[156:159], v1, s[32:35], s66 offen offset:3072 sc1
  v_mfma_f32_16x16x32_bf16 v[40:43], v[80:83], v[160:163], v[40:43]
  ds_read_b128 v[60:63], v1 offset:53248
  v_mfma_f32_16x16x32_bf16 v[44:47], v[84:87], v[160:163], v[44:47]
  ds_read_b128 v[64:67], v1 offset:54272
  v_mfma_f32_16x16x32_bf16 v[48:51], v[88:91], v[160:163], v[48:51]
  ds_read_b128 v[68:71], v1 offset:55296
  s_waitcnt vmcnt(14)
  s_waitcnt lgkmcnt(6)
  v_mfma_f32_16x16x32_bf16 v[32:35], v[92:95], v[164:167], v[32:35]
  ds_read_b128 v[72:75], v1 offset:56320
  v_mfma_f32_16x16x32_bf16 v[36:39], v[96:99], v[164:167], v[36:39]
  ds_read_b128 v[76:79], v1 offset:57344
  s_add_u32 s66, s66, 4096
  buffer_load_dwordx4 v[160:163], v1, s[32:35], s66 offen offset:0 sc1
  v_mfma_f32_16x16x32_bf16 v[40:43], v[100:103], v[164:167], v[40:43]
  ds_read_b128 v[80:83], v1 offset:58368
  v_mfma_f32_16x16x32_bf16 v[44:47], v[104:107], v[164:167], v[44:47]
  ds_read_b128 v[84:87], v1 offset:59392
  v_mfma_f32_16x16x32_bf16 v[48:51], v[108:111], v[164:167], v[48:51]
  ds_read_b128 v[88:91], v1 offset:60416
  s_waitcnt lgkmcnt(10)
  v_readfirstlane_b32 s56, v31
  s_cmp_ge_u32 s56, 4
  s_cbranch_scc1 L_fl35_ok
  s_mov_b32 s57, 0
L_fl35:
  ds_read_b32 v31, v29 offset:132
  s_waitcnt lgkmcnt(0)
  v_readfirstlane_b32 s56, v31
  s_add_u32 s57, s57, 1
  s_cmp_ge_u32 s56, 4
  s_cbranch_scc1 L_fl35_ok
  s_cmp_lt_u32 s57, 1048576
  s_cbranch_scc1 L_fl35
L_fl35_ok:
  s_waitcnt vmcnt(14)
  s_waitcnt lgkmcnt(5)
  v_mfma_f32_16x16x32_bf16 v[32:35], v[52:55], v[168:171], v[32:35]
  ds_read_b128 v[92:95], v1 offset:61440
  v_mfma_f32_16x16x32_bf16 v[36:39], v[56:59], v[168:171], v[36:39]
  ds_read_b128 v[96:99], v1 offset:62464
  buffer_load_dwordx4 v[164:167], v1, s[32:35], s66 offen offset:1024 sc1
  v_mfma_f32_16x16x32_bf16 v[40:43], v[60:63], v[168:171], v[40:43]
  ds_read_b128 v[100:103], v1 offset:63488
  v_mfma_f32_16x16x32_bf16 v[44:47], v[64:67], v[168:171], v[44:47]
  ds_read_b128 v[104:107], v1 offset:64512
  v_mfma_f32_16x16x32_bf16 v[48:51], v[68:71], v[168:171], v[48:51]
  ds_read_b128 v[108:111], v13 offset:0
  s_waitcnt vmcnt(14)
  s_waitcnt lgkmcnt(5)
  v_mfma_f32_16x16x32_bf16 v[32:35], v[72:75], v[172:175], v[32:35]
  ds_read_b128 v[52:55], v13 offset:1024
  v_mfma_f32_16x16x32_bf16 v[36:39], v[76:79], v[172:175], v[36:39]
  ds_read_b128 v[56:59], v13 offset:2048
  buffer_load_dwordx4 v[168:171], v1, s[32:35], s66 offen offset:2048 sc1
  v_mfma_f32_16x16x32_bf16 v[40:43], v[80:83], v[172:175], v[40:43]
  ds_read_b128 v[60:63], v13 offset:3072
  v_mfma_f32_16x16x32_bf16 v[44:47], v[84:87], v[172:175], v[44:47]
  ds_read_b128 v[64:67], v13 offset:4096
  v_mfma_f32_16x16x32_bf16 v[48:51], v[88:91], v[172:175], v[48:51]
  ds_read_b128 v[68:71], v13 offset:5120
  ds_read_b32 v31, v29 offset:136
  s_waitcnt vmcnt(14)
  s_waitcnt lgkmcnt(6)
  v_mfma_f32_16x16x32_bf16 v[32:35], v[92:95], v[112:115], v[32:35]
  ds_read_b128 v[72:75], v13 offset:6144
  v_mfma_f32_16x16x32_bf16 v[36:39], v[96:99], v[112:115], v[36:39]
  ds_read_b128 v[76:79], v13 offset:7168
  buffer_load_dwordx4 v[172:175], v1, s[32:35], s66 offen offset:3072 sc1
  v_mfma_f32_16x16x32_bf16 v[40:43], v[100:103], v[112:115], v[40:43]
  ds_read_b128 v[80:83], v13 offset:8192
  v_mfma_f32_16x16x32_bf16 v[44:47], v[104:107], v[112:115], v[44:47]
  ds_read_b128 v[84:87], v13 offset:9216
  v_mfma_f32_16x16x32_bf16 v[48:51], v[108:111], v[112:115], v[48:51]
  ds_read_b128 v[88:91], v13 offset:10240
  s_waitcnt vmcnt(14)
  s_waitcnt lgkmcnt(6)
  v_mfma_f32_16x16x32_bf16 v[32:35], v[52:55], v[116:119], v[32:35]
  ds_read_b128 v[92:95], v13 offset:11264
  v_mfma_f32_16x16x32_bf16 v[36:39], v[56:59], v[116:119], v[36:39]
  ds_read_b128 v[96:99], v13 offset:12288
  v_mfma_f32_16x16x32_bf16 v[40:43], v[60:63], v[116:119], v[40:43]
  ds_read_b128 v[100:103], v13 offset:13312
  v_mfma_f32_16x16x32_bf16 v[44:47], v[64:67], v[116:119], v[44:47]
  ds_read_b128 v[104:107], v13 offset:14336
  v_mfma_f32_16x16x32_bf16 v[48:51], v[68:71], v[116:119], v[48:51]
  ds_read_b128 v[108:111], v13 offset:15360
  s_waitcnt lgkmcnt(10)
  v_readfirstlane_b32 s56, v31
  s_cmp_ge_u32 s56, 4
  s_cbranch_scc1 L_fl36_ok
  s_mov_b32 s57, 0
L_fl36:
  ds_read_b32 v31, v29 offset:136
  s_waitcnt lgkmcnt(0)
  v_readfirstlane_b32 s56, v31
  s_add_u32 s57, s57, 1
  s_cmp_ge_u32 s56, 4
  s_cbranch_scc1 L_fl36_ok
  s_cmp_lt_u32 s57, 1048576
  s_cbranch_scc1 L_fl36
L_fl36_ok:
  s_waitcnt vmcnt(13)
  s_waitcnt lgkmcnt(5)
  v_mfma_f32_16x16x32_bf16 v[32:35], v[72:75], v[120:123], v[32:35]
  ds_read_b128 v[52:55], v13 offset:16384
  v_mfma_f32_16x16x32_bf16 v[36:39], v[76:79], v[120:123], v[36:39]
  ds_read_b128 v[56:59], v13 offset:17408
  v_mfma_f32_16x16x32_bf16 v[40:43], v[80:83], v[120:123], v[40:43]
  ds_read_b128 v[60:63], v13 offset:18432
  v_mfma_f32_16x16x32_bf16 v[44:47], v[84:87], v[120:123], v[44:47]
  ds_read_b128 v[64:67], v13 offset:19456
  v_mfma_f32_16x16x32_bf16 v[48:51], v[88:91], v[120:123], v[48:51]
  ds_read_b128 v[68:71], v13 offset:20480
  s_waitcnt vmcnt(12)
  s_waitcnt lgkmcnt(5)
  v_mfma_f32_16x16x32_bf16 v[32:35], v[92:95], v[124:127], v[32:35]
  ds_read_b128 v[72:75], v13 offset:21504
  v_mfma_f32_16x16x32_bf16 v[36:39], v[96:99], v[124:127], v[36:39]
  ds_read_b128 v[76:79], v13 offset:22528
  v_mfma_f32_16x16x32_bf16 v[40:43], v[100:103], v[124:127], v[40:43]
  ds_read_b128 v[80:83], v13 offset:23552
  v_mfma_f32_16x16x32_bf16 v[44:47], v[104:107], v[124:127], v[44:47]
  ds_read_b128 v[84:87], v13 offset:24576
  v_mfma_f32_16x16x32_bf16 v[48:51], v[108:111], v[124:127], v[48:51]
  ds_read_b128 v[88:91], v13 offset:25600
  ds_read_b32 v31, v29 offset:140
  s_waitcnt vmcnt(11)
  s_waitcnt lgkmcnt(6)
  v_mfma_f32_16x16x32_bf16 v[32:35], v[52:55], v[128:131], v[32:35]
  ds_read_b128 v[92:95], v13 offset:26624
  v_mfma_f32_16x16x32_bf16 v[36:39], v[56:59], v[128:131], v[36:39]
  ds_read_b128 v[96:99], v13 offset:27648
  v_mfma_f32_16x16x32_bf16 v[40:43], v[60:63], v[128:131], v[40:43]
  ds_read_b128 v[100:103], v13 offset:28672
  v_mfma_f32_16x16x32_bf16 v[44:47], v[64:67], v[128:131], v[44:47]
  ds_read_b128 v[104:107], v13 offset:29696
  v_mfma_f32_16x16x32_bf16 v[48:51], v[68:71], v[128:131], v[48:51]
  ds_read_b128 v[108:111], v13 offset:30720
  s_waitcnt vmcnt(10)
  s_waitcnt lgkmcnt(6)
  v_mfma_f32_16x16x32_bf16 v[32:35], v[72:75], v[132:135], v[32:35]
  ds_read_b128 v[52:55], v13 offset:31744
  v_mfma_f32_16x16x32_bf16 v[36:39], v[76:79], v[132:135], v[36:39]
  ds_read_b128 v[56:59], v13 offset:32768
  v_mfma_f32_16x16x32_bf16 v[40:43], v[80:83], v[132:135], v[40:43]
  ds_read_b128 v[60:63], v13 offset:33792
  v_mfma_f32_16x16x32_bf16 v[44:47], v[84:87], v[132:135], v[44:47]
  ds_read_b128 v[64:67], v13 offset:34816
  v_mfma_f32_16x16x32_bf16 v[48:51], v[88:91], v[132:135], v[48:51]
  ds_read_b128 v[68:71], v13 offset:35840
  s_waitcnt lgkmcnt(10)
  v_readfirstlane_b32 s56, v31
  s_cmp_ge_u32 s56, 4
  s_cbranch_scc1 L_fl37_ok
  s_mov_b32 s57, 0
L_fl37:
  ds_read_b32 v31, v29 offset:140
  s_waitcnt lgkmcnt(0)
  v_readfirstlane_b32 s56, v31
  s_add_u32 s57, s57, 1
  s_cmp_ge_u32 s56, 4
  s_cbranch_scc1 L_fl37_ok
  s_cmp_lt_u32 s57, 1048576
  s_cbranch_scc1 L_fl37
L_fl37_ok:
  s_waitcnt vmcnt(9)
  s_waitcnt lgkmcnt(5)
  v_mfma_f32_16x16x32_bf16 v[32:35], v[92:95], v[136:139], v[32:35]
  ds_read_b128 v[72:75], v13 offset:36864
  v_mfma_f32_16x16x32_bf16 v[36:39], v[96:99], v[136:139], v[36:39]
  ds_read_b128 v[76:79], v13 offset:37888
  v_mfma_f32_16x16x32_bf16 v[40:43], v[100:103], v[136:139], v[40:43]
  ds_read_b128 v[80:83], v13 offset:38912
  v_mfma_f32_16x16x32_bf16 v[44:47], v[104:107], v[136:139], v[44:47]
  ds_read_b128 v[84:87], v13 offset:39936
  v_mfma_f32_16x16x32_bf16 v[48:51], v[108:111], v[136:139], v[48:51]
  ds_read_b128 v[88:91], v13 offset:40960
  s_waitcnt vmcnt(8)
  s_waitcnt lgkmcnt(5)
  v_mfma_f32_16x16x32_bf16 v[32:35], v[52:55], v[140:143], v[32:35]
  ds_read_b128 v[92:95], v13 offset:41984
  v_mfma_f32_16x16x32_bf16 v[36:39], v[56:59], v[140:143], v[36:39]
  ds_read_b128 v[96:99], v13 offset:43008
  v_mfma_f32_16x16x32_bf16 v[40:43], v[60:63], v[140:143], v[40:43]
  ds_read_b128 v[100:103], v13 offset:44032
  v_mfma_f32_16x16x32_bf16 v[44:47], v[64:67], v[140:143], v[44:47]
  ds_read_b128 v[104:107], v13 offset:45056
  v_mfma_f32_16x16x32_bf16 v[48:51], v[68:71], v[140:143], v[48:51]
  ds_read_b128 v[108:111], v13 offset:46080
  ds_read_b32 v31, v29 offset:144
  s_waitcnt vmcnt(7)
  s_waitcnt lgkmcnt(6)
  v_mfma_f32_16x16x32_bf16 v[32:35], v[72:75], v[144:147], v[32:35]
  ds_read_b128 v[52:55], v13 offset:47104
  v_mfma_f32_16x16x32_bf16 v[36:39], v[76:79], v[144:147], v[36:39]
  ds_read_b128 v[56:59], v13 offset:48128
  v_mfma_f32_16x16x32_bf16 v[40:43], v[80:83], v[144:147], v[40:43]
  ds_read_b128 v[60:63], v13 offset:49152
  v_mfma_f32_16x16x32_bf16 v[44:47], v[84:87], v[144:147], v[44:47]
  ds_read_b128 v[64:67], v13 offset:50176
  v_mfma_f32_16x16x32_bf16 v[48:51], v[88:91], v[144:147], v[48:51]
  ds_read_b128 v[68:71], v13 offset:51200
  s_waitcnt vmcnt(6)
  s_waitcnt lgkmcnt(6)
  v_mfma_f32_16x16x32_bf16 v[32:35], v[92:95], v[148:151], v[32:35]
  ds_read_b128 v[72:75], v13 offset:52224
  v_mfma_f32_16x16x32_bf16 v[36:39], v[96:99], v[148:151], v[36:39]
  ds_read_b128 v[76:79], v13 offset:53248
  v_mfma_f32_16x16x32_bf16 v[40:43], v[100:103], v[148:151], v[40:43]
  ds_read_b128 v[80:83], v13 offset:54272
  v_mfma_f32_16x16x32_bf16 v[44:47], v[104:107], v[148:151], v[44:47]
  ds_read_b128 v[84:87], v13 offset:55296
  v_mfma_f32_16x16x32_bf16 v[48:51], v[108:111], v[148:151], v[48:51]
  ds_read_b128 v[88:91], v13 offset:56320
  s_waitcnt lgkmcnt(10)
  v_readfirstlane_b32 s56, v31
  s_cmp_ge_u32 s56, 4
  s_cbranch_scc1 L_fl38_ok
  s_mov_b32 s57, 0
L_fl38:
  ds_read_b32 v31, v29 offset:144
  s_waitcnt lgkmcnt(0)
  v_readfirstlane_b32 s56, v31
  s_add_u32 s57, s57, 1
  s_cmp_ge_u32 s56, 4
  s_cbranch_scc1 L_fl38_ok
  s_cmp_lt_u32 s57, 1048576
  s_cbranch_scc1 L_fl38
L_fl38_ok:
  s_waitcnt vmcnt(5)
  s_waitcnt lgkmcnt(5)
  v_mfma_f32_16x16x32_bf16 v[32:35], v[52:55], v[152:155], v[32:35]
  ds_read_b128 v[92:95], v1 offset:0
  v_mfma_f32_16x16x32_bf16 v[36:39], v[56:59], v[152:155], v[36:39]
  ds_read_b128 v[96:99], v1 offset:1024
  v_mfma_f32_16x16x32_bf16 v[40:43], v[60:63], v[152:155], v[40:43]
  ds_read_b128 v[100:103], v1 offset:2048
  v_mfma_f32_16x16x32_bf16 v[44:47], v[64:67], v[152:155], v[44:47]
  ds_read_b128 v[104:107], v1 offset:3072
  v_mfma_f32_16x16x32_bf16 v[48:51], v[68:71], v[152:155], v[48:51]
  ds_read_b128 v[108:111], v1 offset:4096
  s_waitcnt vmcnt(4)
  s_waitcnt lgkmcnt(5)
  v_mfma_f32_16x16x32_bf16 v[32:35], v[72:75], v[156:159], v[32:35]
  ds_read_b128 v[52:55], v1 offset:5120
  v_mfma_f32_16x16x32_bf16 v[36:39], v[76:79], v[156:159], v[36:39]
  ds_read_b128 v[56:59], v1 offset:6144
  v_mfma_f32_16x16x32_bf16 v[40:43], v[80:83], v[156:159], v[40:43]
  ds_read_b128 v[60:63], v1 offset:7168
  v_mfma_f32_16x16x32_bf16 v[44:47], v[84:87], v[156:159], v[44:47]
  ds_read_b128 v[64:67], v1 offset:8192
  v_mfma_f32_16x16x32_bf16 v[48:51], v[88:91], v[156:159], v[48:51]
  ds_read_b128 v[68:71], v1 offset:9216
  s_waitcnt vmcnt(3)
  s_waitcnt lgkmcnt(5)
  v_mfma_f32_16x16x32_bf16 v[32:35], v[92:95], v[160:163], v[32:35]
  ds_read_b128 v[72:75], v1 offset:10240
  v_mfma_f32_16x16x32_bf16 v[36:39], v[96:99], v[160:163], v[36:39]
  ds_read_b128 v[76:79], v1 offset:11264
  v_mfma_f32_16x16x32_bf16 v[40:43], v[100:103], v[160:163], v[40:43]
  ds_read_b128 v[80:83], v1 offset:12288
  v_mfma_f32_16x16x32_bf16 v[44:47], v[104:107], v[160:163], v[44:47]
  ds_read_b128 v[84:87], v1 offset:13312
  v_mfma_f32_16x16x32_bf16 v[48:51], v[108:111], v[160:163], v[48:51]
  ds_read_b128 v[88:91], v1 offset:14336
  s_waitcnt vmcnt(2)
  s_waitcnt lgkmcnt(5)
  v_mfma_f32_16x16x32_bf16 v[32:35], v[52:55], v[164:167], v[32:35]
  ds_read_b128 v[92:95], v1 offset:15360
  v_mfma_f32_16x16x32_bf16 v[36:39], v[56:59], v[164:167], v[36:39]
  ds_read_b128 v[96:99], v1 offset:16384
  v_mfma_f32_16x16x32_bf16 v[40:43], v[60:63], v[164:167], v[40:43]
  ds_read_b128 v[100:103], v1 offset:17408
  v_mfma_f32_16x16x32_bf16 v[44:47], v[64:67], v[164:167], v[44:47]
  ds_read_b128 v[104:107], v1 offset:18432
  v_mfma_f32_16x16x32_bf16 v[48:51], v[68:71], v[164:167], v[48:51]
  ds_read_b128 v[108:111], v1 offset:19456
  s_waitcnt vmcnt(1)
  s_waitcnt lgkmcnt(5)
  v_mfma_f32_16x16x32_bf16 v[32:35], v[72:75], v[168:171], v[32:35]
  v_mfma_f32_16x16x32_bf16 v[36:39], v[76:79], v[168:171], v[36:39]
  v_mfma_f32_16x16x32_bf16 v[40:43], v[80:83], v[168:171], v[40:43]
  v_mfma_f32_16x16x32_bf16 v[44:47], v[84:87], v[168:171], v[44:47]
  v_mfma_f32_16x16x32_bf16 v[48:51], v[88:91], v[168:171], v[48:51]
  s_waitcnt vmcnt(0)
  s_waitcnt lgkmcnt(0)
  v_mfma_f32_16x16x32_bf16 v[32:35], v[92:95], v[172:175], v[32:35]
  v_mfma_f32_16x16x32_bf16 v[36:39], v[96:99], v[172:175], v[36:39]
  v_mfma_f32_16x16x32_bf16 v[40:43], v[100:103], v[172:175], v[40:43]
  v_mfma_f32_16x16x32_bf16 v[44:47], v[104:107], v[172:175], v[44:47]
  v_mfma_f32_16x16x32_bf16 v[48:51], v[108:111], v[172:175], v[48:51]
  s_nop 3
  v_pk_add_f32 v[32:33], v[32:33], v[212:213]
  v_pk_add_f32 v[34:35], v[34:35], v[214:215]
  v_cvt_pk_bf16_f32 v246, v32, v33
  v_cvt_pk_bf16_f32 v247, v34, v35
  v_pk_add_f32 v[36:37], v[36:37], v[216:217]
  v_pk_add_f32 v[38:39], v[38:39], v[218:219]
  v_cvt_pk_bf16_f32 v248, v36, v37
  v_cvt_pk_bf16_f32 v249, v38, v39
  v_pk_add_f32 v[40:41], v[40:41], v[220:221]
  v_pk_add_f32 v[42:43], v[42:43], v[222:223]
  v_cvt_pk_bf16_f32 v250, v40, v41
  v_cvt_pk_bf16_f32 v251, v42, v43
  v_pk_add_f32 v[44:45], v[44:45], v[224:225]
  v_pk_add_f32 v[46:47], v[46:47], v[226:227]
  v_cvt_pk_bf16_f32 v252, v44, v45
  v_cvt_pk_bf16_f32 v253, v46, v47
  v_pk_add_f32 v[48:49], v[48:49], v[228:229]
  v_pk_add_f32 v[50:51], v[50:51], v[230:231]
  v_cvt_pk_bf16_f32 v254, v48, v49
  v_cvt_pk_bf16_f32 v255, v50, v51
  buffer_store_dwordx2 v[246:247], v6, s[36:39], s63 offen offset:0
  buffer_store_dwordx2 v[248:249], v6, s[36:39], s63 offen offset:32
  buffer_store_dwordx2 v[250:251], v6, s[36:39], s63 offen offset:64
  buffer_store_dwordx2 v[252:253], v6, s[36:39], s63 offen offset:96
  buffer_store_dwordx2 v[254:255], v6, s[36:39], s63 offen offset:128
  s_branch L_fin
L_fin:
L_end:
  s_endpgm
.section .rodata,"a"
.p2align 6
.amdhsa_kernel sequential_preLN__sliding_local_dilated__glu_gated_geglu__prompt_kernel
  .amdhsa_next_free_vgpr 256
  .amdhsa_next_free_sgpr 102
  .amdhsa_accum_offset 256
  .amdhsa_group_segment_fixed_size 0
  .amdhsa_kernarg_size 80
  .amdhsa_user_sgpr_count 2
  .amdhsa_user_sgpr_kernarg_segment_ptr 1
  .amdhsa_system_sgpr_workgroup_id_x 1
.end_amdhsa_kernel
```
